```python
import torch

def _softmax(x, axis=-1):
    return torch.softmax(x, dim=axis)
def _gelu(x):
    return torch.nn.functional.gelu(x, approximate="tanh")
def _silu(x):
    return torch.nn.functional.silu(x)
def _sigmoid(x):
    return torch.sigmoid(x)
def _layernorm(x, axis=-1, eps=1e-5):
    m = x.mean(dim=axis, keepdim=True)
    v = x.var(dim=axis, keepdim=True, unbiased=False)
    return (x - m) / torch.sqrt(v + eps)
def _scatter_add(tgt, idx, src, axis=0):
    return tgt.clone().index_add_(axis, idx, src)
def _segment_sum(src, seg, n):
    out = torch.zeros((n,) + src.shape[1:], dtype=src.dtype)
    return out.index_add_(0, seg, src)
def _pad(x, pw):
    flat = tuple(v for pair in reversed(pw) for v in pair)
    return torch.nn.functional.pad(x, flat)

kernel_name = 'standalone__gqa_block_cached__near_ridge'

def setup_inputs():

    _w = (lambda a: (lambda t: t.to(torch.bfloat16) if t.is_floating_point() else t)(torch.as_tensor(a)))
    B, Sq, D = 8, 192, 512
    Hq, Hkv, Sk, Dh = 32, 32, 1024, 128
    assert Hq % Hkv == 0, (Hq, Hkv)
    return {
        "x": _w((lambda *s: torch.randn(*s, dtype=torch.bfloat16) * 0.8)(B, Sq, D)),
        "k_cache": _w((lambda *s: torch.randn(*s, dtype=torch.bfloat16) * 0.8)(B, Hkv, Sk, Dh)),
        "v_cache": _w((lambda *s: torch.randn(*s, dtype=torch.bfloat16) * 0.05)(B, Hkv, Sk, Dh)),
        "wq": _w((lambda *s: torch.randn(*s, dtype=torch.bfloat16) * 0.8)(D, Hq * Dh) * (D ** -0.5)),
        "wo": _w((lambda *s: torch.randn(*s, dtype=torch.bfloat16) * 0.05)(Hq * Dh, D) * ((Hq * Dh) ** -0.5)),
    }

def reference(x, k_cache, v_cache, wq, wo):
    B, Sq, D = x.shape
    Hq, Dh = 32, 128
    Hkv = k_cache.shape[1]
    rep = Hq // Hkv
    q = (lambda x, *d: x.permute(*d))((x @ wq).reshape(B, Sq, Hq, Dh), 0, 2, 1, 3)
    k = (lambda x, n, axis: torch.repeat_interleave(x, n, dim=axis))(k_cache, rep, axis=1)
    v = (lambda x, n, axis: torch.repeat_interleave(x, n, dim=axis))(v_cache, rep, axis=1)
    scores = torch.einsum("bhqd,bhkd->bhqk", q, k) * (Dh ** -0.5)
    p = _softmax(scores, axis=-1)
    o = torch.einsum("bhqk,bhkd->bhqd", p, v)
    return (lambda x, *d: x.permute(*d))(o, 0, 2, 1, 3).reshape(B, Sq, Hq * Dh) @ wo
```

```asm
; @launch grid=(256,1,1) block=(256,1,1) lds=163840
.amdgcn_target "amdgcn-amd-amdhsa--gfx950"
.text
.globl standalone__gqa_block_cached__near_ridge_kernel
.p2align 8
.type standalone__gqa_block_cached__near_ridge_kernel,@function
standalone__gqa_block_cached__near_ridge_kernel:
    s_cmp_ge_u32 s2, 256
    s_cbranch_scc1 L_end
    s_load_dwordx8 s[72:79], s[0:1], 0
    s_load_dwordx8 s[80:87], s[0:1], 32
    v_lshrrev_b32 v15, 6, v0
    v_and_b32 v1, 63, v0
    s_and_b32 s55, s2, 7
    v_readfirstlane_b32 s40, v15
    s_lshl_b32 s55, s55, 2
    s_bfe_u32 s56, s2, 0x20003
    s_add_u32 s44, s55, s56
    s_lshr_b32 s43, s2, 5
    s_mul_i32 s94, s56, 2
    s_add_u32 s94, s94, s43
    s_and_b32 s94, s94, 3
    v_and_b32 v15, 3, v1
    v_lshlrev_b32 v14, 4, v15
    v_lshrrev_b32 v12, 4, v1
    v_lshl_add_u32 v11, v12, 6, v14
    v_bfe_u32 v13, v1, 2, 2
    v_lshl_add_u32 v2, v13, 8, v11
    v_lshl_add_u32 v196, v13, 13, v11
    v_lshrrev_b32 v10, 5, v1
    v_lshl_add_u32 v11, v10, 6, v14
    v_bfe_u32 v9, v1, 2, 3
    v_lshl_add_u32 v4, v9, 10, v11
    s_mul_i32 s55, s40, 131072
    v_add_u32 v196, s55, v196
    v_add_u32 v197, 31728, v196
    v_add_u32 v198, 63456, v196
    v_add_u32 v199, 95184, v196
    s_mul_i32 s55, s40, 49152
    v_add_u32 v190, s55, v4
    v_add_u32 v191, 7136, v190
    v_add_u32 v192, 14272, v190
    v_add_u32 v193, 24576, v190
    v_add_u32 v194, 31712, v190
    v_add_u32 v195, 38848, v190
    s_mul_i32 s91, s40, 6336
    s_lshl_b32 s93, s40, 12
    s_mul_i32 s92, s40, 4160
    s_mul_i32 s55, s43, 196608
    s_lshl_b32 s56, s44, 8
    s_mov_b32 s18, 196608
    s_mov_b32 s19, 0x20000
    s_sub_u32 s22, 0x400000, s56
    s_mov_b32 s23, 0x20000
    s_waitcnt lgkmcnt(0)
    s_add_u32 s16, s72, s55
    s_addc_u32 s17, s73, 0
    s_add_u32 s20, s78, s56
    s_addc_u32 s21, s79, 0
    s_add_u32 s95, s94, 0
    s_add_u32 m0, s92, 75776
    s_and_b32 s95, s95, 7
    s_lshl_b32 s96, s95, 19
    buffer_load_dwordx4 v196, s[20:23], s96 offen offset:0 lds
    s_lshl_b32 s95, s95, 7
    buffer_load_dwordx4 v197, s[20:23], s96 offen offset:1040 lds
    buffer_load_dwordx4 v198, s[20:23], s96 offen offset:2080 lds
    buffer_load_dwordx4 v199, s[20:23], s96 offen offset:3120 lds
    s_add_u32 m0, s91, 92416
    s_nop 0
    buffer_load_dwordx4 v190, s[16:19], s95 offen offset:0 lds
    buffer_load_dwordx4 v191, s[16:19], s95 offen offset:1056 lds
    buffer_load_dwordx4 v192, s[16:19], s95 offen offset:2112 lds
    s_add_u32 m0, m0, 3168
    s_nop 0
    buffer_load_dwordx4 v193, s[16:19], s95 offen offset:0 lds
    buffer_load_dwordx4 v194, s[16:19], s95 offen offset:1056 lds
    buffer_load_dwordx4 v195, s[16:19], s95 offen offset:2112 lds
    s_getpc_b64 s[88:89]
L_pc:
    s_lshr_b32 s55, s2, 3
    s_lshl_b32 s55, s55, 2
    s_add_u32 s55, s55, s40
    s_lshl_b32 s55, s55, 9
    v_lshl_add_u32 v8, v12, 7, s55
    v_min_u32 v8, L_codeend-L_pc-4, v8
    global_load_dword v248, v8, s[88:89]
    s_lshl_b32 s55, s43, 5
    s_add_u32 s55, s55, s44
    s_lshl_b32 s55, s55, 18
    s_add_u32 s24, s74, s55
    s_addc_u32 s25, s75, 0
    s_mov_b32 s26, 0x40000
    s_mov_b32 s27, 0x20000
    s_add_u32 s28, s76, s55
    s_addc_u32 s29, s77, 0
    s_mov_b32 s30, 0x40000
    s_mov_b32 s31, 0x20000
    v_mov_b32 v8, 0
    buffer_load_dword v249, v8, s[24:27], 0 offen nt
    buffer_load_dword v250, v8, s[28:31], 0 offen nt
    s_mov_b32 s36, s86
    s_mov_b32 s37, s87
    s_mov_b32 s38, 67108864
    s_mov_b32 s39, 0x20000
    s_mov_b32 s4, s84
    s_mov_b32 s5, s85
    s_mov_b32 s6, 256
    s_mov_b32 s7, 0x20000
    s_or_b32 s55, s2, s40
    s_cmp_lg_u32 s55, 0
    s_cbranch_scc1 L_c1
    s_mov_b64 exec, 3
    s_memrealtime s[12:13]
    v_lshlrev_b32 v8, 7, v1
    s_waitcnt lgkmcnt(0)
    s_or_b32 s12, s12, 1
    v_mov_b32 v252, s12
    v_mov_b32 v253, s13
    buffer_store_dwordx2 v[252:253], v8, s[4:7], 0 offen sc1
    s_mov_b64 exec, -1
L_c1:
    s_mov_b32 s8, s82
    s_mov_b32 s9, s83
    s_mov_b32 s10, 1572864
    s_mov_b32 s11, 0x20000
    v_add_u32 v2, s93, v2
    s_mul_i32 s52, s40, 4224
    v_lshlrev_b32 v11, 4, v15
    v_lshl_add_u32 v11, v13, 6, v11
    v_mul_u32_u24 v9, 2080, v12
    v_add_u32 v11, v9, v11
    v_add_u32 v187, 75776, v11
    v_add_u32 v188, 117760, v11
    v_add_u32 v189, 33792, v11
    v_lshlrev_b32 v9, 3, v15
    v_lshl_add_u32 v9, v13, 6, v9
    v_lshl_add_u32 v11, v10, 10, v9
    v_and_b32 v8, 1, v12
    v_lshl_add_u32 v11, v8, 8, v11
    v_lshl_add_u32 v3, v8, 5, v11
    v_xor_b32 v14, 32, v3
    v_lshlrev_b32 v8, 5, v8
    v_xor_b32 v4, v8, v4
    v_mul_u32_u24 v11, 1056, v12
    v_add_u32 v11, v11, v9
    v_add_u32 v7, 16896, v11
    v_add_u32 v8, 84480, v11
    v_mul_u32_u24 v11, 1056, v13
    v_lshl_add_u32 v11, v15, 6, v11
    v_lshl_add_u32 v5, v12, 4, v11
    v_add_u32 v6, 67584, v5
    v_bfe_u32 v11, v1, 3, 1
    v_mul_u32_u24 v11, 1056, v11
    v_and_b32 v9, 7, v1
    v_lshl_add_u32 v11, v9, 6, v11
    v_lshl_add_u32 v11, v12, 4, v11
    v_add_u32 v11, s91, v11
    v_add_u32 v184, 92416, v11
    v_add_u32 v185, 134400, v11
    v_add_u32 v186, 50432, v11
    v_lshlrev_b32 v0, 4, v1
    s_bfe_u32 s55, s2, 0x20001
    s_lshl_b32 s55, s55, 2
    s_bfe_u32 s56, s2, 0x20003
    s_add_u32 s97, s55, s56
    s_lshr_b32 s98, s2, 5
    s_and_b32 s42, s2, 1
    s_mul_i32 s57, s98, 1
    s_mul_i32 s56, s56, 4
    s_add_u32 s99, s57, s56
    s_and_b32 s99, s99, 15
    s_lshl_b32 s14, s99, 15
    s_lshl_b32 s99, s99, 10
    s_lshl_b32 s55, s98, 7
    s_sub_u32 s34, 0x80000, s55
    s_lshl_b32 s56, s40, 19
    s_add_u32 s55, s55, s56
    s_lshl_b32 s56, s42, 21
    s_add_u32 s55, s55, s56
    s_add_u32 s32, s80, s55
    s_addc_u32 s33, s81, 0
    s_mov_b32 s35, 0x20000
    s_mul_i32 s90, s40, 15360
    s_add_u32 s90, s90, 101376
    s_lshl_b32 s53, s40, 12
    s_mul_i32 s45, s2, 1152
    s_add_u32 s45, s45, 16777216
    s_mov_b32 s47, 0x40004000
    v_mov_b32 v11, 0x3f803f80
    v_cmp_eq_u32 vcc, 0, v15
    s_nop 1
    v_cndmask_b32 v11, 0, v11, vcc
    s_mov_b32 s57, 0x3e0293ee
    s_mov_b32 s56, s57
    v_accvgpr_write_b32 a252, v11
    v_accvgpr_write_b32 a253, v11
    v_accvgpr_write_b32 a254, v11
    v_accvgpr_write_b32 a255, v11
    s_add_u32 s95, s94, 1
    s_add_u32 m0, s92, 117760
    s_and_b32 s95, s95, 7
    s_lshl_b32 s96, s95, 19
    buffer_load_dwordx4 v196, s[20:23], s96 offen offset:0 lds
    s_lshl_b32 s95, s95, 7
    buffer_load_dwordx4 v197, s[20:23], s96 offen offset:1040 lds
    buffer_load_dwordx4 v198, s[20:23], s96 offen offset:2080 lds
    buffer_load_dwordx4 v199, s[20:23], s96 offen offset:3120 lds
    s_add_u32 m0, s91, 134400
    s_nop 0
    buffer_load_dwordx4 v190, s[16:19], s95 offen offset:0 lds
    buffer_load_dwordx4 v191, s[16:19], s95 offen offset:1056 lds
    buffer_load_dwordx4 v192, s[16:19], s95 offen offset:2112 lds
    s_add_u32 m0, m0, 3168
    s_nop 0
    buffer_load_dwordx4 v193, s[16:19], s95 offen offset:0 lds
    buffer_load_dwordx4 v194, s[16:19], s95 offen offset:1056 lds
    buffer_load_dwordx4 v195, s[16:19], s95 offen offset:2112 lds
    s_waitcnt vmcnt(13)
    s_barrier
    ds_read_b128 a[0:3], v184 offset:0
    ds_read_b128 a[8:11], v184 offset:2112
    ds_read_b128 a[16:19], v184 offset:4224
    ds_read_b64_tr_b16 a[24:25], v187 offset:0
    ds_read_b64_tr_b16 a[26:27], v187 offset:1040
    ds_read_b64_tr_b16 a[32:33], v187 offset:8
    ds_read_b64_tr_b16 a[34:35], v187 offset:1048
    ds_read_b64_tr_b16 a[40:41], v187 offset:256
    ds_read_b64_tr_b16 a[42:43], v187 offset:1296
    ds_read_b64_tr_b16 a[48:49], v187 offset:264
    ds_read_b64_tr_b16 a[50:51], v187 offset:1304
    ds_read_b64_tr_b16 a[56:57], v187 offset:512
    ds_read_b64_tr_b16 a[58:59], v187 offset:1552
    ds_read_b64_tr_b16 a[64:65], v187 offset:520
    ds_read_b64_tr_b16 a[66:67], v187 offset:1560
    ds_read_b64_tr_b16 a[72:73], v187 offset:768
    ds_read_b64_tr_b16 a[74:75], v187 offset:1808
    ds_read_b64_tr_b16 a[80:81], v187 offset:776
    ds_read_b64_tr_b16 a[82:83], v187 offset:1816
    ds_read_b128 a[4:7], v184 offset:512
    ds_read_b128 a[12:15], v184 offset:2624
    ds_read_b128 a[20:23], v184 offset:4736
    ds_read_b64_tr_b16 a[28:29], v187 offset:8320
    ds_read_b64_tr_b16 a[30:31], v187 offset:9360
    ds_read_b64_tr_b16 a[36:37], v187 offset:8328
    ds_read_b64_tr_b16 a[38:39], v187 offset:9368
    ds_read_b64_tr_b16 a[44:45], v187 offset:8576
    ds_read_b64_tr_b16 a[46:47], v187 offset:9616
    ds_read_b64_tr_b16 a[52:53], v187 offset:8584
    ds_read_b64_tr_b16 a[54:55], v187 offset:9624
    ds_read_b64_tr_b16 a[60:61], v187 offset:8832
    ds_read_b64_tr_b16 a[62:63], v187 offset:9872
    ds_read_b64_tr_b16 a[68:69], v187 offset:8840
    ds_read_b64_tr_b16 a[70:71], v187 offset:9880
    ds_read_b64_tr_b16 a[76:77], v187 offset:9088
    ds_read_b64_tr_b16 a[78:79], v187 offset:10128
    ds_read_b64_tr_b16 a[84:85], v187 offset:9096
    ds_read_b64_tr_b16 a[86:87], v187 offset:10136
    s_waitcnt lgkmcnt(0)
    v_mfma_f32_16x16x32_bf16 v[16:19], a[24:27], a[0:3], 0
    s_add_u32 s95, s94, 2
    s_add_u32 m0, s92, 33792
    s_and_b32 s95, s95, 7
    s_lshl_b32 s96, s95, 19
    buffer_load_dwordx4 v196, s[20:23], s96 offen offset:0 lds
    s_lshl_b32 s95, s95, 7
    v_mfma_f32_16x16x32_bf16 v[16:19], a[28:31], a[4:7], v[16:19]
    v_mfma_f32_16x16x32_bf16 v[48:51], a[24:27], a[8:11], 0
    buffer_load_dwordx4 v197, s[20:23], s96 offen offset:1040 lds
    v_mfma_f32_16x16x32_bf16 v[48:51], a[28:31], a[12:15], v[48:51]
    v_mfma_f32_16x16x32_bf16 v[80:83], a[24:27], a[16:19], 0
    buffer_load_dwordx4 v198, s[20:23], s96 offen offset:2080 lds
    v_mfma_f32_16x16x32_bf16 v[80:83], a[28:31], a[20:23], v[80:83]
    v_mfma_f32_16x16x32_bf16 v[20:23], a[32:35], a[0:3], 0
    buffer_load_dwordx4 v199, s[20:23], s96 offen offset:3120 lds
    s_add_u32 m0, s91, 50432
    v_mfma_f32_16x16x32_bf16 v[20:23], a[36:39], a[4:7], v[20:23]
    v_mfma_f32_16x16x32_bf16 v[52:55], a[32:35], a[8:11], 0
    buffer_load_dwordx4 v190, s[16:19], s95 offen offset:0 lds
    v_mfma_f32_16x16x32_bf16 v[52:55], a[36:39], a[12:15], v[52:55]
    v_mfma_f32_16x16x32_bf16 v[84:87], a[32:35], a[16:19], 0
    buffer_load_dwordx4 v191, s[16:19], s95 offen offset:1056 lds
    v_mfma_f32_16x16x32_bf16 v[84:87], a[36:39], a[20:23], v[84:87]
    v_mfma_f32_16x16x32_bf16 v[24:27], a[40:43], a[0:3], 0
    buffer_load_dwordx4 v192, s[16:19], s95 offen offset:2112 lds
    s_add_u32 m0, m0, 3168
    v_mfma_f32_16x16x32_bf16 v[24:27], a[44:47], a[4:7], v[24:27]
    v_mfma_f32_16x16x32_bf16 v[56:59], a[40:43], a[8:11], 0
    buffer_load_dwordx4 v193, s[16:19], s95 offen offset:0 lds
    v_mfma_f32_16x16x32_bf16 v[56:59], a[44:47], a[12:15], v[56:59]
    v_mfma_f32_16x16x32_bf16 v[88:91], a[40:43], a[16:19], 0
    buffer_load_dwordx4 v194, s[16:19], s95 offen offset:1056 lds
    v_mfma_f32_16x16x32_bf16 v[88:91], a[44:47], a[20:23], v[88:91]
    v_mfma_f32_16x16x32_bf16 v[28:31], a[48:51], a[0:3], 0
    buffer_load_dwordx4 v195, s[16:19], s95 offen offset:2112 lds
    v_mfma_f32_16x16x32_bf16 v[28:31], a[52:55], a[4:7], v[28:31]
    v_mfma_f32_16x16x32_bf16 v[60:63], a[48:51], a[8:11], 0
    s_waitcnt vmcnt(10)
    s_barrier
    v_mfma_f32_16x16x32_bf16 v[60:63], a[52:55], a[12:15], v[60:63]
    ds_read_b128 a[88:91], v185 offset:0
    ds_read_b128 a[96:99], v185 offset:2112
    s_add_u32 s95, s94, 3
    s_add_u32 m0, s92, 75776
    s_and_b32 s95, s95, 7
    s_lshl_b32 s96, s95, 19
    buffer_load_dwordx4 v196, s[20:23], s96 offen offset:0 lds
    s_lshl_b32 s95, s95, 7
    v_mfma_f32_16x16x32_bf16 v[92:95], a[48:51], a[16:19], 0
    ds_read_b128 a[104:107], v185 offset:4224
    ds_read_b64_tr_b16 a[112:113], v188 offset:0
    v_mfma_f32_16x16x32_bf16 v[92:95], a[52:55], a[20:23], v[92:95]
    ds_read_b64_tr_b16 a[114:115], v188 offset:1040
    buffer_load_dwordx4 v197, s[20:23], s96 offen offset:1040 lds
    v_mfma_f32_16x16x32_bf16 v[32:35], a[56:59], a[0:3], 0
    ds_read_b64_tr_b16 a[120:121], v188 offset:8
    ds_read_b64_tr_b16 a[122:123], v188 offset:1048
    v_mfma_f32_16x16x32_bf16 v[32:35], a[60:63], a[4:7], v[32:35]
    ds_read_b64_tr_b16 a[128:129], v188 offset:256
    buffer_load_dwordx4 v198, s[20:23], s96 offen offset:2080 lds
    v_mfma_f32_16x16x32_bf16 v[64:67], a[56:59], a[8:11], 0
    ds_read_b64_tr_b16 a[130:131], v188 offset:1296
    ds_read_b64_tr_b16 a[136:137], v188 offset:264
    v_mfma_f32_16x16x32_bf16 v[64:67], a[60:63], a[12:15], v[64:67]
    ds_read_b64_tr_b16 a[138:139], v188 offset:1304
    v_mfma_f32_16x16x32_bf16 v[96:99], a[56:59], a[16:19], 0
    ds_read_b64_tr_b16 a[144:145], v188 offset:512
    ds_read_b64_tr_b16 a[146:147], v188 offset:1552
    buffer_load_dwordx4 v199, s[20:23], s96 offen offset:3120 lds
    s_add_u32 m0, s91, 92416
    v_mfma_f32_16x16x32_bf16 v[96:99], a[60:63], a[20:23], v[96:99]
    ds_read_b64_tr_b16 a[152:153], v188 offset:520
    v_mfma_f32_16x16x32_bf16 v[36:39], a[64:67], a[0:3], 0
    ds_read_b64_tr_b16 a[154:155], v188 offset:1560
    ds_read_b64_tr_b16 a[160:161], v188 offset:768
    buffer_load_dwordx4 v190, s[16:19], s95 offen offset:0 lds
    v_mfma_f32_16x16x32_bf16 v[36:39], a[68:71], a[4:7], v[36:39]
    ds_read_b64_tr_b16 a[162:163], v188 offset:1808
    v_mfma_f32_16x16x32_bf16 v[68:71], a[64:67], a[8:11], 0
    ds_read_b64_tr_b16 a[168:169], v188 offset:776
    ds_read_b64_tr_b16 a[170:171], v188 offset:1816
    v_mfma_f32_16x16x32_bf16 v[68:71], a[68:71], a[12:15], v[68:71]
    ds_read_b128 a[92:95], v185 offset:512
    buffer_load_dwordx4 v191, s[16:19], s95 offen offset:1056 lds
    v_mfma_f32_16x16x32_bf16 v[100:103], a[64:67], a[16:19], 0
    ds_read_b128 a[100:103], v185 offset:2624
    ds_read_b128 a[108:111], v185 offset:4736
    v_mfma_f32_16x16x32_bf16 v[100:103], a[68:71], a[20:23], v[100:103]
    ds_read_b64_tr_b16 a[116:117], v188 offset:8320
    buffer_load_dwordx4 v192, s[16:19], s95 offen offset:2112 lds
    s_add_u32 m0, m0, 3168
    v_mfma_f32_16x16x32_bf16 v[40:43], a[72:75], a[0:3], 0
    ds_read_b64_tr_b16 a[118:119], v188 offset:9360
    ds_read_b64_tr_b16 a[124:125], v188 offset:8328
    v_mfma_f32_16x16x32_bf16 v[40:43], a[76:79], a[4:7], v[40:43]
    ds_read_b64_tr_b16 a[126:127], v188 offset:9368
    v_mfma_f32_16x16x32_bf16 v[72:75], a[72:75], a[8:11], 0
    ds_read_b64_tr_b16 a[132:133], v188 offset:8576
    ds_read_b64_tr_b16 a[134:135], v188 offset:9616
    buffer_load_dwordx4 v193, s[16:19], s95 offen offset:0 lds
    v_mfma_f32_16x16x32_bf16 v[72:75], a[76:79], a[12:15], v[72:75]
    ds_read_b64_tr_b16 a[140:141], v188 offset:8584
    v_mfma_f32_16x16x32_bf16 v[104:107], a[72:75], a[16:19], 0
    ds_read_b64_tr_b16 a[142:143], v188 offset:9624
    ds_read_b64_tr_b16 a[148:149], v188 offset:8832
    buffer_load_dwordx4 v194, s[16:19], s95 offen offset:1056 lds
    v_mfma_f32_16x16x32_bf16 v[104:107], a[76:79], a[20:23], v[104:107]
    ds_read_b64_tr_b16 a[150:151], v188 offset:9872
    v_mfma_f32_16x16x32_bf16 v[44:47], a[80:83], a[0:3], 0
    ds_read_b64_tr_b16 a[156:157], v188 offset:8840
    ds_read_b64_tr_b16 a[158:159], v188 offset:9880
    v_mfma_f32_16x16x32_bf16 v[44:47], a[84:87], a[4:7], v[44:47]
    ds_read_b64_tr_b16 a[164:165], v188 offset:9088
    buffer_load_dwordx4 v195, s[16:19], s95 offen offset:2112 lds
    v_mfma_f32_16x16x32_bf16 v[76:79], a[80:83], a[8:11], 0
    ds_read_b64_tr_b16 a[166:167], v188 offset:10128
    ds_read_b64_tr_b16 a[172:173], v188 offset:9096
    v_mfma_f32_16x16x32_bf16 v[76:79], a[84:87], a[12:15], v[76:79]
    ds_read_b64_tr_b16 a[174:175], v188 offset:10136
    s_lshr_b32 s55, s2, 1
    s_lshl_b32 s55, s55, 14
    s_add_u32 s55, s55, s93
    s_lshl_b32 s54, s42, 21
    s_add_u32 s55, s55, s54
    v_lshl_add_u32 v251, v1, 6, s55
    global_load_dword v251, v251, s[80:81]
    v_mfma_f32_16x16x32_bf16 v[108:111], a[80:83], a[16:19], 0
    v_mfma_f32_16x16x32_bf16 v[108:111], a[84:87], a[20:23], v[108:111]
    s_waitcnt vmcnt(11) lgkmcnt(0)
    s_barrier
    v_mfma_f32_16x16x32_bf16 v[16:19], a[112:115], a[88:91], v[16:19]
    ds_read_b128 a[0:3], v186 offset:0
    s_add_u32 s95, s94, 4
    s_add_u32 m0, s92, 117760
    s_and_b32 s95, s95, 7
    s_lshl_b32 s96, s95, 19
    buffer_load_dwordx4 v196, s[20:23], s96 offen offset:0 lds
    s_lshl_b32 s95, s95, 7
    v_mfma_f32_16x16x32_bf16 v[16:19], a[116:119], a[92:95], v[16:19]
    ds_read_b128 a[8:11], v186 offset:2112
    v_mfma_f32_16x16x32_bf16 v[48:51], a[112:115], a[96:99], v[48:51]
    ds_read_b128 a[16:19], v186 offset:4224
    v_mfma_f32_16x16x32_bf16 v[48:51], a[116:119], a[100:103], v[48:51]
    ds_read_b64_tr_b16 a[24:25], v189 offset:0
    v_mfma_f32_16x16x32_bf16 v[80:83], a[112:115], a[104:107], v[80:83]
    ds_read_b64_tr_b16 a[26:27], v189 offset:1040
    buffer_load_dwordx4 v197, s[20:23], s96 offen offset:1040 lds
    v_mfma_f32_16x16x32_bf16 v[80:83], a[116:119], a[108:111], v[80:83]
    ds_read_b64_tr_b16 a[32:33], v189 offset:8
    v_mfma_f32_16x16x32_bf16 v[20:23], a[120:123], a[88:91], v[20:23]
    ds_read_b64_tr_b16 a[34:35], v189 offset:1048
    v_mfma_f32_16x16x32_bf16 v[20:23], a[124:127], a[92:95], v[20:23]
    v_mfma_f32_16x16x32_bf16 v[52:55], a[120:123], a[96:99], v[52:55]
    ds_read_b64_tr_b16 a[40:41], v189 offset:256
    v_mfma_f32_16x16x32_bf16 v[52:55], a[124:127], a[100:103], v[52:55]
    ds_read_b64_tr_b16 a[42:43], v189 offset:1296
    buffer_load_dwordx4 v198, s[20:23], s96 offen offset:2080 lds
    v_mfma_f32_16x16x32_bf16 v[84:87], a[120:123], a[104:107], v[84:87]
    ds_read_b64_tr_b16 a[48:49], v189 offset:264
    v_mfma_f32_16x16x32_bf16 v[84:87], a[124:127], a[108:111], v[84:87]
    ds_read_b64_tr_b16 a[50:51], v189 offset:1304
    v_mfma_f32_16x16x32_bf16 v[24:27], a[128:131], a[88:91], v[24:27]
    ds_read_b64_tr_b16 a[56:57], v189 offset:512
    v_mfma_f32_16x16x32_bf16 v[24:27], a[132:135], a[92:95], v[24:27]
    ds_read_b64_tr_b16 a[58:59], v189 offset:1552
    v_mfma_f32_16x16x32_bf16 v[56:59], a[128:131], a[96:99], v[56:59]
    buffer_load_dwordx4 v199, s[20:23], s96 offen offset:3120 lds
    s_add_u32 m0, s91, 134400
    v_mfma_f32_16x16x32_bf16 v[56:59], a[132:135], a[100:103], v[56:59]
    ds_read_b64_tr_b16 a[64:65], v189 offset:520
    v_mfma_f32_16x16x32_bf16 v[88:91], a[128:131], a[104:107], v[88:91]
    ds_read_b64_tr_b16 a[66:67], v189 offset:1560
    v_mfma_f32_16x16x32_bf16 v[88:91], a[132:135], a[108:111], v[88:91]
    ds_read_b64_tr_b16 a[72:73], v189 offset:768
    v_mfma_f32_16x16x32_bf16 v[28:31], a[136:139], a[88:91], v[28:31]
    ds_read_b64_tr_b16 a[74:75], v189 offset:1808
    v_mfma_f32_16x16x32_bf16 v[28:31], a[140:143], a[92:95], v[28:31]
    ds_read_b64_tr_b16 a[80:81], v189 offset:776
    buffer_load_dwordx4 v190, s[16:19], s95 offen offset:0 lds
    v_mfma_f32_16x16x32_bf16 v[60:63], a[136:139], a[96:99], v[60:63]
    ds_read_b64_tr_b16 a[82:83], v189 offset:1816
    v_mfma_f32_16x16x32_bf16 v[60:63], a[140:143], a[100:103], v[60:63]
    v_mfma_f32_16x16x32_bf16 v[92:95], a[136:139], a[104:107], v[92:95]
    ds_read_b128 a[4:7], v186 offset:512
    v_mfma_f32_16x16x32_bf16 v[92:95], a[140:143], a[108:111], v[92:95]
    ds_read_b128 a[12:15], v186 offset:2624
    v_mfma_f32_16x16x32_bf16 v[32:35], a[144:147], a[88:91], v[32:35]
    ds_read_b128 a[20:23], v186 offset:4736
    buffer_load_dwordx4 v191, s[16:19], s95 offen offset:1056 lds
    v_mfma_f32_16x16x32_bf16 v[32:35], a[148:151], a[92:95], v[32:35]
    ds_read_b64_tr_b16 a[28:29], v189 offset:8320
    v_mfma_f32_16x16x32_bf16 v[64:67], a[144:147], a[96:99], v[64:67]
    ds_read_b64_tr_b16 a[30:31], v189 offset:9360
    v_mfma_f32_16x16x32_bf16 v[64:67], a[148:151], a[100:103], v[64:67]
    ds_read_b64_tr_b16 a[36:37], v189 offset:8328
    v_mfma_f32_16x16x32_bf16 v[96:99], a[144:147], a[104:107], v[96:99]
    ds_read_b64_tr_b16 a[38:39], v189 offset:9368
    buffer_load_dwordx4 v192, s[16:19], s95 offen offset:2112 lds
    s_add_u32 m0, m0, 3168
    v_mfma_f32_16x16x32_bf16 v[96:99], a[148:151], a[108:111], v[96:99]
    v_mfma_f32_16x16x32_bf16 v[36:39], a[152:155], a[88:91], v[36:39]
    ds_read_b64_tr_b16 a[44:45], v189 offset:8576
    v_mfma_f32_16x16x32_bf16 v[36:39], a[156:159], a[92:95], v[36:39]
    ds_read_b64_tr_b16 a[46:47], v189 offset:9616
    v_mfma_f32_16x16x32_bf16 v[68:71], a[152:155], a[96:99], v[68:71]
    ds_read_b64_tr_b16 a[52:53], v189 offset:8584
    v_mfma_f32_16x16x32_bf16 v[68:71], a[156:159], a[100:103], v[68:71]
    ds_read_b64_tr_b16 a[54:55], v189 offset:9624
    buffer_load_dwordx4 v193, s[16:19], s95 offen offset:0 lds
    v_mfma_f32_16x16x32_bf16 v[100:103], a[152:155], a[104:107], v[100:103]
    ds_read_b64_tr_b16 a[60:61], v189 offset:8832
    v_mfma_f32_16x16x32_bf16 v[100:103], a[156:159], a[108:111], v[100:103]
    ds_read_b64_tr_b16 a[62:63], v189 offset:9872
    v_mfma_f32_16x16x32_bf16 v[40:43], a[160:163], a[88:91], v[40:43]
    v_mfma_f32_16x16x32_bf16 v[40:43], a[164:167], a[92:95], v[40:43]
    ds_read_b64_tr_b16 a[68:69], v189 offset:8840
    v_mfma_f32_16x16x32_bf16 v[72:75], a[160:163], a[96:99], v[72:75]
    ds_read_b64_tr_b16 a[70:71], v189 offset:9880
    buffer_load_dwordx4 v194, s[16:19], s95 offen offset:1056 lds
    v_mfma_f32_16x16x32_bf16 v[72:75], a[164:167], a[100:103], v[72:75]
    ds_read_b64_tr_b16 a[76:77], v189 offset:9088
    v_mfma_f32_16x16x32_bf16 v[104:107], a[160:163], a[104:107], v[104:107]
    ds_read_b64_tr_b16 a[78:79], v189 offset:10128
    v_mfma_f32_16x16x32_bf16 v[104:107], a[164:167], a[108:111], v[104:107]
    ds_read_b64_tr_b16 a[84:85], v189 offset:9096
    v_mfma_f32_16x16x32_bf16 v[44:47], a[168:171], a[88:91], v[44:47]
    ds_read_b64_tr_b16 a[86:87], v189 offset:10136
    v_mfma_f32_16x16x32_bf16 v[44:47], a[172:175], a[92:95], v[44:47]
    buffer_load_dwordx4 v195, s[16:19], s95 offen offset:2112 lds
    v_mfma_f32_16x16x32_bf16 v[76:79], a[168:171], a[96:99], v[76:79]
    v_mfma_f32_16x16x32_bf16 v[76:79], a[172:175], a[100:103], v[76:79]
    v_mfma_f32_16x16x32_bf16 v[108:111], a[168:171], a[104:107], v[108:111]
    v_mfma_f32_16x16x32_bf16 v[108:111], a[172:175], a[108:111], v[108:111]
    s_waitcnt vmcnt(11) lgkmcnt(0)
    s_barrier
    v_mfma_f32_16x16x32_bf16 v[16:19], a[24:27], a[0:3], v[16:19]
    ds_read_b128 a[88:91], v184 offset:0
    s_add_u32 s95, s94, 5
    s_add_u32 m0, s92, 33792
    s_and_b32 s95, s95, 7
    s_lshl_b32 s96, s95, 19
    buffer_load_dwordx4 v196, s[20:23], s96 offen offset:0 lds
    s_lshl_b32 s95, s95, 7
    v_mfma_f32_16x16x32_bf16 v[16:19], a[28:31], a[4:7], v[16:19]
    ds_read_b128 a[96:99], v184 offset:2112
    v_mfma_f32_16x16x32_bf16 v[48:51], a[24:27], a[8:11], v[48:51]
    ds_read_b128 a[104:107], v184 offset:4224
    v_mfma_f32_16x16x32_bf16 v[48:51], a[28:31], a[12:15], v[48:51]
    ds_read_b64_tr_b16 a[112:113], v187 offset:0
    v_mfma_f32_16x16x32_bf16 v[80:83], a[24:27], a[16:19], v[80:83]
    ds_read_b64_tr_b16 a[114:115], v187 offset:1040
    buffer_load_dwordx4 v197, s[20:23], s96 offen offset:1040 lds
    v_mfma_f32_16x16x32_bf16 v[80:83], a[28:31], a[20:23], v[80:83]
    ds_read_b64_tr_b16 a[120:121], v187 offset:8
    v_mfma_f32_16x16x32_bf16 v[20:23], a[32:35], a[0:3], v[20:23]
    ds_read_b64_tr_b16 a[122:123], v187 offset:1048
    v_mfma_f32_16x16x32_bf16 v[20:23], a[36:39], a[4:7], v[20:23]
    v_mfma_f32_16x16x32_bf16 v[52:55], a[32:35], a[8:11], v[52:55]
    ds_read_b64_tr_b16 a[128:129], v187 offset:256
    v_mfma_f32_16x16x32_bf16 v[52:55], a[36:39], a[12:15], v[52:55]
    ds_read_b64_tr_b16 a[130:131], v187 offset:1296
    buffer_load_dwordx4 v198, s[20:23], s96 offen offset:2080 lds
    v_mfma_f32_16x16x32_bf16 v[84:87], a[32:35], a[16:19], v[84:87]
    ds_read_b64_tr_b16 a[136:137], v187 offset:264
    v_mfma_f32_16x16x32_bf16 v[84:87], a[36:39], a[20:23], v[84:87]
    ds_read_b64_tr_b16 a[138:139], v187 offset:1304
    v_mfma_f32_16x16x32_bf16 v[24:27], a[40:43], a[0:3], v[24:27]
    ds_read_b64_tr_b16 a[144:145], v187 offset:512
    v_mfma_f32_16x16x32_bf16 v[24:27], a[44:47], a[4:7], v[24:27]
    ds_read_b64_tr_b16 a[146:147], v187 offset:1552
    v_mfma_f32_16x16x32_bf16 v[56:59], a[40:43], a[8:11], v[56:59]
    buffer_load_dwordx4 v199, s[20:23], s96 offen offset:3120 lds
    s_add_u32 m0, s91, 50432
    v_mfma_f32_16x16x32_bf16 v[56:59], a[44:47], a[12:15], v[56:59]
    ds_read_b64_tr_b16 a[152:153], v187 offset:520
    v_mfma_f32_16x16x32_bf16 v[88:91], a[40:43], a[16:19], v[88:91]
    ds_read_b64_tr_b16 a[154:155], v187 offset:1560
    v_mfma_f32_16x16x32_bf16 v[88:91], a[44:47], a[20:23], v[88:91]
    ds_read_b64_tr_b16 a[160:161], v187 offset:768
    v_mfma_f32_16x16x32_bf16 v[28:31], a[48:51], a[0:3], v[28:31]
    ds_read_b64_tr_b16 a[162:163], v187 offset:1808
    v_mfma_f32_16x16x32_bf16 v[28:31], a[52:55], a[4:7], v[28:31]
    ds_read_b64_tr_b16 a[168:169], v187 offset:776
    buffer_load_dwordx4 v190, s[16:19], s95 offen offset:0 lds
    v_mfma_f32_16x16x32_bf16 v[60:63], a[48:51], a[8:11], v[60:63]
    ds_read_b64_tr_b16 a[170:171], v187 offset:1816
    v_mfma_f32_16x16x32_bf16 v[60:63], a[52:55], a[12:15], v[60:63]
    v_mfma_f32_16x16x32_bf16 v[92:95], a[48:51], a[16:19], v[92:95]
    ds_read_b128 a[92:95], v184 offset:512
    v_mfma_f32_16x16x32_bf16 v[92:95], a[52:55], a[20:23], v[92:95]
    ds_read_b128 a[100:103], v184 offset:2624
    v_mfma_f32_16x16x32_bf16 v[32:35], a[56:59], a[0:3], v[32:35]
    ds_read_b128 a[108:111], v184 offset:4736
    buffer_load_dwordx4 v191, s[16:19], s95 offen offset:1056 lds
    v_mfma_f32_16x16x32_bf16 v[32:35], a[60:63], a[4:7], v[32:35]
    ds_read_b64_tr_b16 a[116:117], v187 offset:8320
    v_mfma_f32_16x16x32_bf16 v[64:67], a[56:59], a[8:11], v[64:67]
    ds_read_b64_tr_b16 a[118:119], v187 offset:9360
    v_mfma_f32_16x16x32_bf16 v[64:67], a[60:63], a[12:15], v[64:67]
    ds_read_b64_tr_b16 a[124:125], v187 offset:8328
    v_mfma_f32_16x16x32_bf16 v[96:99], a[56:59], a[16:19], v[96:99]
    ds_read_b64_tr_b16 a[126:127], v187 offset:9368
    buffer_load_dwordx4 v192, s[16:19], s95 offen offset:2112 lds
    s_add_u32 m0, m0, 3168
    v_mfma_f32_16x16x32_bf16 v[96:99], a[60:63], a[20:23], v[96:99]
    v_mfma_f32_16x16x32_bf16 v[36:39], a[64:67], a[0:3], v[36:39]
    ds_read_b64_tr_b16 a[132:133], v187 offset:8576
    v_mfma_f32_16x16x32_bf16 v[36:39], a[68:71], a[4:7], v[36:39]
    ds_read_b64_tr_b16 a[134:135], v187 offset:9616
    v_mfma_f32_16x16x32_bf16 v[68:71], a[64:67], a[8:11], v[68:71]
    ds_read_b64_tr_b16 a[140:141], v187 offset:8584
    v_mfma_f32_16x16x32_bf16 v[68:71], a[68:71], a[12:15], v[68:71]
    ds_read_b64_tr_b16 a[142:143], v187 offset:9624
    buffer_load_dwordx4 v193, s[16:19], s95 offen offset:0 lds
    v_mfma_f32_16x16x32_bf16 v[100:103], a[64:67], a[16:19], v[100:103]
    ds_read_b64_tr_b16 a[148:149], v187 offset:8832
    v_mfma_f32_16x16x32_bf16 v[100:103], a[68:71], a[20:23], v[100:103]
    ds_read_b64_tr_b16 a[150:151], v187 offset:9872
    v_mfma_f32_16x16x32_bf16 v[40:43], a[72:75], a[0:3], v[40:43]
    v_mfma_f32_16x16x32_bf16 v[40:43], a[76:79], a[4:7], v[40:43]
    ds_read_b64_tr_b16 a[156:157], v187 offset:8840
    v_mfma_f32_16x16x32_bf16 v[72:75], a[72:75], a[8:11], v[72:75]
    ds_read_b64_tr_b16 a[158:159], v187 offset:9880
    buffer_load_dwordx4 v194, s[16:19], s95 offen offset:1056 lds
    v_mfma_f32_16x16x32_bf16 v[72:75], a[76:79], a[12:15], v[72:75]
    ds_read_b64_tr_b16 a[164:165], v187 offset:9088
    v_mfma_f32_16x16x32_bf16 v[104:107], a[72:75], a[16:19], v[104:107]
    ds_read_b64_tr_b16 a[166:167], v187 offset:10128
    v_mfma_f32_16x16x32_bf16 v[104:107], a[76:79], a[20:23], v[104:107]
    ds_read_b64_tr_b16 a[172:173], v187 offset:9096
    v_mfma_f32_16x16x32_bf16 v[44:47], a[80:83], a[0:3], v[44:47]
    ds_read_b64_tr_b16 a[174:175], v187 offset:10136
    v_mfma_f32_16x16x32_bf16 v[44:47], a[84:87], a[4:7], v[44:47]
    buffer_load_dwordx4 v195, s[16:19], s95 offen offset:2112 lds
    v_mfma_f32_16x16x32_bf16 v[76:79], a[80:83], a[8:11], v[76:79]
    v_mfma_f32_16x16x32_bf16 v[76:79], a[84:87], a[12:15], v[76:79]
    v_mfma_f32_16x16x32_bf16 v[108:111], a[80:83], a[16:19], v[108:111]
    v_mfma_f32_16x16x32_bf16 v[108:111], a[84:87], a[20:23], v[108:111]
    s_waitcnt vmcnt(10) lgkmcnt(0)
    s_barrier
    v_mfma_f32_16x16x32_bf16 v[16:19], a[112:115], a[88:91], v[16:19]
    ds_read_b128 a[0:3], v185 offset:0
    s_add_u32 s95, s94, 6
    s_add_u32 m0, s92, 75776
    s_and_b32 s95, s95, 7
    s_lshl_b32 s96, s95, 19
    buffer_load_dwordx4 v196, s[20:23], s96 offen offset:0 lds
    s_lshl_b32 s95, s95, 7
    v_mfma_f32_16x16x32_bf16 v[16:19], a[116:119], a[92:95], v[16:19]
    ds_read_b128 a[8:11], v185 offset:2112
    v_mfma_f32_16x16x32_bf16 v[48:51], a[112:115], a[96:99], v[48:51]
    ds_read_b128 a[16:19], v185 offset:4224
    v_mfma_f32_16x16x32_bf16 v[48:51], a[116:119], a[100:103], v[48:51]
    ds_read_b64_tr_b16 a[24:25], v188 offset:0
    v_mfma_f32_16x16x32_bf16 v[80:83], a[112:115], a[104:107], v[80:83]
    ds_read_b64_tr_b16 a[26:27], v188 offset:1040
    buffer_load_dwordx4 v197, s[20:23], s96 offen offset:1040 lds
    v_mfma_f32_16x16x32_bf16 v[80:83], a[116:119], a[108:111], v[80:83]
    ds_read_b64_tr_b16 a[32:33], v188 offset:8
    v_mfma_f32_16x16x32_bf16 v[20:23], a[120:123], a[88:91], v[20:23]
    ds_read_b64_tr_b16 a[34:35], v188 offset:1048
    v_mfma_f32_16x16x32_bf16 v[20:23], a[124:127], a[92:95], v[20:23]
    v_mfma_f32_16x16x32_bf16 v[52:55], a[120:123], a[96:99], v[52:55]
    ds_read_b64_tr_b16 a[40:41], v188 offset:256
    v_mfma_f32_16x16x32_bf16 v[52:55], a[124:127], a[100:103], v[52:55]
    ds_read_b64_tr_b16 a[42:43], v188 offset:1296
    buffer_load_dwordx4 v198, s[20:23], s96 offen offset:2080 lds
    v_mfma_f32_16x16x32_bf16 v[84:87], a[120:123], a[104:107], v[84:87]
    ds_read_b64_tr_b16 a[48:49], v188 offset:264
    v_mfma_f32_16x16x32_bf16 v[84:87], a[124:127], a[108:111], v[84:87]
    ds_read_b64_tr_b16 a[50:51], v188 offset:1304
    v_mfma_f32_16x16x32_bf16 v[24:27], a[128:131], a[88:91], v[24:27]
    ds_read_b64_tr_b16 a[56:57], v188 offset:512
    v_mfma_f32_16x16x32_bf16 v[24:27], a[132:135], a[92:95], v[24:27]
    ds_read_b64_tr_b16 a[58:59], v188 offset:1552
    v_mfma_f32_16x16x32_bf16 v[56:59], a[128:131], a[96:99], v[56:59]
    buffer_load_dwordx4 v199, s[20:23], s96 offen offset:3120 lds
    s_add_u32 m0, s91, 92416
    v_mfma_f32_16x16x32_bf16 v[56:59], a[132:135], a[100:103], v[56:59]
    ds_read_b64_tr_b16 a[64:65], v188 offset:520
    v_mfma_f32_16x16x32_bf16 v[88:91], a[128:131], a[104:107], v[88:91]
    ds_read_b64_tr_b16 a[66:67], v188 offset:1560
    v_mfma_f32_16x16x32_bf16 v[88:91], a[132:135], a[108:111], v[88:91]
    ds_read_b64_tr_b16 a[72:73], v188 offset:768
    v_mfma_f32_16x16x32_bf16 v[28:31], a[136:139], a[88:91], v[28:31]
    ds_read_b64_tr_b16 a[74:75], v188 offset:1808
    v_mfma_f32_16x16x32_bf16 v[28:31], a[140:143], a[92:95], v[28:31]
    ds_read_b64_tr_b16 a[80:81], v188 offset:776
    buffer_load_dwordx4 v190, s[16:19], s95 offen offset:0 lds
    v_mfma_f32_16x16x32_bf16 v[60:63], a[136:139], a[96:99], v[60:63]
    ds_read_b64_tr_b16 a[82:83], v188 offset:1816
    v_mfma_f32_16x16x32_bf16 v[60:63], a[140:143], a[100:103], v[60:63]
    v_mfma_f32_16x16x32_bf16 v[92:95], a[136:139], a[104:107], v[92:95]
    ds_read_b128 a[4:7], v185 offset:512
    v_mfma_f32_16x16x32_bf16 v[92:95], a[140:143], a[108:111], v[92:95]
    ds_read_b128 a[12:15], v185 offset:2624
    v_mfma_f32_16x16x32_bf16 v[32:35], a[144:147], a[88:91], v[32:35]
    ds_read_b128 a[20:23], v185 offset:4736
    buffer_load_dwordx4 v191, s[16:19], s95 offen offset:1056 lds
    v_mfma_f32_16x16x32_bf16 v[32:35], a[148:151], a[92:95], v[32:35]
    ds_read_b64_tr_b16 a[28:29], v188 offset:8320
    v_mfma_f32_16x16x32_bf16 v[64:67], a[144:147], a[96:99], v[64:67]
    ds_read_b64_tr_b16 a[30:31], v188 offset:9360
    v_mfma_f32_16x16x32_bf16 v[64:67], a[148:151], a[100:103], v[64:67]
    ds_read_b64_tr_b16 a[36:37], v188 offset:8328
    v_mfma_f32_16x16x32_bf16 v[96:99], a[144:147], a[104:107], v[96:99]
    ds_read_b64_tr_b16 a[38:39], v188 offset:9368
    buffer_load_dwordx4 v192, s[16:19], s95 offen offset:2112 lds
    s_add_u32 m0, m0, 3168
    v_mfma_f32_16x16x32_bf16 v[96:99], a[148:151], a[108:111], v[96:99]
    v_mfma_f32_16x16x32_bf16 v[36:39], a[152:155], a[88:91], v[36:39]
    ds_read_b64_tr_b16 a[44:45], v188 offset:8576
    v_mfma_f32_16x16x32_bf16 v[36:39], a[156:159], a[92:95], v[36:39]
    ds_read_b64_tr_b16 a[46:47], v188 offset:9616
    v_mfma_f32_16x16x32_bf16 v[68:71], a[152:155], a[96:99], v[68:71]
    ds_read_b64_tr_b16 a[52:53], v188 offset:8584
    v_mfma_f32_16x16x32_bf16 v[68:71], a[156:159], a[100:103], v[68:71]
    ds_read_b64_tr_b16 a[54:55], v188 offset:9624
    buffer_load_dwordx4 v193, s[16:19], s95 offen offset:0 lds
    v_mfma_f32_16x16x32_bf16 v[100:103], a[152:155], a[104:107], v[100:103]
    ds_read_b64_tr_b16 a[60:61], v188 offset:8832
    v_mfma_f32_16x16x32_bf16 v[100:103], a[156:159], a[108:111], v[100:103]
    ds_read_b64_tr_b16 a[62:63], v188 offset:9872
    v_mfma_f32_16x16x32_bf16 v[40:43], a[160:163], a[88:91], v[40:43]
    v_mfma_f32_16x16x32_bf16 v[40:43], a[164:167], a[92:95], v[40:43]
    ds_read_b64_tr_b16 a[68:69], v188 offset:8840
    v_mfma_f32_16x16x32_bf16 v[72:75], a[160:163], a[96:99], v[72:75]
    ds_read_b64_tr_b16 a[70:71], v188 offset:9880
    buffer_load_dwordx4 v194, s[16:19], s95 offen offset:1056 lds
    v_mfma_f32_16x16x32_bf16 v[72:75], a[164:167], a[100:103], v[72:75]
    ds_read_b64_tr_b16 a[76:77], v188 offset:9088
    v_mfma_f32_16x16x32_bf16 v[104:107], a[160:163], a[104:107], v[104:107]
    ds_read_b64_tr_b16 a[78:79], v188 offset:10128
    v_mfma_f32_16x16x32_bf16 v[104:107], a[164:167], a[108:111], v[104:107]
    ds_read_b64_tr_b16 a[84:85], v188 offset:9096
    v_mfma_f32_16x16x32_bf16 v[44:47], a[168:171], a[88:91], v[44:47]
    ds_read_b64_tr_b16 a[86:87], v188 offset:10136
    v_mfma_f32_16x16x32_bf16 v[44:47], a[172:175], a[92:95], v[44:47]
    buffer_load_dwordx4 v195, s[16:19], s95 offen offset:2112 lds
    v_mfma_f32_16x16x32_bf16 v[76:79], a[168:171], a[96:99], v[76:79]
    v_mfma_f32_16x16x32_bf16 v[76:79], a[172:175], a[100:103], v[76:79]
    v_mfma_f32_16x16x32_bf16 v[108:111], a[168:171], a[104:107], v[108:111]
    v_mfma_f32_16x16x32_bf16 v[108:111], a[172:175], a[108:111], v[108:111]
    s_waitcnt vmcnt(10) lgkmcnt(0)
    s_barrier
    v_mfma_f32_16x16x32_bf16 v[16:19], a[24:27], a[0:3], v[16:19]
    ds_read_b128 a[88:91], v186 offset:0
    s_add_u32 s95, s94, 7
    s_add_u32 m0, s92, 117760
    s_and_b32 s95, s95, 7
    s_lshl_b32 s96, s95, 19
    buffer_load_dwordx4 v196, s[20:23], s96 offen offset:0 lds
    s_lshl_b32 s95, s95, 7
    v_mfma_f32_16x16x32_bf16 v[16:19], a[28:31], a[4:7], v[16:19]
    ds_read_b128 a[96:99], v186 offset:2112
    v_mfma_f32_16x16x32_bf16 v[48:51], a[24:27], a[8:11], v[48:51]
    ds_read_b128 a[104:107], v186 offset:4224
    v_mfma_f32_16x16x32_bf16 v[48:51], a[28:31], a[12:15], v[48:51]
    ds_read_b64_tr_b16 a[112:113], v189 offset:0
    buffer_load_dwordx4 v197, s[20:23], s96 offen offset:1040 lds
    v_mfma_f32_16x16x32_bf16 v[80:83], a[24:27], a[16:19], v[80:83]
    ds_read_b64_tr_b16 a[114:115], v189 offset:1040
    v_mfma_f32_16x16x32_bf16 v[80:83], a[28:31], a[20:23], v[80:83]
    ds_read_b64_tr_b16 a[120:121], v189 offset:8
    v_mfma_f32_16x16x32_bf16 v[20:23], a[32:35], a[0:3], v[20:23]
    ds_read_b64_tr_b16 a[122:123], v189 offset:1048
    buffer_load_dwordx4 v198, s[20:23], s96 offen offset:2080 lds
    v_mfma_f32_16x16x32_bf16 v[20:23], a[36:39], a[4:7], v[20:23]
    v_mfma_f32_16x16x32_bf16 v[52:55], a[32:35], a[8:11], v[52:55]
    ds_read_b64_tr_b16 a[128:129], v189 offset:256
    v_mfma_f32_16x16x32_bf16 v[52:55], a[36:39], a[12:15], v[52:55]
    ds_read_b64_tr_b16 a[130:131], v189 offset:1296
    v_mfma_f32_16x16x32_bf16 v[84:87], a[32:35], a[16:19], v[84:87]
    ds_read_b64_tr_b16 a[136:137], v189 offset:264
    buffer_load_dwordx4 v199, s[20:23], s96 offen offset:3120 lds
    s_add_u32 m0, s91, 134400
    v_mfma_f32_16x16x32_bf16 v[84:87], a[36:39], a[20:23], v[84:87]
    ds_read_b64_tr_b16 a[138:139], v189 offset:1304
    v_mfma_f32_16x16x32_bf16 v[24:27], a[40:43], a[0:3], v[24:27]
    ds_read_b64_tr_b16 a[144:145], v189 offset:512
    v_mfma_f32_16x16x32_bf16 v[24:27], a[44:47], a[4:7], v[24:27]
    ds_read_b64_tr_b16 a[146:147], v189 offset:1552
    buffer_load_dwordx4 v190, s[16:19], s95 offen offset:0 lds
    v_mfma_f32_16x16x32_bf16 v[56:59], a[40:43], a[8:11], v[56:59]
    v_mfma_f32_16x16x32_bf16 v[56:59], a[44:47], a[12:15], v[56:59]
    ds_read_b64_tr_b16 a[152:153], v189 offset:520
    v_mfma_f32_16x16x32_bf16 v[88:91], a[40:43], a[16:19], v[88:91]
    ds_read_b64_tr_b16 a[154:155], v189 offset:1560
    v_mfma_f32_16x16x32_bf16 v[88:91], a[44:47], a[20:23], v[88:91]
    ds_read_b64_tr_b16 a[160:161], v189 offset:768
    buffer_load_dwordx4 v191, s[16:19], s95 offen offset:1056 lds
    v_mfma_f32_16x16x32_bf16 v[28:31], a[48:51], a[0:3], v[28:31]
    ds_read_b64_tr_b16 a[162:163], v189 offset:1808
    v_mfma_f32_16x16x32_bf16 v[28:31], a[52:55], a[4:7], v[28:31]
    ds_read_b64_tr_b16 a[168:169], v189 offset:776
    v_mfma_f32_16x16x32_bf16 v[60:63], a[48:51], a[8:11], v[60:63]
    ds_read_b64_tr_b16 a[170:171], v189 offset:1816
    buffer_load_dwordx4 v192, s[16:19], s95 offen offset:2112 lds
    s_add_u32 m0, m0, 3168
    v_mfma_f32_16x16x32_bf16 v[60:63], a[52:55], a[12:15], v[60:63]
    v_mfma_f32_16x16x32_bf16 v[92:95], a[48:51], a[16:19], v[92:95]
    ds_read_b128 a[92:95], v186 offset:512
    v_mfma_f32_16x16x32_bf16 v[92:95], a[52:55], a[20:23], v[92:95]
    ds_read_b128 a[100:103], v186 offset:2624
    v_mfma_f32_16x16x32_bf16 v[32:35], a[56:59], a[0:3], v[32:35]
    ds_read_b128 a[108:111], v186 offset:4736
    buffer_load_dwordx4 v193, s[16:19], s95 offen offset:0 lds
    v_mfma_f32_16x16x32_bf16 v[32:35], a[60:63], a[4:7], v[32:35]
    ds_read_b64_tr_b16 a[116:117], v189 offset:8320
    v_mfma_f32_16x16x32_bf16 v[64:67], a[56:59], a[8:11], v[64:67]
    ds_read_b64_tr_b16 a[118:119], v189 offset:9360
    v_mfma_f32_16x16x32_bf16 v[64:67], a[60:63], a[12:15], v[64:67]
    ds_read_b64_tr_b16 a[124:125], v189 offset:8328
    buffer_load_dwordx4 v194, s[16:19], s95 offen offset:1056 lds
    v_mfma_f32_16x16x32_bf16 v[96:99], a[56:59], a[16:19], v[96:99]
    ds_read_b64_tr_b16 a[126:127], v189 offset:9368
    v_mfma_f32_16x16x32_bf16 v[96:99], a[60:63], a[20:23], v[96:99]
    v_mfma_f32_16x16x32_bf16 v[36:39], a[64:67], a[0:3], v[36:39]
    ds_read_b64_tr_b16 a[132:133], v189 offset:8576
    buffer_load_dwordx4 v195, s[16:19], s95 offen offset:2112 lds
    v_mfma_f32_16x16x32_bf16 v[36:39], a[68:71], a[4:7], v[36:39]
    ds_read_b64_tr_b16 a[134:135], v189 offset:9616
    v_mfma_f32_16x16x32_bf16 v[68:71], a[64:67], a[8:11], v[68:71]
    ds_read_b64_tr_b16 a[140:141], v189 offset:8584
    v_mfma_f32_16x16x32_bf16 v[68:71], a[68:71], a[12:15], v[68:71]
    ds_read_b64_tr_b16 a[142:143], v189 offset:9624
    v_mfma_f32_16x16x32_bf16 v[100:103], a[64:67], a[16:19], v[100:103]
    ds_read_b64_tr_b16 a[148:149], v189 offset:8832
    s_add_u32 m0, s52, 0
    s_mov_b32 s49, 0
    buffer_load_dwordx4 v2, s[24:27], s49 offen offset:0 nt lds
    v_mfma_f32_16x16x32_bf16 v[100:103], a[68:71], a[20:23], v[100:103]
    ds_read_b64_tr_b16 a[150:151], v189 offset:9872
    v_mfma_f32_16x16x32_bf16 v[40:43], a[72:75], a[0:3], v[40:43]
    v_mfma_f32_16x16x32_bf16 v[40:43], a[76:79], a[4:7], v[40:43]
    ds_read_b64_tr_b16 a[156:157], v189 offset:8840
    s_add_u32 m0, s52, 32
    s_mov_b32 s49, 0
    buffer_load_dwordx4 v2, s[24:27], s49 offen offset:1024 nt lds
    v_mfma_f32_16x16x32_bf16 v[72:75], a[72:75], a[8:11], v[72:75]
    ds_read_b64_tr_b16 a[158:159], v189 offset:9880
    v_mfma_f32_16x16x32_bf16 v[72:75], a[76:79], a[12:15], v[72:75]
    ds_read_b64_tr_b16 a[164:165], v189 offset:9088
    v_mfma_f32_16x16x32_bf16 v[104:107], a[72:75], a[16:19], v[104:107]
    ds_read_b64_tr_b16 a[166:167], v189 offset:10128
    v_mfma_f32_16x16x32_bf16 v[104:107], a[76:79], a[20:23], v[104:107]
    ds_read_b64_tr_b16 a[172:173], v189 offset:9096
    s_add_u32 m0, s52, 64
    s_mov_b32 s49, 0
    buffer_load_dwordx4 v2, s[24:27], s49 offen offset:2048 nt lds
    v_mfma_f32_16x16x32_bf16 v[44:47], a[80:83], a[0:3], v[44:47]
    ds_read_b64_tr_b16 a[174:175], v189 offset:10136
    v_mfma_f32_16x16x32_bf16 v[44:47], a[84:87], a[4:7], v[44:47]
    v_mfma_f32_16x16x32_bf16 v[76:79], a[80:83], a[8:11], v[76:79]
    s_add_u32 m0, s52, 96
    s_mov_b32 s49, 0
    buffer_load_dwordx4 v2, s[24:27], s49 offen offset:3072 nt lds
    v_mfma_f32_16x16x32_bf16 v[76:79], a[84:87], a[12:15], v[76:79]
    v_mfma_f32_16x16x32_bf16 v[108:111], a[80:83], a[16:19], v[108:111]
    v_mfma_f32_16x16x32_bf16 v[108:111], a[84:87], a[20:23], v[108:111]
    s_waitcnt vmcnt(14) lgkmcnt(0)
    s_barrier
    v_mfma_f32_16x16x32_bf16 v[16:19], a[112:115], a[88:91], v[16:19]
    ds_read_b128 a[0:3], v184 offset:0
    s_add_u32 m0, s52, 16896
    s_mov_b32 s49, 0
    buffer_load_dwordx4 v2, s[28:31], s49 offen offset:0 nt lds
    v_mfma_f32_16x16x32_bf16 v[16:19], a[116:119], a[92:95], v[16:19]
    ds_read_b128 a[8:11], v184 offset:2112
    v_mfma_f32_16x16x32_bf16 v[48:51], a[112:115], a[96:99], v[48:51]
    ds_read_b128 a[16:19], v184 offset:4224
    v_mfma_f32_16x16x32_bf16 v[48:51], a[116:119], a[100:103], v[48:51]
    ds_read_b64_tr_b16 a[24:25], v187 offset:0
    v_mfma_f32_16x16x32_bf16 v[80:83], a[112:115], a[104:107], v[80:83]
    ds_read_b64_tr_b16 a[26:27], v187 offset:1040
    v_mfma_f32_16x16x32_bf16 v[80:83], a[116:119], a[108:111], v[80:83]
    ds_read_b64_tr_b16 a[32:33], v187 offset:8
    v_mfma_f32_16x16x32_bf16 v[20:23], a[120:123], a[88:91], v[20:23]
    ds_read_b64_tr_b16 a[34:35], v187 offset:1048
    s_add_u32 m0, s52, 16928
    s_mov_b32 s49, 0
    buffer_load_dwordx4 v2, s[28:31], s49 offen offset:1024 nt lds
    v_mfma_f32_16x16x32_bf16 v[20:23], a[124:127], a[92:95], v[20:23]
    v_mfma_f32_16x16x32_bf16 v[52:55], a[120:123], a[96:99], v[52:55]
    ds_read_b64_tr_b16 a[40:41], v187 offset:256
    v_mfma_f32_16x16x32_bf16 v[52:55], a[124:127], a[100:103], v[52:55]
    ds_read_b64_tr_b16 a[42:43], v187 offset:1296
    v_mfma_f32_16x16x32_bf16 v[84:87], a[120:123], a[104:107], v[84:87]
    ds_read_b64_tr_b16 a[48:49], v187 offset:264
    v_mfma_f32_16x16x32_bf16 v[84:87], a[124:127], a[108:111], v[84:87]
    ds_read_b64_tr_b16 a[50:51], v187 offset:1304
    v_mfma_f32_16x16x32_bf16 v[24:27], a[128:131], a[88:91], v[24:27]
    ds_read_b64_tr_b16 a[56:57], v187 offset:512
    s_add_u32 m0, s52, 16960
    s_mov_b32 s49, 0
    buffer_load_dwordx4 v2, s[28:31], s49 offen offset:2048 nt lds
    v_mfma_f32_16x16x32_bf16 v[24:27], a[132:135], a[92:95], v[24:27]
    ds_read_b64_tr_b16 a[58:59], v187 offset:1552
    v_mfma_f32_16x16x32_bf16 v[56:59], a[128:131], a[96:99], v[56:59]
    v_mfma_f32_16x16x32_bf16 v[56:59], a[132:135], a[100:103], v[56:59]
    ds_read_b64_tr_b16 a[64:65], v187 offset:520
    v_mfma_f32_16x16x32_bf16 v[88:91], a[128:131], a[104:107], v[88:91]
    ds_read_b64_tr_b16 a[66:67], v187 offset:1560
    v_mfma_f32_16x16x32_bf16 v[88:91], a[132:135], a[108:111], v[88:91]
    ds_read_b64_tr_b16 a[72:73], v187 offset:768
    v_mfma_f32_16x16x32_bf16 v[28:31], a[136:139], a[88:91], v[28:31]
    ds_read_b64_tr_b16 a[74:75], v187 offset:1808
    s_add_u32 m0, s52, 16992
    s_mov_b32 s49, 0
    buffer_load_dwordx4 v2, s[28:31], s49 offen offset:3072 nt lds
    v_mfma_f32_16x16x32_bf16 v[28:31], a[140:143], a[92:95], v[28:31]
    ds_read_b64_tr_b16 a[80:81], v187 offset:776
    v_mfma_f32_16x16x32_bf16 v[60:63], a[136:139], a[96:99], v[60:63]
    ds_read_b64_tr_b16 a[82:83], v187 offset:1816
    v_mfma_f32_16x16x32_bf16 v[60:63], a[140:143], a[100:103], v[60:63]
    v_mfma_f32_16x16x32_bf16 v[92:95], a[136:139], a[104:107], v[92:95]
    ds_read_b128 a[4:7], v184 offset:512
    v_mfma_f32_16x16x32_bf16 v[92:95], a[140:143], a[108:111], v[92:95]
    ds_read_b128 a[12:15], v184 offset:2624
    v_mfma_f32_16x16x32_bf16 v[32:35], a[144:147], a[88:91], v[32:35]
    ds_read_b128 a[20:23], v184 offset:4736
    s_add_u32 m0, s52, 33792
    s_mov_b32 s49, 16384
    buffer_load_dwordx4 v2, s[24:27], s49 offen offset:0 nt lds
    v_mfma_f32_16x16x32_bf16 v[32:35], a[148:151], a[92:95], v[32:35]
    ds_read_b64_tr_b16 a[28:29], v187 offset:8320
    v_mfma_f32_16x16x32_bf16 v[64:67], a[144:147], a[96:99], v[64:67]
    ds_read_b64_tr_b16 a[30:31], v187 offset:9360
    v_mfma_f32_16x16x32_bf16 v[64:67], a[148:151], a[100:103], v[64:67]
    ds_read_b64_tr_b16 a[36:37], v187 offset:8328
    v_mfma_f32_16x16x32_bf16 v[96:99], a[144:147], a[104:107], v[96:99]
    ds_read_b64_tr_b16 a[38:39], v187 offset:9368
    v_mfma_f32_16x16x32_bf16 v[96:99], a[148:151], a[108:111], v[96:99]
    v_mfma_f32_16x16x32_bf16 v[36:39], a[152:155], a[88:91], v[36:39]
    ds_read_b64_tr_b16 a[44:45], v187 offset:8576
    s_add_u32 m0, s52, 33824
    s_mov_b32 s49, 16384
    buffer_load_dwordx4 v2, s[24:27], s49 offen offset:1024 nt lds
    v_mfma_f32_16x16x32_bf16 v[36:39], a[156:159], a[92:95], v[36:39]
    ds_read_b64_tr_b16 a[46:47], v187 offset:9616
    v_mfma_f32_16x16x32_bf16 v[68:71], a[152:155], a[96:99], v[68:71]
    ds_read_b64_tr_b16 a[52:53], v187 offset:8584
    v_mfma_f32_16x16x32_bf16 v[68:71], a[156:159], a[100:103], v[68:71]
    ds_read_b64_tr_b16 a[54:55], v187 offset:9624
    v_mfma_f32_16x16x32_bf16 v[100:103], a[152:155], a[104:107], v[100:103]
    ds_read_b64_tr_b16 a[60:61], v187 offset:8832
    v_mfma_f32_16x16x32_bf16 v[100:103], a[156:159], a[108:111], v[100:103]
    ds_read_b64_tr_b16 a[62:63], v187 offset:9872
    v_mfma_f32_16x16x32_bf16 v[40:43], a[160:163], a[88:91], v[40:43]
    s_add_u32 m0, s52, 33856
    s_mov_b32 s49, 16384
    buffer_load_dwordx4 v2, s[24:27], s49 offen offset:2048 nt lds
    v_mfma_f32_16x16x32_bf16 v[40:43], a[164:167], a[92:95], v[40:43]
    ds_read_b64_tr_b16 a[68:69], v187 offset:8840
    v_mfma_f32_16x16x32_bf16 v[72:75], a[160:163], a[96:99], v[72:75]
    ds_read_b64_tr_b16 a[70:71], v187 offset:9880
    v_mfma_f32_16x16x32_bf16 v[72:75], a[164:167], a[100:103], v[72:75]
    ds_read_b64_tr_b16 a[76:77], v187 offset:9088
    v_mfma_f32_16x16x32_bf16 v[104:107], a[160:163], a[104:107], v[104:107]
    ds_read_b64_tr_b16 a[78:79], v187 offset:10128
    v_mfma_f32_16x16x32_bf16 v[104:107], a[164:167], a[108:111], v[104:107]
    ds_read_b64_tr_b16 a[84:85], v187 offset:9096
    v_mfma_f32_16x16x32_bf16 v[44:47], a[168:171], a[88:91], v[44:47]
    ds_read_b64_tr_b16 a[86:87], v187 offset:10136
    s_add_u32 m0, s52, 33888
    s_mov_b32 s49, 16384
    buffer_load_dwordx4 v2, s[24:27], s49 offen offset:3072 nt lds
    v_mfma_f32_16x16x32_bf16 v[44:47], a[172:175], a[92:95], v[44:47]
    v_mfma_f32_16x16x32_bf16 v[76:79], a[168:171], a[96:99], v[76:79]
    v_mfma_f32_16x16x32_bf16 v[76:79], a[172:175], a[100:103], v[76:79]
    v_mfma_f32_16x16x32_bf16 v[108:111], a[168:171], a[104:107], v[108:111]
    v_mfma_f32_16x16x32_bf16 v[108:111], a[172:175], a[108:111], v[108:111]
    s_waitcnt vmcnt(12) lgkmcnt(0)
    s_barrier
    v_mfma_f32_16x16x32_bf16 v[16:19], a[24:27], a[0:3], v[16:19]
    ds_read_b128 a[88:91], v185 offset:0
    s_add_u32 m0, s52, 50688
    s_mov_b32 s49, 16384
    buffer_load_dwordx4 v2, s[28:31], s49 offen offset:0 nt lds
    v_mfma_f32_16x16x32_bf16 v[16:19], a[28:31], a[4:7], v[16:19]
    ds_read_b128 a[96:99], v185 offset:2112
    v_mfma_f32_16x16x32_bf16 v[48:51], a[24:27], a[8:11], v[48:51]
    ds_read_b128 a[104:107], v185 offset:4224
    v_mfma_f32_16x16x32_bf16 v[48:51], a[28:31], a[12:15], v[48:51]
    ds_read_b64_tr_b16 a[112:113], v188 offset:0
    v_mfma_f32_16x16x32_bf16 v[80:83], a[24:27], a[16:19], v[80:83]
    ds_read_b64_tr_b16 a[114:115], v188 offset:1040
    v_mfma_f32_16x16x32_bf16 v[80:83], a[28:31], a[20:23], v[80:83]
    ds_read_b64_tr_b16 a[120:121], v188 offset:8
    v_mfma_f32_16x16x32_bf16 v[20:23], a[32:35], a[0:3], v[20:23]
    ds_read_b64_tr_b16 a[122:123], v188 offset:1048
    v_mfma_f32_16x16x32_bf16 v[20:23], a[36:39], a[4:7], v[20:23]
    v_mfma_f32_16x16x32_bf16 v[52:55], a[32:35], a[8:11], v[52:55]
    ds_read_b64_tr_b16 a[128:129], v188 offset:256
    v_mfma_f32_16x16x32_bf16 v[52:55], a[36:39], a[12:15], v[52:55]
    ds_read_b64_tr_b16 a[130:131], v188 offset:1296
    v_mfma_f32_16x16x32_bf16 v[84:87], a[32:35], a[16:19], v[84:87]
    ds_read_b64_tr_b16 a[136:137], v188 offset:264
    v_mfma_f32_16x16x32_bf16 v[84:87], a[36:39], a[20:23], v[84:87]
    ds_read_b64_tr_b16 a[138:139], v188 offset:1304
    v_mfma_f32_16x16x32_bf16 v[24:27], a[40:43], a[0:3], v[24:27]
    ds_read_b64_tr_b16 a[144:145], v188 offset:512
    s_add_u32 m0, s52, 50720
    s_mov_b32 s49, 16384
    buffer_load_dwordx4 v2, s[28:31], s49 offen offset:1024 nt lds
    v_mfma_f32_16x16x32_bf16 v[24:27], a[44:47], a[4:7], v[24:27]
    ds_read_b64_tr_b16 a[146:147], v188 offset:1552
    v_mfma_f32_16x16x32_bf16 v[56:59], a[40:43], a[8:11], v[56:59]
    v_mfma_f32_16x16x32_bf16 v[56:59], a[44:47], a[12:15], v[56:59]
    ds_read_b64_tr_b16 a[152:153], v188 offset:520
    v_mfma_f32_16x16x32_bf16 v[88:91], a[40:43], a[16:19], v[88:91]
    ds_read_b64_tr_b16 a[154:155], v188 offset:1560
    v_mfma_f32_16x16x32_bf16 v[88:91], a[44:47], a[20:23], v[88:91]
    ds_read_b64_tr_b16 a[160:161], v188 offset:768
    v_mfma_f32_16x16x32_bf16 v[28:31], a[48:51], a[0:3], v[28:31]
    ds_read_b64_tr_b16 a[162:163], v188 offset:1808
    v_mfma_f32_16x16x32_bf16 v[28:31], a[52:55], a[4:7], v[28:31]
    ds_read_b64_tr_b16 a[168:169], v188 offset:776
    v_mfma_f32_16x16x32_bf16 v[60:63], a[48:51], a[8:11], v[60:63]
    ds_read_b64_tr_b16 a[170:171], v188 offset:1816
    v_mfma_f32_16x16x32_bf16 v[60:63], a[52:55], a[12:15], v[60:63]
    v_mfma_f32_16x16x32_bf16 v[92:95], a[48:51], a[16:19], v[92:95]
    ds_read_b128 a[92:95], v185 offset:512
    v_mfma_f32_16x16x32_bf16 v[92:95], a[52:55], a[20:23], v[92:95]
    ds_read_b128 a[100:103], v185 offset:2624
    v_mfma_f32_16x16x32_bf16 v[32:35], a[56:59], a[0:3], v[32:35]
    ds_read_b128 a[108:111], v185 offset:4736
    s_add_u32 m0, s52, 50752
    s_mov_b32 s49, 16384
    buffer_load_dwordx4 v2, s[28:31], s49 offen offset:2048 nt lds
    v_mfma_f32_16x16x32_bf16 v[32:35], a[60:63], a[4:7], v[32:35]
    ds_read_b64_tr_b16 a[116:117], v188 offset:8320
    v_mfma_f32_16x16x32_bf16 v[64:67], a[56:59], a[8:11], v[64:67]
    ds_read_b64_tr_b16 a[118:119], v188 offset:9360
    v_mfma_f32_16x16x32_bf16 v[64:67], a[60:63], a[12:15], v[64:67]
    ds_read_b64_tr_b16 a[124:125], v188 offset:8328
    v_mfma_f32_16x16x32_bf16 v[96:99], a[56:59], a[16:19], v[96:99]
    ds_read_b64_tr_b16 a[126:127], v188 offset:9368
    v_mfma_f32_16x16x32_bf16 v[96:99], a[60:63], a[20:23], v[96:99]
    v_mfma_f32_16x16x32_bf16 v[36:39], a[64:67], a[0:3], v[36:39]
    ds_read_b64_tr_b16 a[132:133], v188 offset:8576
    v_mfma_f32_16x16x32_bf16 v[36:39], a[68:71], a[4:7], v[36:39]
    ds_read_b64_tr_b16 a[134:135], v188 offset:9616
    v_mfma_f32_16x16x32_bf16 v[68:71], a[64:67], a[8:11], v[68:71]
    ds_read_b64_tr_b16 a[140:141], v188 offset:8584
    v_mfma_f32_16x16x32_bf16 v[68:71], a[68:71], a[12:15], v[68:71]
    ds_read_b64_tr_b16 a[142:143], v188 offset:9624
    v_mfma_f32_16x16x32_bf16 v[100:103], a[64:67], a[16:19], v[100:103]
    ds_read_b64_tr_b16 a[148:149], v188 offset:8832
    v_mfma_f32_16x16x32_bf16 v[100:103], a[68:71], a[20:23], v[100:103]
    ds_read_b64_tr_b16 a[150:151], v188 offset:9872
    v_mfma_f32_16x16x32_bf16 v[40:43], a[72:75], a[0:3], v[40:43]
    s_add_u32 m0, s52, 50784
    s_mov_b32 s49, 16384
    buffer_load_dwordx4 v2, s[28:31], s49 offen offset:3072 nt lds
    v_mfma_f32_16x16x32_bf16 v[40:43], a[76:79], a[4:7], v[40:43]
    ds_read_b64_tr_b16 a[156:157], v188 offset:8840
    v_mfma_f32_16x16x32_bf16 v[72:75], a[72:75], a[8:11], v[72:75]
    ds_read_b64_tr_b16 a[158:159], v188 offset:9880
    v_mfma_f32_16x16x32_bf16 v[72:75], a[76:79], a[12:15], v[72:75]
    ds_read_b64_tr_b16 a[164:165], v188 offset:9088
    v_mfma_f32_16x16x32_bf16 v[104:107], a[72:75], a[16:19], v[104:107]
    ds_read_b64_tr_b16 a[166:167], v188 offset:10128
    v_mfma_f32_16x16x32_bf16 v[104:107], a[76:79], a[20:23], v[104:107]
    ds_read_b64_tr_b16 a[172:173], v188 offset:9096
    v_mfma_f32_16x16x32_bf16 v[44:47], a[80:83], a[0:3], v[44:47]
    ds_read_b64_tr_b16 a[174:175], v188 offset:10136
    v_mfma_f32_16x16x32_bf16 v[44:47], a[84:87], a[4:7], v[44:47]
    v_mfma_f32_16x16x32_bf16 v[76:79], a[80:83], a[8:11], v[76:79]
    v_mfma_f32_16x16x32_bf16 v[76:79], a[84:87], a[12:15], v[76:79]
    v_mfma_f32_16x16x32_bf16 v[108:111], a[80:83], a[16:19], v[108:111]
    v_mfma_f32_16x16x32_bf16 v[108:111], a[84:87], a[20:23], v[108:111]
    s_waitcnt vmcnt(12) lgkmcnt(0)
    s_barrier
    v_mfma_f32_16x16x32_bf16 v[16:19], a[112:115], a[88:91], v[16:19]
    s_add_u32 m0, s52, 67584
    s_mov_b32 s49, 32768
    buffer_load_dwordx4 v2, s[24:27], s49 offen offset:0 nt lds
    ds_read_b128 a[176:179], v5 offset:0
    v_mfma_f32_16x16x32_bf16 v[16:19], a[116:119], a[92:95], v[16:19]
    ds_read_b128 a[180:183], v5 offset:256
    v_mfma_f32_16x16x32_bf16 v[20:23], a[120:123], a[88:91], v[20:23]
    ds_read_b128 a[184:187], v5 offset:512
    v_mfma_f32_16x16x32_bf16 v[20:23], a[124:127], a[92:95], v[20:23]
    ds_read_b128 a[188:191], v5 offset:768
    v_mfma_f32_16x16x32_bf16 v[24:27], a[128:131], a[88:91], v[24:27]
    v_mfma_f32_16x16x32_bf16 v[24:27], a[132:135], a[92:95], v[24:27]
    ds_read_b128 a[192:195], v5 offset:4224
    v_mul_f32 v16, s57, v16
    v_mul_f32 v17, s57, v17
    v_mul_f32 v18, s57, v18
    v_mfma_f32_16x16x32_bf16 v[28:31], a[136:139], a[88:91], v[28:31]
    ds_read_b128 a[196:199], v5 offset:4480
    v_mul_f32 v19, s57, v19
    v_cvt_pk_bf16_f32 v112, v16, v17
    v_cvt_pk_bf16_f32 v113, v18, v19
    v_mfma_f32_16x16x32_bf16 v[28:31], a[140:143], a[92:95], v[28:31]
    ds_read_b128 a[200:203], v5 offset:4736
    v_mul_f32 v20, s57, v20
    v_mul_f32 v21, s57, v21
    v_mul_f32 v22, s57, v22
    v_mfma_f32_16x16x32_bf16 v[32:35], a[144:147], a[88:91], v[32:35]
    ds_read_b128 a[204:207], v5 offset:4992
    v_mul_f32 v23, s57, v23
    v_cvt_pk_bf16_f32 v114, v20, v21
    v_cvt_pk_bf16_f32 v115, v22, v23
    v_mfma_f32_16x16x32_bf16 v[32:35], a[148:151], a[92:95], v[32:35]
    v_mul_f32 v24, s57, v24
    v_mul_f32 v25, s57, v25
    v_mul_f32 v26, s57, v26
    v_mfma_f32_16x16x32_bf16 v[36:39], a[152:155], a[88:91], v[36:39]
    ds_read_b128 a[208:211], v5 offset:8448
    v_mul_f32 v27, s57, v27
    v_cvt_pk_bf16_f32 v116, v24, v25
    v_cvt_pk_bf16_f32 v117, v26, v27
    v_mfma_f32_16x16x32_bf16 v[36:39], a[156:159], a[92:95], v[36:39]
    ds_read_b128 a[212:215], v5 offset:8704
    v_mul_f32 v28, s57, v28
    v_mul_f32 v29, s57, v29
    v_mul_f32 v30, s57, v30
    v_mfma_f32_16x16x32_bf16 v[40:43], a[160:163], a[88:91], v[40:43]
    s_add_u32 m0, s52, 67616
    s_mov_b32 s49, 32768
    buffer_load_dwordx4 v2, s[24:27], s49 offen offset:1024 nt lds
    ds_read_b128 a[216:219], v5 offset:8960
    v_mul_f32 v31, s57, v31
    v_cvt_pk_bf16_f32 v118, v28, v29
    v_cvt_pk_bf16_f32 v119, v30, v31
    v_mfma_f32_16x16x32_bf16 v[40:43], a[164:167], a[92:95], v[40:43]
    ds_read_b128 a[220:223], v5 offset:9216
    v_mul_f32 v32, s57, v32
    v_mul_f32 v33, s57, v33
    v_mul_f32 v34, s57, v34
    v_mfma_f32_16x16x32_bf16 v[44:47], a[168:171], a[88:91], v[44:47]
    v_mul_f32 v35, s57, v35
    v_cvt_pk_bf16_f32 v120, v32, v33
    v_cvt_pk_bf16_f32 v121, v34, v35
    v_mfma_f32_16x16x32_bf16 v[44:47], a[172:175], a[92:95], v[44:47]
    ds_read_b128 a[224:227], v5 offset:12672
    v_mul_f32 v36, s57, v36
    v_mul_f32 v37, s57, v37
    v_mul_f32 v38, s57, v38
    v_mfma_f32_16x16x32_bf16 v[48:51], a[112:115], a[96:99], v[48:51]
    ds_read_b128 a[228:231], v5 offset:12928
    v_mul_f32 v39, s57, v39
    v_cvt_pk_bf16_f32 v122, v36, v37
    v_cvt_pk_bf16_f32 v123, v38, v39
    v_mfma_f32_16x16x32_bf16 v[48:51], a[116:119], a[100:103], v[48:51]
    ds_read_b128 a[232:235], v5 offset:13184
    v_mul_f32 v40, s57, v40
    v_mul_f32 v41, s57, v41
    v_mul_f32 v42, s57, v42
    v_mfma_f32_16x16x32_bf16 v[52:55], a[120:123], a[96:99], v[52:55]
    ds_read_b128 a[236:239], v5 offset:13440
    v_mul_f32 v43, s57, v43
    v_cvt_pk_bf16_f32 v124, v40, v41
    v_cvt_pk_bf16_f32 v125, v42, v43
    v_mfma_f32_16x16x32_bf16 v[52:55], a[124:127], a[100:103], v[52:55]
    v_mul_f32 v44, s57, v44
    v_mul_f32 v45, s57, v45
    v_mul_f32 v46, s57, v46
    v_mfma_f32_16x16x32_bf16 v[56:59], a[128:131], a[96:99], v[56:59]
    v_mul_f32 v47, s57, v47
    v_cvt_pk_bf16_f32 v126, v44, v45
    v_cvt_pk_bf16_f32 v127, v46, v47
    v_mfma_f32_16x16x32_bf16 v[56:59], a[132:135], a[100:103], v[56:59]
    v_mul_f32 v48, s57, v48
    v_mul_f32 v49, s57, v49
    v_mul_f32 v50, s57, v50
    v_mfma_f32_16x16x32_bf16 v[60:63], a[136:139], a[96:99], v[60:63]
    v_mul_f32 v51, s57, v51
    v_cvt_pk_bf16_f32 v128, v48, v49
    v_cvt_pk_bf16_f32 v129, v50, v51
    v_mfma_f32_16x16x32_bf16 v[60:63], a[140:143], a[100:103], v[60:63]
    v_mul_f32 v52, s57, v52
    v_mul_f32 v53, s57, v53
    v_mul_f32 v54, s57, v54
    v_mfma_f32_16x16x32_bf16 v[64:67], a[144:147], a[96:99], v[64:67]
    s_add_u32 m0, s52, 67648
    s_mov_b32 s49, 32768
    buffer_load_dwordx4 v2, s[24:27], s49 offen offset:2048 nt lds
    v_mul_f32 v55, s57, v55
    v_cvt_pk_bf16_f32 v130, v52, v53
    v_cvt_pk_bf16_f32 v131, v54, v55
    v_mfma_f32_16x16x32_bf16 v[64:67], a[148:151], a[100:103], v[64:67]
    v_mul_f32 v56, s57, v56
    v_mul_f32 v57, s57, v57
    v_mul_f32 v58, s57, v58
    v_mfma_f32_16x16x32_bf16 v[68:71], a[152:155], a[96:99], v[68:71]
    v_mul_f32 v59, s57, v59
    v_cvt_pk_bf16_f32 v132, v56, v57
    v_cvt_pk_bf16_f32 v133, v58, v59
    v_mfma_f32_16x16x32_bf16 v[68:71], a[156:159], a[100:103], v[68:71]
    v_mul_f32 v60, s57, v60
    v_mul_f32 v61, s57, v61
    v_mul_f32 v62, s57, v62
    v_mfma_f32_16x16x32_bf16 v[72:75], a[160:163], a[96:99], v[72:75]
    v_mul_f32 v63, s57, v63
    v_cvt_pk_bf16_f32 v134, v60, v61
    v_cvt_pk_bf16_f32 v135, v62, v63
    v_mfma_f32_16x16x32_bf16 v[72:75], a[164:167], a[100:103], v[72:75]
    v_mul_f32 v64, s57, v64
    v_mul_f32 v65, s57, v65
    v_mul_f32 v66, s57, v66
    v_mfma_f32_16x16x32_bf16 v[76:79], a[168:171], a[96:99], v[76:79]
    v_mul_f32 v67, s57, v67
    v_cvt_pk_bf16_f32 v136, v64, v65
    v_cvt_pk_bf16_f32 v137, v66, v67
    v_mfma_f32_16x16x32_bf16 v[76:79], a[172:175], a[100:103], v[76:79]
    v_mul_f32 v68, s57, v68
    v_mul_f32 v69, s57, v69
    v_mul_f32 v70, s57, v70
    v_mfma_f32_16x16x32_bf16 v[80:83], a[112:115], a[104:107], v[80:83]
    v_mul_f32 v71, s57, v71
    v_cvt_pk_bf16_f32 v138, v68, v69
    v_cvt_pk_bf16_f32 v139, v70, v71
    v_mfma_f32_16x16x32_bf16 v[80:83], a[116:119], a[108:111], v[80:83]
    v_mul_f32 v72, s57, v72
    v_mul_f32 v73, s57, v73
    v_mul_f32 v74, s57, v74
    v_mfma_f32_16x16x32_bf16 v[84:87], a[120:123], a[104:107], v[84:87]
    v_mul_f32 v75, s57, v75
    v_cvt_pk_bf16_f32 v140, v72, v73
    v_cvt_pk_bf16_f32 v141, v74, v75
    v_mfma_f32_16x16x32_bf16 v[84:87], a[124:127], a[108:111], v[84:87]
    v_mul_f32 v76, s57, v76
    v_mul_f32 v77, s57, v77
    v_mul_f32 v78, s57, v78
    v_mfma_f32_16x16x32_bf16 v[88:91], a[128:131], a[104:107], v[88:91]
    s_add_u32 m0, s52, 67680
    s_mov_b32 s49, 32768
    buffer_load_dwordx4 v2, s[24:27], s49 offen offset:3072 nt lds
    v_mul_f32 v79, s57, v79
    v_cvt_pk_bf16_f32 v142, v76, v77
    v_cvt_pk_bf16_f32 v143, v78, v79
    v_mfma_f32_16x16x32_bf16 v[88:91], a[132:135], a[108:111], v[88:91]
    v_mul_f32 v80, s57, v80
    v_mul_f32 v81, s57, v81
    v_mul_f32 v82, s57, v82
    v_mfma_f32_16x16x32_bf16 v[92:95], a[136:139], a[104:107], v[92:95]
    v_mul_f32 v83, s57, v83
    v_cvt_pk_bf16_f32 v144, v80, v81
    v_cvt_pk_bf16_f32 v145, v82, v83
    v_mfma_f32_16x16x32_bf16 v[92:95], a[140:143], a[108:111], v[92:95]
    v_mul_f32 v84, s57, v84
    v_mul_f32 v85, s57, v85
    v_mul_f32 v86, s57, v86
    v_mfma_f32_16x16x32_bf16 v[96:99], a[144:147], a[104:107], v[96:99]
    v_mul_f32 v87, s57, v87
    v_cvt_pk_bf16_f32 v146, v84, v85
    v_cvt_pk_bf16_f32 v147, v86, v87
    v_mfma_f32_16x16x32_bf16 v[96:99], a[148:151], a[108:111], v[96:99]
    v_mul_f32 v88, s57, v88
    v_mul_f32 v89, s57, v89
    v_mul_f32 v90, s57, v90
    v_mfma_f32_16x16x32_bf16 v[100:103], a[152:155], a[104:107], v[100:103]
    v_mul_f32 v91, s57, v91
    v_cvt_pk_bf16_f32 v148, v88, v89
    v_cvt_pk_bf16_f32 v149, v90, v91
    v_mfma_f32_16x16x32_bf16 v[100:103], a[156:159], a[108:111], v[100:103]
    v_mul_f32 v92, s57, v92
    v_mul_f32 v93, s57, v93
    v_mul_f32 v94, s57, v94
    v_mfma_f32_16x16x32_bf16 v[104:107], a[160:163], a[104:107], v[104:107]
    v_mul_f32 v95, s57, v95
    v_cvt_pk_bf16_f32 v150, v92, v93
    v_cvt_pk_bf16_f32 v151, v94, v95
    v_mfma_f32_16x16x32_bf16 v[104:107], a[164:167], a[108:111], v[104:107]
    v_mul_f32 v96, s57, v96
    v_mul_f32 v97, s57, v97
    v_mul_f32 v98, s57, v98
    v_mfma_f32_16x16x32_bf16 v[108:111], a[168:171], a[104:107], v[108:111]
    v_mul_f32 v99, s57, v99
    v_cvt_pk_bf16_f32 v152, v96, v97
    v_cvt_pk_bf16_f32 v153, v98, v99
    v_mfma_f32_16x16x32_bf16 v[108:111], a[172:175], a[108:111], v[108:111]
    v_mul_f32 v100, s57, v100
    v_mul_f32 v101, s57, v101
    v_mul_f32 v102, s57, v102
    s_waitcnt lgkmcnt(0)
    v_mfma_f32_16x16x32_bf16 v[160:163], a[176:179], v[112:115], 0
    v_mul_f32 v103, s57, v103
    v_cvt_pk_bf16_f32 v154, v100, v101
    v_cvt_pk_bf16_f32 v155, v102, v103
    v_mfma_f32_16x16x32_bf16 v[160:163], a[180:183], v[116:119], v[160:163]
    v_mul_f32 v104, s57, v104
    v_mul_f32 v105, s57, v105
    v_mfma_f32_16x16x32_bf16 v[160:163], a[184:187], v[120:123], v[160:163]
    v_mul_f32 v106, s57, v106
    v_mul_f32 v107, s57, v107
    v_cvt_pk_bf16_f32 v156, v104, v105
    v_mfma_f32_16x16x32_bf16 v[160:163], a[188:191], v[124:127], v[160:163]
    v_cvt_pk_bf16_f32 v157, v106, v107
    v_mul_f32 v108, s57, v108
    v_mfma_f32_16x16x32_bf16 v[164:167], a[192:195], v[112:115], 0
    v_mul_f32 v109, s57, v109
    v_mul_f32 v110, s57, v110
    v_mul_f32 v111, s57, v111
    v_mfma_f32_16x16x32_bf16 v[164:167], a[196:199], v[116:119], v[164:167]
    v_cvt_pk_bf16_f32 v158, v108, v109
    v_cvt_pk_bf16_f32 v159, v110, v111
    v_mfma_f32_16x16x32_bf16 v[164:167], a[200:203], v[120:123], v[164:167]
    v_mfma_f32_16x16x32_bf16 v[164:167], a[204:207], v[124:127], v[164:167]
    v_mfma_f32_16x16x32_bf16 v[168:171], a[208:211], v[112:115], 0
    v_mfma_f32_16x16x32_bf16 v[168:171], a[212:215], v[116:119], v[168:171]
    v_mfma_f32_16x16x32_bf16 v[168:171], a[216:219], v[120:123], v[168:171]
    v_mfma_f32_16x16x32_bf16 v[168:171], a[220:223], v[124:127], v[168:171]
    v_mfma_f32_16x16x32_bf16 v[172:175], a[224:227], v[112:115], 0
    v_mfma_f32_16x16x32_bf16 v[172:175], a[228:231], v[116:119], v[172:175]
    v_mfma_f32_16x16x32_bf16 v[172:175], a[232:235], v[120:123], v[172:175]
    v_mfma_f32_16x16x32_bf16 v[172:175], a[236:239], v[124:127], v[172:175]
    v_mfma_f32_16x16x32_bf16 v[176:179], a[176:179], v[128:131], 0
    v_mfma_f32_16x16x32_bf16 v[176:179], a[180:183], v[132:135], v[176:179]
    v_mfma_f32_16x16x32_bf16 v[176:179], a[184:187], v[136:139], v[176:179]
    v_mfma_f32_16x16x32_bf16 v[176:179], a[188:191], v[140:143], v[176:179]
    v_mfma_f32_16x16x32_bf16 v[180:183], a[192:195], v[128:131], 0
    v_max3_f32 v248, v160, v161, v162
    v_max3_f32 v249, v163, v164, v165
    v_max3_f32 v248, v248, v166, v167
    v_max3_f32 v249, v249, v168, v169
    v_mfma_f32_16x16x32_bf16 v[180:183], a[196:199], v[132:135], v[180:183]
    v_max3_f32 v248, v248, v170, v171
    v_max3_f32 v249, v249, v172, v173
    v_max3_f32 v248, v248, v174, v175
    v_max_f32 v248, v248, v249
    v_mfma_f32_16x16x32_bf16 v[180:183], a[200:203], v[136:139], v[180:183]
    v_mov_b32 v250, v248
    s_nop 1
    v_permlane32_swap_b32 v250, v248
    v_mfma_f32_16x16x32_bf16 v[180:183], a[204:207], v[140:143], v[180:183]
    s_nop 1
    v_max_f32 v248, v248, v250
    v_mov_b32 v250, v248
    s_nop 1
    v_mfma_f32_16x16x32_bf16 v[184:187], a[208:211], v[128:131], 0
    v_permlane16_swap_b32 v250, v248
    s_nop 1
    v_max_f32 v248, v248, v250
    v_sub_f32 v232, 0xc1000000, v248
    v_mfma_f32_16x16x32_bf16 v[184:187], a[212:215], v[132:135], v[184:187]
    v_sub_f32 v233, 0xc1000000, v248
    v_sub_f32 v234, 0xc1000000, v248
    v_sub_f32 v235, 0xc1000000, v248
    v_mfma_f32_16x16x32_bf16 v[184:187], a[216:219], v[136:139], v[184:187]
    v_add_f32 v160, v160, v232
    v_add_f32 v161, v161, v232
    v_exp_f32 v160, v160
    v_add_f32 v162, v162, v232
    v_mfma_f32_16x16x32_bf16 v[184:187], a[220:223], v[140:143], v[184:187]
    v_exp_f32 v161, v161
    v_add_f32 v163, v163, v232
    v_exp_f32 v162, v162
    v_cvt_pk_bf16_f32 v208, v160, v161
    v_mfma_f32_16x16x32_bf16 v[188:191], a[224:227], v[128:131], 0
    v_add_f32 v164, v164, v232
    v_exp_f32 v163, v163
    v_add_f32 v165, v165, v232
    v_mfma_f32_16x16x32_bf16 v[188:191], a[228:231], v[132:135], v[188:191]
    v_exp_f32 v164, v164
    v_cvt_pk_bf16_f32 v209, v162, v163
    v_add_f32 v166, v166, v232
    v_exp_f32 v165, v165
    v_mfma_f32_16x16x32_bf16 v[188:191], a[232:235], v[136:139], v[188:191]
    v_add_f32 v167, v167, v232
    v_exp_f32 v166, v166
    v_cvt_pk_bf16_f32 v210, v164, v165
    v_add_f32 v168, v168, v232
    v_mfma_f32_16x16x32_bf16 v[188:191], a[236:239], v[140:143], v[188:191]
    v_exp_f32 v167, v167
    v_add_f32 v169, v169, v232
    v_exp_f32 v168, v168
    s_waitcnt vmcnt(8)
    s_barrier
    v_cvt_pk_bf16_f32 v211, v166, v167
    v_add_f32 v170, v170, v232
    v_exp_f32 v169, v169
    v_add_f32 v171, v171, v232
    v_exp_f32 v170, v170
    v_cvt_pk_bf16_f32 v212, v168, v169
    v_add_f32 v172, v172, v232
    v_exp_f32 v171, v171
    v_add_f32 v173, v173, v232
    v_exp_f32 v172, v172
    v_cvt_pk_bf16_f32 v213, v170, v171
    v_add_f32 v174, v174, v232
    v_exp_f32 v173, v173
    v_add_f32 v175, v175, v232
    v_exp_f32 v174, v174
    v_cvt_pk_bf16_f32 v214, v172, v173
    v_exp_f32 v175, v175
    s_nop 0
    v_cvt_pk_bf16_f32 v215, v174, v175
    v_mfma_f32_16x16x32_bf16 v[192:195], a[176:179], v[144:147], 0
    ds_read_b64_tr_b16 a[80:81], v7 offset:0
    ds_read_b64_tr_b16 a[82:83], v7 offset:4224
    v_mfma_f32_16x16x32_bf16 v[192:195], a[180:183], v[148:151], v[192:195]
    ds_read_b64_tr_b16 a[84:85], v7 offset:8448
    ds_read_b64_tr_b16 a[86:87], v7 offset:12672
    v_mfma_f32_16x16x32_bf16 v[192:195], a[184:187], v[152:155], v[192:195]
    s_add_u32 m0, s52, 84480
    s_mov_b32 s49, 32768
    v_max3_f32 v248, v176, v177, v178
    v_max3_f32 v249, v179, v180, v181
    v_mfma_f32_16x16x32_bf16 v[192:195], a[188:191], v[156:159], v[192:195]
    ds_read_b64_tr_b16 a[88:89], v7 offset:32
    buffer_load_dwordx4 v2, s[28:31], s49 offen offset:0 nt lds
    v_max3_f32 v248, v248, v182, v183
    v_max3_f32 v249, v249, v184, v185
    v_mfma_f32_16x16x32_bf16 v[196:199], a[192:195], v[144:147], 0
    ds_read_b64_tr_b16 a[90:91], v7 offset:4256
    ds_read_b64_tr_b16 a[92:93], v7 offset:8480
    v_max3_f32 v248, v248, v186, v187
    v_max3_f32 v249, v249, v188, v189
    v_mfma_f32_16x16x32_bf16 v[196:199], a[196:199], v[148:151], v[196:199]
    ds_read_b64_tr_b16 a[94:95], v7 offset:12704
    ds_read_b64_tr_b16 a[96:97], v7 offset:256
    v_max3_f32 v248, v248, v190, v191
    v_max_f32 v248, v248, v249
    v_mfma_f32_16x16x32_bf16 v[196:199], a[200:203], v[152:155], v[196:199]
    ds_read_b64_tr_b16 a[98:99], v7 offset:4480
    ds_read_b64_tr_b16 a[100:101], v7 offset:8704
    v_mov_b32 v250, v248
    s_nop 1
    v_mfma_f32_16x16x32_bf16 v[196:199], a[204:207], v[156:159], v[196:199]
    ds_read_b64_tr_b16 a[102:103], v7 offset:12928
    ds_read_b64_tr_b16 a[104:105], v7 offset:288
    v_permlane32_swap_b32 v250, v248
    s_nop 1
    v_mfma_f32_16x16x32_bf16 v[200:203], a[208:211], v[144:147], 0
    ds_read_b64_tr_b16 a[106:107], v7 offset:4512
    ds_read_b64_tr_b16 a[108:109], v7 offset:8736
    v_max_f32 v248, v248, v250
    v_mov_b32 v250, v248
    v_mfma_f32_16x16x32_bf16 v[200:203], a[212:215], v[148:151], v[200:203]
    ds_read_b64_tr_b16 a[110:111], v7 offset:12960
    ds_read_b64_tr_b16 a[144:145], v7 offset:512
    s_nop 1
    v_permlane16_swap_b32 v250, v248
    v_mfma_f32_16x16x32_bf16 v[200:203], a[216:219], v[152:155], v[200:203]
    ds_read_b64_tr_b16 a[146:147], v7 offset:4736
    s_add_u32 m0, s52, 84512
    s_nop 1
    v_max_f32 v248, v248, v250
    v_mfma_f32_16x16x32_bf16 v[200:203], a[220:223], v[156:159], v[200:203]
    ds_read_b64_tr_b16 a[148:149], v7 offset:8960
    buffer_load_dwordx4 v2, s[28:31], s49 offen offset:1024 nt lds
    v_sub_f32 v236, 0xc1000000, v248
    v_sub_f32 v237, 0xc1000000, v248
    v_mfma_f32_16x16x32_bf16 v[204:207], a[224:227], v[144:147], 0
    ds_read_b64_tr_b16 a[150:151], v7 offset:13184
    ds_read_b64_tr_b16 a[152:153], v7 offset:544
    v_sub_f32 v238, 0xc1000000, v248
    v_sub_f32 v239, 0xc1000000, v248
    v_mfma_f32_16x16x32_bf16 v[204:207], a[228:231], v[148:151], v[204:207]
    ds_read_b64_tr_b16 a[154:155], v7 offset:4768
    ds_read_b64_tr_b16 a[156:157], v7 offset:8992
    v_add_f32 v176, v176, v236
    v_add_f32 v177, v177, v236
    v_mfma_f32_16x16x32_bf16 v[204:207], a[232:235], v[152:155], v[204:207]
    ds_read_b64_tr_b16 a[158:159], v7 offset:13216
    ds_read_b64_tr_b16 a[160:161], v7 offset:768
    v_exp_f32 v176, v176
    v_add_f32 v178, v178, v236
    v_mfma_f32_16x16x32_bf16 v[204:207], a[236:239], v[156:159], v[204:207]
    ds_read_b64_tr_b16 a[162:163], v7 offset:4992
    ds_read_b64_tr_b16 a[164:165], v7 offset:9216
    v_exp_f32 v177, v177
    v_add_f32 v179, v179, v236
    s_waitcnt lgkmcnt(15)
    v_mfma_f32_16x16x32_bf16 v[16:19], a[80:83], v[208:211], 0
    ds_read_b64_tr_b16 a[166:167], v7 offset:13440
    ds_read_b64_tr_b16 a[168:169], v7 offset:800
    v_exp_f32 v178, v178
    v_cvt_pk_bf16_f32 v216, v176, v177
    v_mfma_f32_16x16x32_bf16 v[16:19], a[84:87], v[212:215], v[16:19]
    ds_read_b64_tr_b16 a[170:171], v7 offset:5024
    ds_read_b64_tr_b16 a[172:173], v7 offset:9248
    v_add_f32 v180, v180, v236
    v_exp_f32 v179, v179
    v_mfma_f32_16x16x32_bf16 v[20:23], a[88:91], v[208:211], 0
    ds_read_b64_tr_b16 a[174:175], v7 offset:13472
    s_add_u32 m0, s52, 84544
    v_add_f32 v181, v181, v236
    v_exp_f32 v180, v180
    v_mfma_f32_16x16x32_bf16 v[20:23], a[92:95], v[212:215], v[20:23]
    ds_read_b128 a[176:179], v5 offset:33792
    buffer_load_dwordx4 v2, s[28:31], s49 offen offset:2048 nt lds
    v_cvt_pk_bf16_f32 v217, v178, v179
    v_add_f32 v182, v182, v236
    s_waitcnt lgkmcnt(15)
    v_mfma_f32_16x16x32_bf16 v[24:27], a[96:99], v[208:211], 0
    ds_read_b128 a[180:183], v5 offset:34048
    ds_read_b128 a[184:187], v5 offset:34304
    v_exp_f32 v181, v181
    v_add_f32 v183, v183, v236
    v_mfma_f32_16x16x32_bf16 v[24:27], a[100:103], v[212:215], v[24:27]
    ds_read_b128 a[188:191], v5 offset:34560
    ds_read_b128 a[192:195], v5 offset:38016
    v_exp_f32 v182, v182
    v_cvt_pk_bf16_f32 v218, v180, v181
    v_mfma_f32_16x16x32_bf16 v[28:31], a[104:107], v[208:211], 0
    ds_read_b128 a[196:199], v5 offset:38272
    ds_read_b128 a[200:203], v5 offset:38528
    v_add_f32 v184, v184, v236
    v_exp_f32 v183, v183
    v_mfma_f32_16x16x32_bf16 v[28:31], a[108:111], v[212:215], v[28:31]
    ds_read_b128 a[204:207], v5 offset:38784
    ds_read_b128 a[208:211], v5 offset:42240
    v_add_f32 v185, v185, v236
    v_exp_f32 v184, v184
    s_waitcnt lgkmcnt(15)
    v_mfma_f32_16x16x32_bf16 v[32:35], a[144:147], v[208:211], 0
    ds_read_b128 a[212:215], v5 offset:42496
    ds_read_b128 a[216:219], v5 offset:42752
    v_cvt_pk_bf16_f32 v219, v182, v183
    v_add_f32 v186, v186, v236
    v_mfma_f32_16x16x32_bf16 v[32:35], a[148:151], v[212:215], v[32:35]
    ds_read_b128 a[220:223], v5 offset:43008
    ds_read_b128 a[224:227], v5 offset:46464
    v_exp_f32 v185, v185
    v_add_f32 v187, v187, v236
    v_mfma_f32_16x16x32_bf16 v[36:39], a[152:155], v[208:211], 0
    ds_read_b128 a[228:231], v5 offset:46720
    s_add_u32 m0, s52, 84576
    v_exp_f32 v186, v186
    v_cvt_pk_bf16_f32 v220, v184, v185
    v_mfma_f32_16x16x32_bf16 v[36:39], a[156:159], v[212:215], v[36:39]
    ds_read_b128 a[232:235], v5 offset:46976
    buffer_load_dwordx4 v2, s[28:31], s49 offen offset:3072 nt lds
    v_add_f32 v188, v188, v236
    v_exp_f32 v187, v187
    s_waitcnt lgkmcnt(15)
    v_mfma_f32_16x16x32_bf16 v[40:43], a[160:163], v[208:211], 0
    ds_read_b128 a[236:239], v5 offset:47232
    v_add_f32 v189, v189, v236
    v_exp_f32 v188, v188
    v_mfma_f32_16x16x32_bf16 v[40:43], a[164:167], v[212:215], v[40:43]
    v_cvt_pk_bf16_f32 v221, v186, v187
    v_add_f32 v190, v190, v236
    v_mfma_f32_16x16x32_bf16 v[44:47], a[168:171], v[208:211], 0
    v_exp_f32 v189, v189
    v_add_f32 v191, v191, v236
    v_mfma_f32_16x16x32_bf16 v[44:47], a[172:175], v[212:215], v[44:47]
    v_exp_f32 v190, v190
    v_cvt_pk_bf16_f32 v222, v188, v189
    v_mfma_f32_16x16x32_bf16 a[240:243], a[252:255], v[208:211], 0
    v_exp_f32 v191, v191
    s_nop 0
    v_mfma_f32_16x16x32_bf16 a[240:243], a[252:255], v[212:215], a[240:243]
    v_cvt_pk_bf16_f32 v223, v190, v191
    s_waitcnt lgkmcnt(12)
    v_mfma_f32_16x16x32_bf16 v[160:163], a[176:179], v[112:115], v[232:235]
    v_mfma_f32_16x16x32_bf16 v[160:163], a[180:183], v[116:119], v[160:163]
    v_mfma_f32_16x16x32_bf16 v[160:163], a[184:187], v[120:123], v[160:163]
    s_add_u32 m0, s52, 0
    s_mov_b32 s49, 49152
    v_max3_f32 v248, v192, v193, v194
    v_max3_f32 v249, v195, v196, v197
    v_mfma_f32_16x16x32_bf16 v[160:163], a[188:191], v[124:127], v[160:163]
    buffer_load_dwordx4 v2, s[24:27], s49 offen offset:0 nt lds
    v_max3_f32 v248, v248, v198, v199
    v_max3_f32 v249, v249, v200, v201
    s_waitcnt lgkmcnt(8)
    v_mfma_f32_16x16x32_bf16 v[164:167], a[192:195], v[112:115], v[232:235]
    v_max3_f32 v248, v248, v202, v203
    v_max3_f32 v249, v249, v204, v205
    v_mfma_f32_16x16x32_bf16 v[164:167], a[196:199], v[116:119], v[164:167]
    v_max3_f32 v248, v248, v206, v207
    v_max_f32 v248, v248, v249
    v_mfma_f32_16x16x32_bf16 v[164:167], a[200:203], v[120:123], v[164:167]
    v_mov_b32 v250, v248
    s_nop 1
    v_mfma_f32_16x16x32_bf16 v[164:167], a[204:207], v[124:127], v[164:167]
    v_permlane32_swap_b32 v250, v248
    s_nop 1
    s_waitcnt lgkmcnt(4)
    v_mfma_f32_16x16x32_bf16 v[168:171], a[208:211], v[112:115], v[232:235]
    v_max_f32 v248, v248, v250
    v_mov_b32 v250, v248
    v_mfma_f32_16x16x32_bf16 v[168:171], a[212:215], v[116:119], v[168:171]
    s_nop 1
    v_permlane16_swap_b32 v250, v248
    v_mfma_f32_16x16x32_bf16 v[168:171], a[216:219], v[120:123], v[168:171]
    s_add_u32 m0, s52, 32
    s_nop 1
    v_max_f32 v248, v248, v250
    v_mfma_f32_16x16x32_bf16 v[168:171], a[220:223], v[124:127], v[168:171]
    buffer_load_dwordx4 v2, s[24:27], s49 offen offset:1024 nt lds
    v_sub_f32 v240, 0xc1000000, v248
    v_sub_f32 v241, 0xc1000000, v248
    s_waitcnt lgkmcnt(0)
    v_mfma_f32_16x16x32_bf16 v[172:175], a[224:227], v[112:115], v[232:235]
    v_sub_f32 v242, 0xc1000000, v248
    v_sub_f32 v243, 0xc1000000, v248
    v_mfma_f32_16x16x32_bf16 v[172:175], a[228:231], v[116:119], v[172:175]
    v_add_f32 v192, v192, v240
    v_add_f32 v193, v193, v240
    v_mfma_f32_16x16x32_bf16 v[172:175], a[232:235], v[120:123], v[172:175]
    v_exp_f32 v192, v192
    v_add_f32 v194, v194, v240
    v_mfma_f32_16x16x32_bf16 v[172:175], a[236:239], v[124:127], v[172:175]
    v_exp_f32 v193, v193
    v_add_f32 v195, v195, v240
    v_mfma_f32_16x16x32_bf16 v[48:51], a[80:83], v[216:219], 0
    v_exp_f32 v194, v194
    v_cvt_pk_bf16_f32 v224, v192, v193
    v_mfma_f32_16x16x32_bf16 v[48:51], a[84:87], v[220:223], v[48:51]
    v_add_f32 v196, v196, v240
    v_exp_f32 v195, v195
    v_mfma_f32_16x16x32_bf16 v[52:55], a[88:91], v[216:219], 0
    s_add_u32 m0, s52, 64
    v_add_f32 v197, v197, v240
    v_exp_f32 v196, v196
    v_mfma_f32_16x16x32_bf16 v[52:55], a[92:95], v[220:223], v[52:55]
    buffer_load_dwordx4 v2, s[24:27], s49 offen offset:2048 nt lds
    v_cvt_pk_bf16_f32 v225, v194, v195
    v_add_f32 v198, v198, v240
    v_mfma_f32_16x16x32_bf16 v[56:59], a[96:99], v[216:219], 0
    v_exp_f32 v197, v197
    v_add_f32 v199, v199, v240
    v_mfma_f32_16x16x32_bf16 v[56:59], a[100:103], v[220:223], v[56:59]
    v_exp_f32 v198, v198
    v_cvt_pk_bf16_f32 v226, v196, v197
    v_mfma_f32_16x16x32_bf16 v[60:63], a[104:107], v[216:219], 0
    v_add_f32 v200, v200, v240
    v_exp_f32 v199, v199
    v_mfma_f32_16x16x32_bf16 v[60:63], a[108:111], v[220:223], v[60:63]
    v_add_f32 v201, v201, v240
    v_exp_f32 v200, v200
    v_mfma_f32_16x16x32_bf16 v[64:67], a[144:147], v[216:219], 0
    v_cvt_pk_bf16_f32 v227, v198, v199
    v_add_f32 v202, v202, v240
    v_mfma_f32_16x16x32_bf16 v[64:67], a[148:151], v[220:223], v[64:67]
    v_exp_f32 v201, v201
    v_add_f32 v203, v203, v240
    v_mfma_f32_16x16x32_bf16 v[68:71], a[152:155], v[216:219], 0
    v_exp_f32 v202, v202
    v_cvt_pk_bf16_f32 v228, v200, v201
    v_mfma_f32_16x16x32_bf16 v[68:71], a[156:159], v[220:223], v[68:71]
    v_add_f32 v204, v204, v240
    v_exp_f32 v203, v203
    v_mfma_f32_16x16x32_bf16 v[72:75], a[160:163], v[216:219], 0
    s_add_u32 m0, s52, 96
    v_add_f32 v205, v205, v240
    v_exp_f32 v204, v204
    v_mfma_f32_16x16x32_bf16 v[72:75], a[164:167], v[220:223], v[72:75]
    buffer_load_dwordx4 v2, s[24:27], s49 offen offset:3072 nt lds
    v_cvt_pk_bf16_f32 v229, v202, v203
    v_add_f32 v206, v206, v240
    v_mfma_f32_16x16x32_bf16 v[76:79], a[168:171], v[216:219], 0
    v_exp_f32 v205, v205
    v_add_f32 v207, v207, v240
    v_mfma_f32_16x16x32_bf16 v[76:79], a[172:175], v[220:223], v[76:79]
    v_exp_f32 v206, v206
    v_cvt_pk_bf16_f32 v230, v204, v205
    v_mfma_f32_16x16x32_bf16 a[244:247], a[252:255], v[216:219], 0
    v_exp_f32 v207, v207
    s_nop 0
    v_mfma_f32_16x16x32_bf16 a[244:247], a[252:255], v[220:223], a[244:247]
    v_cvt_pk_bf16_f32 v231, v206, v207
    v_mfma_f32_16x16x32_bf16 v[176:179], a[176:179], v[128:131], v[236:239]
    v_exp_f32 v244, v160
    v_mfma_f32_16x16x32_bf16 v[176:179], a[180:183], v[132:135], v[176:179]
    v_mfma_f32_16x16x32_bf16 v[176:179], a[184:187], v[136:139], v[176:179]
    v_exp_f32 v245, v161
    s_waitcnt vmcnt(8)
    s_barrier
    v_mfma_f32_16x16x32_bf16 v[176:179], a[188:191], v[140:143], v[176:179]
    ds_read_b64_tr_b16 a[112:113], v7 offset:33792
    v_cvt_pk_bf16_f32 v208, v244, v245
    v_mfma_f32_16x16x32_bf16 v[180:183], a[192:195], v[128:131], v[236:239]
    v_exp_f32 v246, v162
    v_mfma_f32_16x16x32_bf16 v[180:183], a[196:199], v[132:135], v[180:183]
    ds_read_b64_tr_b16 a[114:115], v7 offset:38016
    ds_read_b64_tr_b16 a[116:117], v7 offset:42240
    v_mfma_f32_16x16x32_bf16 v[180:183], a[200:203], v[136:139], v[180:183]
    v_exp_f32 v247, v163
    v_mfma_f32_16x16x32_bf16 v[180:183], a[204:207], v[140:143], v[180:183]
    ds_read_b64_tr_b16 a[118:119], v7 offset:46464
    v_cvt_pk_bf16_f32 v209, v246, v247
    v_mfma_f32_16x16x32_bf16 v[184:187], a[208:211], v[128:131], v[236:239]
    v_exp_f32 v244, v164
    v_mfma_f32_16x16x32_bf16 v[184:187], a[212:215], v[132:135], v[184:187]
    ds_read_b64_tr_b16 a[120:121], v7 offset:33824
    ds_read_b64_tr_b16 a[122:123], v7 offset:38048
    v_mfma_f32_16x16x32_bf16 v[184:187], a[216:219], v[136:139], v[184:187]
    v_exp_f32 v245, v165
    s_add_u32 m0, s52, 16896
    s_mov_b32 s49, 49152
    v_mfma_f32_16x16x32_bf16 v[184:187], a[220:223], v[140:143], v[184:187]
    buffer_load_dwordx4 v2, s[28:31], s49 offen offset:0 nt lds
    v_cvt_pk_bf16_f32 v210, v244, v245
    v_mfma_f32_16x16x32_bf16 v[188:191], a[224:227], v[128:131], v[236:239]
    v_exp_f32 v246, v166
    v_mfma_f32_16x16x32_bf16 v[188:191], a[228:231], v[132:135], v[188:191]
    ds_read_b64_tr_b16 a[124:125], v7 offset:42272
    v_or3_b32 v11, v208, v209, v210
    v_mfma_f32_16x16x32_bf16 v[188:191], a[232:235], v[136:139], v[188:191]
    v_exp_f32 v247, v167
    v_mfma_f32_16x16x32_bf16 v[188:191], a[236:239], v[140:143], v[188:191]
    ds_read_b64_tr_b16 a[126:127], v7 offset:46496
    v_cvt_pk_bf16_f32 v211, v246, v247
    v_mfma_f32_16x16x32_bf16 v[80:83], a[80:83], v[224:227], 0
    v_exp_f32 v244, v168
    v_mfma_f32_16x16x32_bf16 v[80:83], a[84:87], v[228:231], v[80:83]
    ds_read_b64_tr_b16 a[128:129], v7 offset:34048
    ds_read_b64_tr_b16 a[130:131], v7 offset:38272
    v_mfma_f32_16x16x32_bf16 v[84:87], a[88:91], v[224:227], 0
    v_exp_f32 v245, v169
    v_mfma_f32_16x16x32_bf16 v[84:87], a[92:95], v[228:231], v[84:87]
    ds_read_b64_tr_b16 a[132:133], v7 offset:42496
    v_cvt_pk_bf16_f32 v212, v244, v245
    v_mfma_f32_16x16x32_bf16 v[88:91], a[96:99], v[224:227], 0
    v_exp_f32 v246, v170
    v_mfma_f32_16x16x32_bf16 v[88:91], a[100:103], v[228:231], v[88:91]
    ds_read_b64_tr_b16 a[134:135], v7 offset:46720
    v_or3_b32 v11, v11, v211, v212
    v_mfma_f32_16x16x32_bf16 v[92:95], a[104:107], v[224:227], 0
    v_exp_f32 v247, v171
    s_add_u32 m0, s52, 16928
    v_mfma_f32_16x16x32_bf16 v[92:95], a[108:111], v[228:231], v[92:95]
    buffer_load_dwordx4 v2, s[28:31], s49 offen offset:1024 nt lds
    v_cvt_pk_bf16_f32 v213, v246, v247
    v_mfma_f32_16x16x32_bf16 v[96:99], a[144:147], v[224:227], 0
    v_exp_f32 v244, v172
    v_mfma_f32_16x16x32_bf16 v[96:99], a[148:151], v[228:231], v[96:99]
    ds_read_b64_tr_b16 a[136:137], v7 offset:34080
    ds_read_b64_tr_b16 a[138:139], v7 offset:38304
    v_mfma_f32_16x16x32_bf16 v[100:103], a[152:155], v[224:227], 0
    v_exp_f32 v245, v173
    v_mfma_f32_16x16x32_bf16 v[100:103], a[156:159], v[228:231], v[100:103]
    ds_read_b64_tr_b16 a[140:141], v7 offset:42528
    v_cvt_pk_bf16_f32 v214, v244, v245
    v_mfma_f32_16x16x32_bf16 v[104:107], a[160:163], v[224:227], 0
    v_exp_f32 v246, v174
    v_mfma_f32_16x16x32_bf16 v[104:107], a[164:167], v[228:231], v[104:107]
    ds_read_b64_tr_b16 a[142:143], v7 offset:46752
    v_or3_b32 v11, v11, v213, v214
    v_mfma_f32_16x16x32_bf16 v[108:111], a[168:171], v[224:227], 0
    v_exp_f32 v247, v175
    v_mfma_f32_16x16x32_bf16 v[108:111], a[172:175], v[228:231], v[108:111]
    ds_read_b64_tr_b16 a[144:145], v7 offset:34304
    v_cvt_pk_bf16_f32 v215, v246, v247
    v_mfma_f32_16x16x32_bf16 a[248:251], a[252:255], v[224:227], 0
    v_bitop3_b32 v11, v11, v215, s47 bitop3:0xa8
    v_cmp_ne_u32 vcc, 0, v11
    v_mfma_f32_16x16x32_bf16 a[248:251], a[252:255], v[228:231], a[248:251]
    ds_read_b64_tr_b16 a[146:147], v7 offset:38528
    ds_read_b64_tr_b16 a[148:149], v7 offset:42752
    v_mfma_f32_16x16x32_bf16 v[192:195], a[176:179], v[144:147], v[240:243]
    v_exp_f32 v244, v176
    v_mfma_f32_16x16x32_bf16 v[192:195], a[180:183], v[148:151], v[192:195]
    ds_read_b64_tr_b16 a[150:151], v7 offset:46976
    s_cbranch_vccnz L_st1_0
L_bk1_0:
    v_mfma_f32_16x16x32_bf16 v[192:195], a[184:187], v[152:155], v[192:195]
    v_exp_f32 v245, v177
    s_add_u32 m0, s52, 16960
    v_mfma_f32_16x16x32_bf16 v[192:195], a[188:191], v[156:159], v[192:195]
    buffer_load_dwordx4 v2, s[28:31], s49 offen offset:2048 nt lds
    v_cvt_pk_bf16_f32 v216, v244, v245
    v_mfma_f32_16x16x32_bf16 v[196:199], a[192:195], v[144:147], v[240:243]
    v_exp_f32 v246, v178
    v_mfma_f32_16x16x32_bf16 v[196:199], a[196:199], v[148:151], v[196:199]
    ds_read_b64_tr_b16 a[152:153], v7 offset:34336
    ds_read_b64_tr_b16 a[154:155], v7 offset:38560
    v_mfma_f32_16x16x32_bf16 v[196:199], a[200:203], v[152:155], v[196:199]
    v_exp_f32 v247, v179
    v_mfma_f32_16x16x32_bf16 v[196:199], a[204:207], v[156:159], v[196:199]
    ds_read_b64_tr_b16 a[156:157], v7 offset:42784
    v_cvt_pk_bf16_f32 v217, v246, v247
    v_mfma_f32_16x16x32_bf16 v[200:203], a[208:211], v[144:147], v[240:243]
    v_exp_f32 v244, v180
    v_mfma_f32_16x16x32_bf16 v[200:203], a[212:215], v[148:151], v[200:203]
    ds_read_b64_tr_b16 a[158:159], v7 offset:47008
    ds_read_b64_tr_b16 a[160:161], v7 offset:34560
    v_mfma_f32_16x16x32_bf16 v[200:203], a[216:219], v[152:155], v[200:203]
    v_exp_f32 v245, v181
    v_mfma_f32_16x16x32_bf16 v[200:203], a[220:223], v[156:159], v[200:203]
    ds_read_b64_tr_b16 a[162:163], v7 offset:38784
    v_cvt_pk_bf16_f32 v218, v244, v245
    v_mfma_f32_16x16x32_bf16 v[204:207], a[224:227], v[144:147], v[240:243]
    v_exp_f32 v246, v182
    v_mfma_f32_16x16x32_bf16 v[204:207], a[228:231], v[148:151], v[204:207]
    ds_read_b64_tr_b16 a[164:165], v7 offset:43008
    v_or3_b32 v11, v216, v217, v218
    v_mfma_f32_16x16x32_bf16 v[204:207], a[232:235], v[152:155], v[204:207]
    v_exp_f32 v247, v183
    s_add_u32 m0, s52, 16992
    v_mfma_f32_16x16x32_bf16 v[204:207], a[236:239], v[156:159], v[204:207]
    buffer_load_dwordx4 v2, s[28:31], s49 offen offset:3072 nt lds
    v_cvt_pk_bf16_f32 v219, v246, v247
    s_waitcnt lgkmcnt(11)
    v_mfma_f32_16x16x32_bf16 v[16:19], a[112:115], v[208:211], v[16:19]
    v_exp_f32 v244, v184
    v_mfma_f32_16x16x32_bf16 v[16:19], a[116:119], v[212:215], v[16:19]
    ds_read_b64_tr_b16 a[166:167], v7 offset:47232
    ds_read_b64_tr_b16 a[168:169], v7 offset:34592
    v_mfma_f32_16x16x32_bf16 v[20:23], a[120:123], v[208:211], v[20:23]
    v_exp_f32 v245, v185
    v_mfma_f32_16x16x32_bf16 v[20:23], a[124:127], v[212:215], v[20:23]
    ds_read_b64_tr_b16 a[170:171], v7 offset:38816
    v_cvt_pk_bf16_f32 v220, v244, v245
    v_mfma_f32_16x16x32_bf16 v[24:27], a[128:131], v[208:211], v[24:27]
    ds_read_b64_tr_b16 a[172:173], v7 offset:43040
    ds_read_b64_tr_b16 a[174:175], v7 offset:47264
    v_exp_f32 v246, v186
    v_mfma_f32_16x16x32_bf16 v[24:27], a[132:135], v[212:215], v[24:27]
    ds_read_b128 a[176:179], v6 offset:0
    v_or3_b32 v11, v11, v219, v220
    v_mfma_f32_16x16x32_bf16 v[28:31], a[136:139], v[208:211], v[28:31]
    v_exp_f32 v247, v187
    v_mfma_f32_16x16x32_bf16 v[28:31], a[140:143], v[212:215], v[28:31]
    ds_read_b128 a[180:183], v6 offset:256
    v_cvt_pk_bf16_f32 v221, v246, v247
    s_waitcnt lgkmcnt(10)
    v_mfma_f32_16x16x32_bf16 v[32:35], a[144:147], v[208:211], v[32:35]
    v_exp_f32 v244, v188
    v_mfma_f32_16x16x32_bf16 v[32:35], a[148:151], v[212:215], v[32:35]
    ds_read_b128 a[184:187], v6 offset:512
    ds_read_b128 a[188:191], v6 offset:768
    v_mfma_f32_16x16x32_bf16 v[36:39], a[152:155], v[208:211], v[36:39]
    v_exp_f32 v245, v189
    s_add_u32 m0, s52, 33792
    s_mov_b32 s49, 65536
    v_mfma_f32_16x16x32_bf16 v[36:39], a[156:159], v[212:215], v[36:39]
    buffer_load_dwordx4 v2, s[24:27], s49 offen offset:0 nt lds
    v_cvt_pk_bf16_f32 v222, v244, v245
    s_waitcnt lgkmcnt(4)
    v_mfma_f32_16x16x32_bf16 v[40:43], a[160:163], v[208:211], v[40:43]
    v_exp_f32 v246, v190
    v_mfma_f32_16x16x32_bf16 v[40:43], a[164:167], v[212:215], v[40:43]
    ds_read_b128 a[192:195], v6 offset:4224
    v_or3_b32 v11, v11, v221, v222
    v_mfma_f32_16x16x32_bf16 v[44:47], a[168:171], v[208:211], v[44:47]
    ds_read_b128 a[196:199], v6 offset:4480
    ds_read_b128 a[200:203], v6 offset:4736
    ds_read_b128 a[204:207], v6 offset:4992
    v_exp_f32 v247, v191
    v_mfma_f32_16x16x32_bf16 v[44:47], a[172:175], v[212:215], v[44:47]
    ds_read_b128 a[208:211], v6 offset:8448
    v_cvt_pk_bf16_f32 v223, v246, v247
    v_mfma_f32_16x16x32_bf16 a[240:243], a[252:255], v[208:211], a[240:243]
    v_bitop3_b32 v11, v11, v223, s47 bitop3:0xa8
    v_cmp_ne_u32 vcc, 0, v11
    v_mfma_f32_16x16x32_bf16 a[240:243], a[252:255], v[212:215], a[240:243]
    ds_read_b128 a[212:215], v6 offset:8704
    ds_read_b128 a[216:219], v6 offset:8960
    s_waitcnt lgkmcnt(7)
    v_mfma_f32_16x16x32_bf16 v[160:163], a[176:179], v[112:115], v[232:235]
    ds_read_b128 a[220:223], v6 offset:9216
    v_exp_f32 v244, v192
    v_mfma_f32_16x16x32_bf16 v[160:163], a[180:183], v[116:119], v[160:163]
    ds_read_b128 a[224:227], v6 offset:12672
    s_cbranch_vccnz L_st1_1
L_bk1_1:
    v_mfma_f32_16x16x32_bf16 v[160:163], a[184:187], v[120:123], v[160:163]
    v_exp_f32 v245, v193
    v_mfma_f32_16x16x32_bf16 v[160:163], a[188:191], v[124:127], v[160:163]
    ds_read_b128 a[228:231], v6 offset:12928
    v_cvt_pk_bf16_f32 v224, v244, v245
    s_waitcnt lgkmcnt(6)
    v_mfma_f32_16x16x32_bf16 v[164:167], a[192:195], v[112:115], v[232:235]
    ds_read_b128 a[232:235], v6 offset:13184
    ds_read_b128 a[236:239], v6 offset:13440
    v_exp_f32 v246, v194
    v_mfma_f32_16x16x32_bf16 v[164:167], a[196:199], v[116:119], v[164:167]
    v_mfma_f32_16x16x32_bf16 v[164:167], a[200:203], v[120:123], v[164:167]
    v_exp_f32 v247, v195
    v_mfma_f32_16x16x32_bf16 v[164:167], a[204:207], v[124:127], v[164:167]
    v_cvt_pk_bf16_f32 v225, v246, v247
    s_waitcnt lgkmcnt(4)
    v_mfma_f32_16x16x32_bf16 v[168:171], a[208:211], v[112:115], v[232:235]
    v_exp_f32 v244, v196
    s_add_u32 m0, s52, 33824
    v_mfma_f32_16x16x32_bf16 v[168:171], a[212:215], v[116:119], v[168:171]
    buffer_load_dwordx4 v2, s[24:27], s49 offen offset:1024 nt lds
    v_mfma_f32_16x16x32_bf16 v[168:171], a[216:219], v[120:123], v[168:171]
    v_exp_f32 v245, v197
    v_mfma_f32_16x16x32_bf16 v[168:171], a[220:223], v[124:127], v[168:171]
    v_cvt_pk_bf16_f32 v226, v244, v245
    s_waitcnt lgkmcnt(0)
    v_mfma_f32_16x16x32_bf16 v[172:175], a[224:227], v[112:115], v[232:235]
    v_exp_f32 v246, v198
    v_mfma_f32_16x16x32_bf16 v[172:175], a[228:231], v[116:119], v[172:175]
    v_or3_b32 v11, v224, v225, v226
    v_mfma_f32_16x16x32_bf16 v[172:175], a[232:235], v[120:123], v[172:175]
    v_exp_f32 v247, v199
    v_mfma_f32_16x16x32_bf16 v[172:175], a[236:239], v[124:127], v[172:175]
    v_cvt_pk_bf16_f32 v227, v246, v247
    v_mfma_f32_16x16x32_bf16 v[48:51], a[112:115], v[216:219], v[48:51]
    v_exp_f32 v244, v200
    v_mfma_f32_16x16x32_bf16 v[48:51], a[116:119], v[220:223], v[48:51]
    v_mfma_f32_16x16x32_bf16 v[52:55], a[120:123], v[216:219], v[52:55]
    v_exp_f32 v245, v201
    s_add_u32 m0, s52, 33856
    v_mfma_f32_16x16x32_bf16 v[52:55], a[124:127], v[220:223], v[52:55]
    buffer_load_dwordx4 v2, s[24:27], s49 offen offset:2048 nt lds
    v_cvt_pk_bf16_f32 v228, v244, v245
    v_mfma_f32_16x16x32_bf16 v[56:59], a[128:131], v[216:219], v[56:59]
    v_exp_f32 v246, v202
    v_mfma_f32_16x16x32_bf16 v[56:59], a[132:135], v[220:223], v[56:59]
    v_or3_b32 v11, v11, v227, v228
    v_mfma_f32_16x16x32_bf16 v[60:63], a[136:139], v[216:219], v[60:63]
    v_exp_f32 v247, v203
    v_mfma_f32_16x16x32_bf16 v[60:63], a[140:143], v[220:223], v[60:63]
    v_cvt_pk_bf16_f32 v229, v246, v247
    v_mfma_f32_16x16x32_bf16 v[64:67], a[144:147], v[216:219], v[64:67]
    v_exp_f32 v244, v204
    v_mfma_f32_16x16x32_bf16 v[64:67], a[148:151], v[220:223], v[64:67]
    v_mfma_f32_16x16x32_bf16 v[68:71], a[152:155], v[216:219], v[68:71]
    v_exp_f32 v245, v205
    v_mfma_f32_16x16x32_bf16 v[68:71], a[156:159], v[220:223], v[68:71]
    v_cvt_pk_bf16_f32 v230, v244, v245
    v_mfma_f32_16x16x32_bf16 v[72:75], a[160:163], v[216:219], v[72:75]
    v_exp_f32 v246, v206
    s_add_u32 m0, s52, 33888
    v_mfma_f32_16x16x32_bf16 v[72:75], a[164:167], v[220:223], v[72:75]
    buffer_load_dwordx4 v2, s[24:27], s49 offen offset:3072 nt lds
    v_or3_b32 v11, v11, v229, v230
    v_mfma_f32_16x16x32_bf16 v[76:79], a[168:171], v[216:219], v[76:79]
    v_exp_f32 v247, v207
    v_mfma_f32_16x16x32_bf16 v[76:79], a[172:175], v[220:223], v[76:79]
    v_cvt_pk_bf16_f32 v231, v246, v247
    v_mfma_f32_16x16x32_bf16 a[244:247], a[252:255], v[216:219], a[244:247]
    v_bitop3_b32 v11, v11, v231, s47 bitop3:0xa8
    v_cmp_ne_u32 vcc, 0, v11
    v_mfma_f32_16x16x32_bf16 a[244:247], a[252:255], v[220:223], a[244:247]
    v_mfma_f32_16x16x32_bf16 v[176:179], a[176:179], v[128:131], v[236:239]
    v_exp_f32 v244, v160
    v_mfma_f32_16x16x32_bf16 v[176:179], a[180:183], v[132:135], v[176:179]
    s_cbranch_vccnz L_st1_2
L_bk1_2:
    v_mfma_f32_16x16x32_bf16 v[176:179], a[184:187], v[136:139], v[176:179]
    v_exp_f32 v245, v161
    s_waitcnt vmcnt(8)
    s_barrier
    v_mfma_f32_16x16x32_bf16 v[176:179], a[188:191], v[140:143], v[176:179]
    ds_read_b64_tr_b16 a[80:81], v8 offset:0
    v_cvt_pk_bf16_f32 v208, v244, v245
    v_mfma_f32_16x16x32_bf16 v[180:183], a[192:195], v[128:131], v[236:239]
    v_exp_f32 v246, v162
    v_mfma_f32_16x16x32_bf16 v[180:183], a[196:199], v[132:135], v[180:183]
    ds_read_b64_tr_b16 a[82:83], v8 offset:4224
    ds_read_b64_tr_b16 a[84:85], v8 offset:8448
    v_mfma_f32_16x16x32_bf16 v[180:183], a[200:203], v[136:139], v[180:183]
    v_exp_f32 v247, v163
    v_mfma_f32_16x16x32_bf16 v[180:183], a[204:207], v[140:143], v[180:183]
    ds_read_b64_tr_b16 a[86:87], v8 offset:12672
    v_cvt_pk_bf16_f32 v209, v246, v247
    v_mfma_f32_16x16x32_bf16 v[184:187], a[208:211], v[128:131], v[236:239]
    v_exp_f32 v244, v164
    v_mfma_f32_16x16x32_bf16 v[184:187], a[212:215], v[132:135], v[184:187]
    ds_read_b64_tr_b16 a[88:89], v8 offset:32
    ds_read_b64_tr_b16 a[90:91], v8 offset:4256
    v_mfma_f32_16x16x32_bf16 v[184:187], a[216:219], v[136:139], v[184:187]
    v_exp_f32 v245, v165
    s_add_u32 m0, s52, 50688
    s_mov_b32 s49, 65536
    v_mfma_f32_16x16x32_bf16 v[184:187], a[220:223], v[140:143], v[184:187]
    buffer_load_dwordx4 v2, s[28:31], s49 offen offset:0 nt lds
    v_cvt_pk_bf16_f32 v210, v244, v245
    v_mfma_f32_16x16x32_bf16 v[188:191], a[224:227], v[128:131], v[236:239]
    v_exp_f32 v246, v166
    v_mfma_f32_16x16x32_bf16 v[188:191], a[228:231], v[132:135], v[188:191]
    ds_read_b64_tr_b16 a[92:93], v8 offset:8480
    v_or3_b32 v11, v208, v209, v210
    v_mfma_f32_16x16x32_bf16 v[188:191], a[232:235], v[136:139], v[188:191]
    v_exp_f32 v247, v167
    v_mfma_f32_16x16x32_bf16 v[188:191], a[236:239], v[140:143], v[188:191]
    ds_read_b64_tr_b16 a[94:95], v8 offset:12704
    v_cvt_pk_bf16_f32 v211, v246, v247
    v_mfma_f32_16x16x32_bf16 v[80:83], a[112:115], v[224:227], v[80:83]
    v_exp_f32 v244, v168
    v_mfma_f32_16x16x32_bf16 v[80:83], a[116:119], v[228:231], v[80:83]
    ds_read_b64_tr_b16 a[96:97], v8 offset:256
    ds_read_b64_tr_b16 a[98:99], v8 offset:4480
    v_mfma_f32_16x16x32_bf16 v[84:87], a[120:123], v[224:227], v[84:87]
    v_exp_f32 v245, v169
    v_mfma_f32_16x16x32_bf16 v[84:87], a[124:127], v[228:231], v[84:87]
    ds_read_b64_tr_b16 a[100:101], v8 offset:8704
    v_cvt_pk_bf16_f32 v212, v244, v245
    v_mfma_f32_16x16x32_bf16 v[88:91], a[128:131], v[224:227], v[88:91]
    v_exp_f32 v246, v170
    v_mfma_f32_16x16x32_bf16 v[88:91], a[132:135], v[228:231], v[88:91]
    ds_read_b64_tr_b16 a[102:103], v8 offset:12928
    v_or3_b32 v11, v11, v211, v212
    v_mfma_f32_16x16x32_bf16 v[92:95], a[136:139], v[224:227], v[92:95]
    v_exp_f32 v247, v171
    s_add_u32 m0, s52, 50720
    v_mfma_f32_16x16x32_bf16 v[92:95], a[140:143], v[228:231], v[92:95]
    buffer_load_dwordx4 v2, s[28:31], s49 offen offset:1024 nt lds
    v_cvt_pk_bf16_f32 v213, v246, v247
    v_mfma_f32_16x16x32_bf16 v[96:99], a[144:147], v[224:227], v[96:99]
    v_exp_f32 v244, v172
    v_mfma_f32_16x16x32_bf16 v[96:99], a[148:151], v[228:231], v[96:99]
    ds_read_b64_tr_b16 a[104:105], v8 offset:288
    ds_read_b64_tr_b16 a[106:107], v8 offset:4512
    v_mfma_f32_16x16x32_bf16 v[100:103], a[152:155], v[224:227], v[100:103]
    v_exp_f32 v245, v173
    v_mfma_f32_16x16x32_bf16 v[100:103], a[156:159], v[228:231], v[100:103]
    ds_read_b64_tr_b16 a[108:109], v8 offset:8736
    v_cvt_pk_bf16_f32 v214, v244, v245
    v_mfma_f32_16x16x32_bf16 v[104:107], a[160:163], v[224:227], v[104:107]
    v_exp_f32 v246, v174
    v_mfma_f32_16x16x32_bf16 v[104:107], a[164:167], v[228:231], v[104:107]
    ds_read_b64_tr_b16 a[110:111], v8 offset:12960
    v_or3_b32 v11, v11, v213, v214
    v_mfma_f32_16x16x32_bf16 v[108:111], a[168:171], v[224:227], v[108:111]
    v_exp_f32 v247, v175
    v_mfma_f32_16x16x32_bf16 v[108:111], a[172:175], v[228:231], v[108:111]
    ds_read_b64_tr_b16 a[144:145], v8 offset:512
    v_cvt_pk_bf16_f32 v215, v246, v247
    v_mfma_f32_16x16x32_bf16 a[248:251], a[252:255], v[224:227], a[248:251]
    v_bitop3_b32 v11, v11, v215, s47 bitop3:0xa8
    v_cmp_ne_u32 vcc, 0, v11
    v_mfma_f32_16x16x32_bf16 a[248:251], a[252:255], v[228:231], a[248:251]
    ds_read_b64_tr_b16 a[146:147], v8 offset:4736
    ds_read_b64_tr_b16 a[148:149], v8 offset:8960
    v_mfma_f32_16x16x32_bf16 v[192:195], a[176:179], v[144:147], v[240:243]
    v_exp_f32 v244, v176
    v_mfma_f32_16x16x32_bf16 v[192:195], a[180:183], v[148:151], v[192:195]
    ds_read_b64_tr_b16 a[150:151], v8 offset:13184
    s_cbranch_vccnz L_st2_0
L_bk2_0:
    v_mfma_f32_16x16x32_bf16 v[192:195], a[184:187], v[152:155], v[192:195]
    v_exp_f32 v245, v177
    s_add_u32 m0, s52, 50752
    v_mfma_f32_16x16x32_bf16 v[192:195], a[188:191], v[156:159], v[192:195]
    buffer_load_dwordx4 v2, s[28:31], s49 offen offset:2048 nt lds
    v_cvt_pk_bf16_f32 v216, v244, v245
    v_mfma_f32_16x16x32_bf16 v[196:199], a[192:195], v[144:147], v[240:243]
    v_exp_f32 v246, v178
    v_mfma_f32_16x16x32_bf16 v[196:199], a[196:199], v[148:151], v[196:199]
    ds_read_b64_tr_b16 a[152:153], v8 offset:544
    ds_read_b64_tr_b16 a[154:155], v8 offset:4768
    v_mfma_f32_16x16x32_bf16 v[196:199], a[200:203], v[152:155], v[196:199]
    v_exp_f32 v247, v179
    v_mfma_f32_16x16x32_bf16 v[196:199], a[204:207], v[156:159], v[196:199]
    ds_read_b64_tr_b16 a[156:157], v8 offset:8992
    v_cvt_pk_bf16_f32 v217, v246, v247
    v_mfma_f32_16x16x32_bf16 v[200:203], a[208:211], v[144:147], v[240:243]
    v_exp_f32 v244, v180
    v_mfma_f32_16x16x32_bf16 v[200:203], a[212:215], v[148:151], v[200:203]
    ds_read_b64_tr_b16 a[158:159], v8 offset:13216
    ds_read_b64_tr_b16 a[160:161], v8 offset:768
    v_mfma_f32_16x16x32_bf16 v[200:203], a[216:219], v[152:155], v[200:203]
    v_exp_f32 v245, v181
    v_mfma_f32_16x16x32_bf16 v[200:203], a[220:223], v[156:159], v[200:203]
    ds_read_b64_tr_b16 a[162:163], v8 offset:4992
    v_cvt_pk_bf16_f32 v218, v244, v245
    v_mfma_f32_16x16x32_bf16 v[204:207], a[224:227], v[144:147], v[240:243]
    v_exp_f32 v246, v182
    v_mfma_f32_16x16x32_bf16 v[204:207], a[228:231], v[148:151], v[204:207]
    ds_read_b64_tr_b16 a[164:165], v8 offset:9216
    v_or3_b32 v11, v216, v217, v218
    v_mfma_f32_16x16x32_bf16 v[204:207], a[232:235], v[152:155], v[204:207]
    v_exp_f32 v247, v183
    s_add_u32 m0, s52, 50784
    v_mfma_f32_16x16x32_bf16 v[204:207], a[236:239], v[156:159], v[204:207]
    buffer_load_dwordx4 v2, s[28:31], s49 offen offset:3072 nt lds
    v_cvt_pk_bf16_f32 v219, v246, v247
    s_waitcnt lgkmcnt(11)
    v_mfma_f32_16x16x32_bf16 v[16:19], a[80:83], v[208:211], v[16:19]
    v_exp_f32 v244, v184
    v_mfma_f32_16x16x32_bf16 v[16:19], a[84:87], v[212:215], v[16:19]
    ds_read_b64_tr_b16 a[166:167], v8 offset:13440
    ds_read_b64_tr_b16 a[168:169], v8 offset:800
    v_mfma_f32_16x16x32_bf16 v[20:23], a[88:91], v[208:211], v[20:23]
    v_exp_f32 v245, v185
    v_mfma_f32_16x16x32_bf16 v[20:23], a[92:95], v[212:215], v[20:23]
    ds_read_b64_tr_b16 a[170:171], v8 offset:5024
    v_cvt_pk_bf16_f32 v220, v244, v245
    v_mfma_f32_16x16x32_bf16 v[24:27], a[96:99], v[208:211], v[24:27]
    ds_read_b64_tr_b16 a[172:173], v8 offset:9248
    ds_read_b64_tr_b16 a[174:175], v8 offset:13472
    v_exp_f32 v246, v186
    v_mfma_f32_16x16x32_bf16 v[24:27], a[100:103], v[212:215], v[24:27]
    ds_read_b128 a[176:179], v5 offset:0
    v_or3_b32 v11, v11, v219, v220
    v_mfma_f32_16x16x32_bf16 v[28:31], a[104:107], v[208:211], v[28:31]
    v_exp_f32 v247, v187
    v_mfma_f32_16x16x32_bf16 v[28:31], a[108:111], v[212:215], v[28:31]
    ds_read_b128 a[180:183], v5 offset:256
    v_cvt_pk_bf16_f32 v221, v246, v247
    s_waitcnt lgkmcnt(10)
    v_mfma_f32_16x16x32_bf16 v[32:35], a[144:147], v[208:211], v[32:35]
    v_exp_f32 v244, v188
    v_mfma_f32_16x16x32_bf16 v[32:35], a[148:151], v[212:215], v[32:35]
    ds_read_b128 a[184:187], v5 offset:512
    ds_read_b128 a[188:191], v5 offset:768
    v_mfma_f32_16x16x32_bf16 v[36:39], a[152:155], v[208:211], v[36:39]
    v_exp_f32 v245, v189
    s_add_u32 m0, s52, 67584
    s_mov_b32 s49, 81920
    v_mfma_f32_16x16x32_bf16 v[36:39], a[156:159], v[212:215], v[36:39]
    buffer_load_dwordx4 v2, s[24:27], s49 offen offset:0 nt lds
    v_cvt_pk_bf16_f32 v222, v244, v245
    s_waitcnt lgkmcnt(4)
    v_mfma_f32_16x16x32_bf16 v[40:43], a[160:163], v[208:211], v[40:43]
    v_exp_f32 v246, v190
    v_mfma_f32_16x16x32_bf16 v[40:43], a[164:167], v[212:215], v[40:43]
    ds_read_b128 a[192:195], v5 offset:4224
    v_or3_b32 v11, v11, v221, v222
    v_mfma_f32_16x16x32_bf16 v[44:47], a[168:171], v[208:211], v[44:47]
    ds_read_b128 a[196:199], v5 offset:4480
    ds_read_b128 a[200:203], v5 offset:4736
    ds_read_b128 a[204:207], v5 offset:4992
    v_exp_f32 v247, v191
    v_mfma_f32_16x16x32_bf16 v[44:47], a[172:175], v[212:215], v[44:47]
    ds_read_b128 a[208:211], v5 offset:8448
    v_cvt_pk_bf16_f32 v223, v246, v247
    v_mfma_f32_16x16x32_bf16 a[240:243], a[252:255], v[208:211], a[240:243]
    v_bitop3_b32 v11, v11, v223, s47 bitop3:0xa8
    v_cmp_ne_u32 vcc, 0, v11
    v_mfma_f32_16x16x32_bf16 a[240:243], a[252:255], v[212:215], a[240:243]
    ds_read_b128 a[212:215], v5 offset:8704
    ds_read_b128 a[216:219], v5 offset:8960
    s_waitcnt lgkmcnt(7)
    v_mfma_f32_16x16x32_bf16 v[160:163], a[176:179], v[112:115], v[232:235]
    ds_read_b128 a[220:223], v5 offset:9216
    v_exp_f32 v244, v192
    v_mfma_f32_16x16x32_bf16 v[160:163], a[180:183], v[116:119], v[160:163]
    ds_read_b128 a[224:227], v5 offset:12672
    s_cbranch_vccnz L_st2_1
L_bk2_1:
    v_mfma_f32_16x16x32_bf16 v[160:163], a[184:187], v[120:123], v[160:163]
    v_exp_f32 v245, v193
    v_mfma_f32_16x16x32_bf16 v[160:163], a[188:191], v[124:127], v[160:163]
    ds_read_b128 a[228:231], v5 offset:12928
    v_cvt_pk_bf16_f32 v224, v244, v245
    s_waitcnt lgkmcnt(6)
    v_mfma_f32_16x16x32_bf16 v[164:167], a[192:195], v[112:115], v[232:235]
    ds_read_b128 a[232:235], v5 offset:13184
    ds_read_b128 a[236:239], v5 offset:13440
    v_exp_f32 v246, v194
    v_mfma_f32_16x16x32_bf16 v[164:167], a[196:199], v[116:119], v[164:167]
    v_mfma_f32_16x16x32_bf16 v[164:167], a[200:203], v[120:123], v[164:167]
    v_exp_f32 v247, v195
    v_mfma_f32_16x16x32_bf16 v[164:167], a[204:207], v[124:127], v[164:167]
    v_cvt_pk_bf16_f32 v225, v246, v247
    s_waitcnt lgkmcnt(4)
    v_mfma_f32_16x16x32_bf16 v[168:171], a[208:211], v[112:115], v[232:235]
    v_exp_f32 v244, v196
    s_add_u32 m0, s52, 67616
    v_mfma_f32_16x16x32_bf16 v[168:171], a[212:215], v[116:119], v[168:171]
    buffer_load_dwordx4 v2, s[24:27], s49 offen offset:1024 nt lds
    v_mfma_f32_16x16x32_bf16 v[168:171], a[216:219], v[120:123], v[168:171]
    v_exp_f32 v245, v197
    v_mfma_f32_16x16x32_bf16 v[168:171], a[220:223], v[124:127], v[168:171]
    v_cvt_pk_bf16_f32 v226, v244, v245
    s_waitcnt lgkmcnt(0)
    v_mfma_f32_16x16x32_bf16 v[172:175], a[224:227], v[112:115], v[232:235]
    v_exp_f32 v246, v198
    v_mfma_f32_16x16x32_bf16 v[172:175], a[228:231], v[116:119], v[172:175]
    v_or3_b32 v11, v224, v225, v226
    v_mfma_f32_16x16x32_bf16 v[172:175], a[232:235], v[120:123], v[172:175]
    v_exp_f32 v247, v199
    v_mfma_f32_16x16x32_bf16 v[172:175], a[236:239], v[124:127], v[172:175]
    v_cvt_pk_bf16_f32 v227, v246, v247
    v_mfma_f32_16x16x32_bf16 v[48:51], a[80:83], v[216:219], v[48:51]
    v_exp_f32 v244, v200
    v_mfma_f32_16x16x32_bf16 v[48:51], a[84:87], v[220:223], v[48:51]
    v_mfma_f32_16x16x32_bf16 v[52:55], a[88:91], v[216:219], v[52:55]
    v_exp_f32 v245, v201
    s_add_u32 m0, s52, 67648
    v_mfma_f32_16x16x32_bf16 v[52:55], a[92:95], v[220:223], v[52:55]
    buffer_load_dwordx4 v2, s[24:27], s49 offen offset:2048 nt lds
    v_cvt_pk_bf16_f32 v228, v244, v245
    v_mfma_f32_16x16x32_bf16 v[56:59], a[96:99], v[216:219], v[56:59]
    v_exp_f32 v246, v202
    v_mfma_f32_16x16x32_bf16 v[56:59], a[100:103], v[220:223], v[56:59]
    v_or3_b32 v11, v11, v227, v228
    v_mfma_f32_16x16x32_bf16 v[60:63], a[104:107], v[216:219], v[60:63]
    v_exp_f32 v247, v203
    v_mfma_f32_16x16x32_bf16 v[60:63], a[108:111], v[220:223], v[60:63]
    v_cvt_pk_bf16_f32 v229, v246, v247
    v_mfma_f32_16x16x32_bf16 v[64:67], a[144:147], v[216:219], v[64:67]
    v_exp_f32 v244, v204
    v_mfma_f32_16x16x32_bf16 v[64:67], a[148:151], v[220:223], v[64:67]
    v_mfma_f32_16x16x32_bf16 v[68:71], a[152:155], v[216:219], v[68:71]
    v_exp_f32 v245, v205
    v_mfma_f32_16x16x32_bf16 v[68:71], a[156:159], v[220:223], v[68:71]
    v_cvt_pk_bf16_f32 v230, v244, v245
    v_mfma_f32_16x16x32_bf16 v[72:75], a[160:163], v[216:219], v[72:75]
    v_exp_f32 v246, v206
    s_add_u32 m0, s52, 67680
    v_mfma_f32_16x16x32_bf16 v[72:75], a[164:167], v[220:223], v[72:75]
    buffer_load_dwordx4 v2, s[24:27], s49 offen offset:3072 nt lds
    v_or3_b32 v11, v11, v229, v230
    v_mfma_f32_16x16x32_bf16 v[76:79], a[168:171], v[216:219], v[76:79]
    v_exp_f32 v247, v207
    v_mfma_f32_16x16x32_bf16 v[76:79], a[172:175], v[220:223], v[76:79]
    v_cvt_pk_bf16_f32 v231, v246, v247
    v_mfma_f32_16x16x32_bf16 a[244:247], a[252:255], v[216:219], a[244:247]
    v_bitop3_b32 v11, v11, v231, s47 bitop3:0xa8
    v_cmp_ne_u32 vcc, 0, v11
    v_mfma_f32_16x16x32_bf16 a[244:247], a[252:255], v[220:223], a[244:247]
    v_mfma_f32_16x16x32_bf16 v[176:179], a[176:179], v[128:131], v[236:239]
    v_exp_f32 v244, v160
    v_mfma_f32_16x16x32_bf16 v[176:179], a[180:183], v[132:135], v[176:179]
    s_cbranch_vccnz L_st2_2
L_bk2_2:
    v_mfma_f32_16x16x32_bf16 v[176:179], a[184:187], v[136:139], v[176:179]
    v_exp_f32 v245, v161
    s_waitcnt vmcnt(8)
    s_barrier
    v_mfma_f32_16x16x32_bf16 v[176:179], a[188:191], v[140:143], v[176:179]
    ds_read_b64_tr_b16 a[112:113], v7 offset:0
    v_cvt_pk_bf16_f32 v208, v244, v245
    v_mfma_f32_16x16x32_bf16 v[180:183], a[192:195], v[128:131], v[236:239]
    v_exp_f32 v246, v162
    v_mfma_f32_16x16x32_bf16 v[180:183], a[196:199], v[132:135], v[180:183]
    ds_read_b64_tr_b16 a[114:115], v7 offset:4224
    ds_read_b64_tr_b16 a[116:117], v7 offset:8448
    v_mfma_f32_16x16x32_bf16 v[180:183], a[200:203], v[136:139], v[180:183]
    v_exp_f32 v247, v163
    v_mfma_f32_16x16x32_bf16 v[180:183], a[204:207], v[140:143], v[180:183]
    ds_read_b64_tr_b16 a[118:119], v7 offset:12672
    v_cvt_pk_bf16_f32 v209, v246, v247
    v_mfma_f32_16x16x32_bf16 v[184:187], a[208:211], v[128:131], v[236:239]
    v_exp_f32 v244, v164
    v_mfma_f32_16x16x32_bf16 v[184:187], a[212:215], v[132:135], v[184:187]
    ds_read_b64_tr_b16 a[120:121], v7 offset:32
    ds_read_b64_tr_b16 a[122:123], v7 offset:4256
    v_mfma_f32_16x16x32_bf16 v[184:187], a[216:219], v[136:139], v[184:187]
    v_exp_f32 v245, v165
    s_add_u32 m0, s52, 84480
    s_mov_b32 s49, 81920
    v_mfma_f32_16x16x32_bf16 v[184:187], a[220:223], v[140:143], v[184:187]
    buffer_load_dwordx4 v2, s[28:31], s49 offen offset:0 nt lds
    v_cvt_pk_bf16_f32 v210, v244, v245
    v_mfma_f32_16x16x32_bf16 v[188:191], a[224:227], v[128:131], v[236:239]
    v_exp_f32 v246, v166
    v_mfma_f32_16x16x32_bf16 v[188:191], a[228:231], v[132:135], v[188:191]
    ds_read_b64_tr_b16 a[124:125], v7 offset:8480
    v_or3_b32 v11, v208, v209, v210
    v_mfma_f32_16x16x32_bf16 v[188:191], a[232:235], v[136:139], v[188:191]
    v_exp_f32 v247, v167
    v_mfma_f32_16x16x32_bf16 v[188:191], a[236:239], v[140:143], v[188:191]
    ds_read_b64_tr_b16 a[126:127], v7 offset:12704
    v_cvt_pk_bf16_f32 v211, v246, v247
    v_mfma_f32_16x16x32_bf16 v[80:83], a[80:83], v[224:227], v[80:83]
    v_exp_f32 v244, v168
    v_mfma_f32_16x16x32_bf16 v[80:83], a[84:87], v[228:231], v[80:83]
    ds_read_b64_tr_b16 a[128:129], v7 offset:256
    ds_read_b64_tr_b16 a[130:131], v7 offset:4480
    v_mfma_f32_16x16x32_bf16 v[84:87], a[88:91], v[224:227], v[84:87]
    v_exp_f32 v245, v169
    v_mfma_f32_16x16x32_bf16 v[84:87], a[92:95], v[228:231], v[84:87]
    ds_read_b64_tr_b16 a[132:133], v7 offset:8704
    v_cvt_pk_bf16_f32 v212, v244, v245
    v_mfma_f32_16x16x32_bf16 v[88:91], a[96:99], v[224:227], v[88:91]
    v_exp_f32 v246, v170
    v_mfma_f32_16x16x32_bf16 v[88:91], a[100:103], v[228:231], v[88:91]
    ds_read_b64_tr_b16 a[134:135], v7 offset:12928
    v_or3_b32 v11, v11, v211, v212
    v_mfma_f32_16x16x32_bf16 v[92:95], a[104:107], v[224:227], v[92:95]
    v_exp_f32 v247, v171
    s_add_u32 m0, s52, 84512
    v_mfma_f32_16x16x32_bf16 v[92:95], a[108:111], v[228:231], v[92:95]
    buffer_load_dwordx4 v2, s[28:31], s49 offen offset:1024 nt lds
    v_cvt_pk_bf16_f32 v213, v246, v247
    v_mfma_f32_16x16x32_bf16 v[96:99], a[144:147], v[224:227], v[96:99]
    v_exp_f32 v244, v172
    v_mfma_f32_16x16x32_bf16 v[96:99], a[148:151], v[228:231], v[96:99]
    ds_read_b64_tr_b16 a[136:137], v7 offset:288
    ds_read_b64_tr_b16 a[138:139], v7 offset:4512
    v_mfma_f32_16x16x32_bf16 v[100:103], a[152:155], v[224:227], v[100:103]
    v_exp_f32 v245, v173
    v_mfma_f32_16x16x32_bf16 v[100:103], a[156:159], v[228:231], v[100:103]
    ds_read_b64_tr_b16 a[140:141], v7 offset:8736
    v_cvt_pk_bf16_f32 v214, v244, v245
    v_mfma_f32_16x16x32_bf16 v[104:107], a[160:163], v[224:227], v[104:107]
    v_exp_f32 v246, v174
    v_mfma_f32_16x16x32_bf16 v[104:107], a[164:167], v[228:231], v[104:107]
    ds_read_b64_tr_b16 a[142:143], v7 offset:12960
    v_or3_b32 v11, v11, v213, v214
    v_mfma_f32_16x16x32_bf16 v[108:111], a[168:171], v[224:227], v[108:111]
    v_exp_f32 v247, v175
    v_mfma_f32_16x16x32_bf16 v[108:111], a[172:175], v[228:231], v[108:111]
    ds_read_b64_tr_b16 a[144:145], v7 offset:512
    v_cvt_pk_bf16_f32 v215, v246, v247
    v_mfma_f32_16x16x32_bf16 a[248:251], a[252:255], v[224:227], a[248:251]
    v_bitop3_b32 v11, v11, v215, s47 bitop3:0xa8
    v_cmp_ne_u32 vcc, 0, v11
    v_mfma_f32_16x16x32_bf16 a[248:251], a[252:255], v[228:231], a[248:251]
    ds_read_b64_tr_b16 a[146:147], v7 offset:4736
    ds_read_b64_tr_b16 a[148:149], v7 offset:8960
    v_mfma_f32_16x16x32_bf16 v[192:195], a[176:179], v[144:147], v[240:243]
    v_exp_f32 v244, v176
    v_mfma_f32_16x16x32_bf16 v[192:195], a[180:183], v[148:151], v[192:195]
    ds_read_b64_tr_b16 a[150:151], v7 offset:13184
    s_cbranch_vccnz L_st3_0
L_bk3_0:
    v_mfma_f32_16x16x32_bf16 v[192:195], a[184:187], v[152:155], v[192:195]
    v_exp_f32 v245, v177
    s_add_u32 m0, s52, 84544
    v_mfma_f32_16x16x32_bf16 v[192:195], a[188:191], v[156:159], v[192:195]
    buffer_load_dwordx4 v2, s[28:31], s49 offen offset:2048 nt lds
    v_cvt_pk_bf16_f32 v216, v244, v245
    v_mfma_f32_16x16x32_bf16 v[196:199], a[192:195], v[144:147], v[240:243]
    v_exp_f32 v246, v178
    v_mfma_f32_16x16x32_bf16 v[196:199], a[196:199], v[148:151], v[196:199]
    ds_read_b64_tr_b16 a[152:153], v7 offset:544
    ds_read_b64_tr_b16 a[154:155], v7 offset:4768
    v_mfma_f32_16x16x32_bf16 v[196:199], a[200:203], v[152:155], v[196:199]
    v_exp_f32 v247, v179
    v_mfma_f32_16x16x32_bf16 v[196:199], a[204:207], v[156:159], v[196:199]
    ds_read_b64_tr_b16 a[156:157], v7 offset:8992
    v_cvt_pk_bf16_f32 v217, v246, v247
    v_mfma_f32_16x16x32_bf16 v[200:203], a[208:211], v[144:147], v[240:243]
    v_exp_f32 v244, v180
    v_mfma_f32_16x16x32_bf16 v[200:203], a[212:215], v[148:151], v[200:203]
    ds_read_b64_tr_b16 a[158:159], v7 offset:13216
    ds_read_b64_tr_b16 a[160:161], v7 offset:768
    v_mfma_f32_16x16x32_bf16 v[200:203], a[216:219], v[152:155], v[200:203]
    v_exp_f32 v245, v181
    v_mfma_f32_16x16x32_bf16 v[200:203], a[220:223], v[156:159], v[200:203]
    ds_read_b64_tr_b16 a[162:163], v7 offset:4992
    v_cvt_pk_bf16_f32 v218, v244, v245
    v_mfma_f32_16x16x32_bf16 v[204:207], a[224:227], v[144:147], v[240:243]
    v_exp_f32 v246, v182
    v_mfma_f32_16x16x32_bf16 v[204:207], a[228:231], v[148:151], v[204:207]
    ds_read_b64_tr_b16 a[164:165], v7 offset:9216
    v_or3_b32 v11, v216, v217, v218
    v_mfma_f32_16x16x32_bf16 v[204:207], a[232:235], v[152:155], v[204:207]
    v_exp_f32 v247, v183
    s_add_u32 m0, s52, 84576
    v_mfma_f32_16x16x32_bf16 v[204:207], a[236:239], v[156:159], v[204:207]
    buffer_load_dwordx4 v2, s[28:31], s49 offen offset:3072 nt lds
    v_cvt_pk_bf16_f32 v219, v246, v247
    s_waitcnt lgkmcnt(11)
    v_mfma_f32_16x16x32_bf16 v[16:19], a[112:115], v[208:211], v[16:19]
    v_exp_f32 v244, v184
    v_mfma_f32_16x16x32_bf16 v[16:19], a[116:119], v[212:215], v[16:19]
    ds_read_b64_tr_b16 a[166:167], v7 offset:13440
    ds_read_b64_tr_b16 a[168:169], v7 offset:800
    v_mfma_f32_16x16x32_bf16 v[20:23], a[120:123], v[208:211], v[20:23]
    v_exp_f32 v245, v185
    v_mfma_f32_16x16x32_bf16 v[20:23], a[124:127], v[212:215], v[20:23]
    ds_read_b64_tr_b16 a[170:171], v7 offset:5024
    v_cvt_pk_bf16_f32 v220, v244, v245
    v_mfma_f32_16x16x32_bf16 v[24:27], a[128:131], v[208:211], v[24:27]
    ds_read_b64_tr_b16 a[172:173], v7 offset:9248
    ds_read_b64_tr_b16 a[174:175], v7 offset:13472
    v_exp_f32 v246, v186
    v_mfma_f32_16x16x32_bf16 v[24:27], a[132:135], v[212:215], v[24:27]
    ds_read_b128 a[176:179], v5 offset:33792
    v_or3_b32 v11, v11, v219, v220
    v_mfma_f32_16x16x32_bf16 v[28:31], a[136:139], v[208:211], v[28:31]
    v_exp_f32 v247, v187
    v_mfma_f32_16x16x32_bf16 v[28:31], a[140:143], v[212:215], v[28:31]
    ds_read_b128 a[180:183], v5 offset:34048
    v_cvt_pk_bf16_f32 v221, v246, v247
    s_waitcnt lgkmcnt(10)
    v_mfma_f32_16x16x32_bf16 v[32:35], a[144:147], v[208:211], v[32:35]
    v_exp_f32 v244, v188
    v_mfma_f32_16x16x32_bf16 v[32:35], a[148:151], v[212:215], v[32:35]
    ds_read_b128 a[184:187], v5 offset:34304
    ds_read_b128 a[188:191], v5 offset:34560
    v_mfma_f32_16x16x32_bf16 v[36:39], a[152:155], v[208:211], v[36:39]
    v_exp_f32 v245, v189
    s_add_u32 m0, s52, 0
    s_mov_b32 s49, 98304
    v_mfma_f32_16x16x32_bf16 v[36:39], a[156:159], v[212:215], v[36:39]
    buffer_load_dwordx4 v2, s[24:27], s49 offen offset:0 nt lds
    v_cvt_pk_bf16_f32 v222, v244, v245
    s_waitcnt lgkmcnt(4)
    v_mfma_f32_16x16x32_bf16 v[40:43], a[160:163], v[208:211], v[40:43]
    v_exp_f32 v246, v190
    v_mfma_f32_16x16x32_bf16 v[40:43], a[164:167], v[212:215], v[40:43]
    ds_read_b128 a[192:195], v5 offset:38016
    v_or3_b32 v11, v11, v221, v222
    v_mfma_f32_16x16x32_bf16 v[44:47], a[168:171], v[208:211], v[44:47]
    ds_read_b128 a[196:199], v5 offset:38272
    ds_read_b128 a[200:203], v5 offset:38528
    ds_read_b128 a[204:207], v5 offset:38784
    v_exp_f32 v247, v191
    v_mfma_f32_16x16x32_bf16 v[44:47], a[172:175], v[212:215], v[44:47]
    ds_read_b128 a[208:211], v5 offset:42240
    v_cvt_pk_bf16_f32 v223, v246, v247
    v_mfma_f32_16x16x32_bf16 a[240:243], a[252:255], v[208:211], a[240:243]
    v_bitop3_b32 v11, v11, v223, s47 bitop3:0xa8
    v_cmp_ne_u32 vcc, 0, v11
    v_mfma_f32_16x16x32_bf16 a[240:243], a[252:255], v[212:215], a[240:243]
    ds_read_b128 a[212:215], v5 offset:42496
    ds_read_b128 a[216:219], v5 offset:42752
    s_waitcnt lgkmcnt(7)
    v_mfma_f32_16x16x32_bf16 v[160:163], a[176:179], v[112:115], v[232:235]
    ds_read_b128 a[220:223], v5 offset:43008
    v_exp_f32 v244, v192
    v_mfma_f32_16x16x32_bf16 v[160:163], a[180:183], v[116:119], v[160:163]
    ds_read_b128 a[224:227], v5 offset:46464
    s_cbranch_vccnz L_st3_1
L_bk3_1:
    v_mfma_f32_16x16x32_bf16 v[160:163], a[184:187], v[120:123], v[160:163]
    v_exp_f32 v245, v193
    v_mfma_f32_16x16x32_bf16 v[160:163], a[188:191], v[124:127], v[160:163]
    ds_read_b128 a[228:231], v5 offset:46720
    v_cvt_pk_bf16_f32 v224, v244, v245
    s_waitcnt lgkmcnt(6)
    v_mfma_f32_16x16x32_bf16 v[164:167], a[192:195], v[112:115], v[232:235]
    ds_read_b128 a[232:235], v5 offset:46976
    ds_read_b128 a[236:239], v5 offset:47232
    v_exp_f32 v246, v194
    v_mfma_f32_16x16x32_bf16 v[164:167], a[196:199], v[116:119], v[164:167]
    v_mfma_f32_16x16x32_bf16 v[164:167], a[200:203], v[120:123], v[164:167]
    v_exp_f32 v247, v195
    v_mfma_f32_16x16x32_bf16 v[164:167], a[204:207], v[124:127], v[164:167]
    v_cvt_pk_bf16_f32 v225, v246, v247
    s_waitcnt lgkmcnt(4)
    v_mfma_f32_16x16x32_bf16 v[168:171], a[208:211], v[112:115], v[232:235]
    v_exp_f32 v244, v196
    s_add_u32 m0, s52, 32
    v_mfma_f32_16x16x32_bf16 v[168:171], a[212:215], v[116:119], v[168:171]
    buffer_load_dwordx4 v2, s[24:27], s49 offen offset:1024 nt lds
    v_mfma_f32_16x16x32_bf16 v[168:171], a[216:219], v[120:123], v[168:171]
    v_exp_f32 v245, v197
    v_mfma_f32_16x16x32_bf16 v[168:171], a[220:223], v[124:127], v[168:171]
    v_cvt_pk_bf16_f32 v226, v244, v245
    s_waitcnt lgkmcnt(0)
    v_mfma_f32_16x16x32_bf16 v[172:175], a[224:227], v[112:115], v[232:235]
    v_exp_f32 v246, v198
    v_mfma_f32_16x16x32_bf16 v[172:175], a[228:231], v[116:119], v[172:175]
    v_or3_b32 v11, v224, v225, v226
    v_mfma_f32_16x16x32_bf16 v[172:175], a[232:235], v[120:123], v[172:175]
    v_exp_f32 v247, v199
    v_mfma_f32_16x16x32_bf16 v[172:175], a[236:239], v[124:127], v[172:175]
    v_cvt_pk_bf16_f32 v227, v246, v247
    v_mfma_f32_16x16x32_bf16 v[48:51], a[112:115], v[216:219], v[48:51]
    v_exp_f32 v244, v200
    v_mfma_f32_16x16x32_bf16 v[48:51], a[116:119], v[220:223], v[48:51]
    v_mfma_f32_16x16x32_bf16 v[52:55], a[120:123], v[216:219], v[52:55]
    v_exp_f32 v245, v201
    s_add_u32 m0, s52, 64
    v_mfma_f32_16x16x32_bf16 v[52:55], a[124:127], v[220:223], v[52:55]
    buffer_load_dwordx4 v2, s[24:27], s49 offen offset:2048 nt lds
    v_cvt_pk_bf16_f32 v228, v244, v245
    v_mfma_f32_16x16x32_bf16 v[56:59], a[128:131], v[216:219], v[56:59]
    v_exp_f32 v246, v202
    v_mfma_f32_16x16x32_bf16 v[56:59], a[132:135], v[220:223], v[56:59]
    v_or3_b32 v11, v11, v227, v228
    v_mfma_f32_16x16x32_bf16 v[60:63], a[136:139], v[216:219], v[60:63]
    v_exp_f32 v247, v203
    v_mfma_f32_16x16x32_bf16 v[60:63], a[140:143], v[220:223], v[60:63]
    v_cvt_pk_bf16_f32 v229, v246, v247
    v_mfma_f32_16x16x32_bf16 v[64:67], a[144:147], v[216:219], v[64:67]
    v_exp_f32 v244, v204
    v_mfma_f32_16x16x32_bf16 v[64:67], a[148:151], v[220:223], v[64:67]
    v_mfma_f32_16x16x32_bf16 v[68:71], a[152:155], v[216:219], v[68:71]
    v_exp_f32 v245, v205
    v_mfma_f32_16x16x32_bf16 v[68:71], a[156:159], v[220:223], v[68:71]
    v_cvt_pk_bf16_f32 v230, v244, v245
    v_mfma_f32_16x16x32_bf16 v[72:75], a[160:163], v[216:219], v[72:75]
    v_exp_f32 v246, v206
    s_add_u32 m0, s52, 96
    v_mfma_f32_16x16x32_bf16 v[72:75], a[164:167], v[220:223], v[72:75]
    buffer_load_dwordx4 v2, s[24:27], s49 offen offset:3072 nt lds
    v_or3_b32 v11, v11, v229, v230
    v_mfma_f32_16x16x32_bf16 v[76:79], a[168:171], v[216:219], v[76:79]
    v_exp_f32 v247, v207
    v_mfma_f32_16x16x32_bf16 v[76:79], a[172:175], v[220:223], v[76:79]
    v_cvt_pk_bf16_f32 v231, v246, v247
    v_mfma_f32_16x16x32_bf16 a[244:247], a[252:255], v[216:219], a[244:247]
    v_bitop3_b32 v11, v11, v231, s47 bitop3:0xa8
    v_cmp_ne_u32 vcc, 0, v11
    v_mfma_f32_16x16x32_bf16 a[244:247], a[252:255], v[220:223], a[244:247]
    v_mfma_f32_16x16x32_bf16 v[176:179], a[176:179], v[128:131], v[236:239]
    v_exp_f32 v244, v160
    v_mfma_f32_16x16x32_bf16 v[176:179], a[180:183], v[132:135], v[176:179]
    s_cbranch_vccnz L_st3_2
L_bk3_2:
    v_mfma_f32_16x16x32_bf16 v[176:179], a[184:187], v[136:139], v[176:179]
    v_exp_f32 v245, v161
    s_waitcnt vmcnt(8)
    s_barrier
    v_mfma_f32_16x16x32_bf16 v[176:179], a[188:191], v[140:143], v[176:179]
    ds_read_b64_tr_b16 a[80:81], v7 offset:33792
    v_cvt_pk_bf16_f32 v208, v244, v245
    v_mfma_f32_16x16x32_bf16 v[180:183], a[192:195], v[128:131], v[236:239]
    v_exp_f32 v246, v162
    v_mfma_f32_16x16x32_bf16 v[180:183], a[196:199], v[132:135], v[180:183]
    ds_read_b64_tr_b16 a[82:83], v7 offset:38016
    ds_read_b64_tr_b16 a[84:85], v7 offset:42240
    v_mfma_f32_16x16x32_bf16 v[180:183], a[200:203], v[136:139], v[180:183]
    v_exp_f32 v247, v163
    v_mfma_f32_16x16x32_bf16 v[180:183], a[204:207], v[140:143], v[180:183]
    ds_read_b64_tr_b16 a[86:87], v7 offset:46464
    v_cvt_pk_bf16_f32 v209, v246, v247
    v_mfma_f32_16x16x32_bf16 v[184:187], a[208:211], v[128:131], v[236:239]
    v_exp_f32 v244, v164
    v_mfma_f32_16x16x32_bf16 v[184:187], a[212:215], v[132:135], v[184:187]
    ds_read_b64_tr_b16 a[88:89], v7 offset:33824
    ds_read_b64_tr_b16 a[90:91], v7 offset:38048
    v_mfma_f32_16x16x32_bf16 v[184:187], a[216:219], v[136:139], v[184:187]
    v_exp_f32 v245, v165
    s_add_u32 m0, s52, 16896
    s_mov_b32 s49, 98304
    v_mfma_f32_16x16x32_bf16 v[184:187], a[220:223], v[140:143], v[184:187]
    buffer_load_dwordx4 v2, s[28:31], s49 offen offset:0 nt lds
    v_cvt_pk_bf16_f32 v210, v244, v245
    v_mfma_f32_16x16x32_bf16 v[188:191], a[224:227], v[128:131], v[236:239]
    v_exp_f32 v246, v166
    v_mfma_f32_16x16x32_bf16 v[188:191], a[228:231], v[132:135], v[188:191]
    ds_read_b64_tr_b16 a[92:93], v7 offset:42272
    v_or3_b32 v11, v208, v209, v210
    v_mfma_f32_16x16x32_bf16 v[188:191], a[232:235], v[136:139], v[188:191]
    v_exp_f32 v247, v167
    v_mfma_f32_16x16x32_bf16 v[188:191], a[236:239], v[140:143], v[188:191]
    ds_read_b64_tr_b16 a[94:95], v7 offset:46496
    v_cvt_pk_bf16_f32 v211, v246, v247
    v_mfma_f32_16x16x32_bf16 v[80:83], a[112:115], v[224:227], v[80:83]
    v_exp_f32 v244, v168
    v_mfma_f32_16x16x32_bf16 v[80:83], a[116:119], v[228:231], v[80:83]
    ds_read_b64_tr_b16 a[96:97], v7 offset:34048
    ds_read_b64_tr_b16 a[98:99], v7 offset:38272
    v_mfma_f32_16x16x32_bf16 v[84:87], a[120:123], v[224:227], v[84:87]
    v_exp_f32 v245, v169
    v_mfma_f32_16x16x32_bf16 v[84:87], a[124:127], v[228:231], v[84:87]
    ds_read_b64_tr_b16 a[100:101], v7 offset:42496
    v_cvt_pk_bf16_f32 v212, v244, v245
    v_mfma_f32_16x16x32_bf16 v[88:91], a[128:131], v[224:227], v[88:91]
    v_exp_f32 v246, v170
    v_mfma_f32_16x16x32_bf16 v[88:91], a[132:135], v[228:231], v[88:91]
    ds_read_b64_tr_b16 a[102:103], v7 offset:46720
    v_or3_b32 v11, v11, v211, v212
    v_mfma_f32_16x16x32_bf16 v[92:95], a[136:139], v[224:227], v[92:95]
    v_exp_f32 v247, v171
    s_add_u32 m0, s52, 16928
    v_mfma_f32_16x16x32_bf16 v[92:95], a[140:143], v[228:231], v[92:95]
    buffer_load_dwordx4 v2, s[28:31], s49 offen offset:1024 nt lds
    v_cvt_pk_bf16_f32 v213, v246, v247
    v_mfma_f32_16x16x32_bf16 v[96:99], a[144:147], v[224:227], v[96:99]
    v_exp_f32 v244, v172
    v_mfma_f32_16x16x32_bf16 v[96:99], a[148:151], v[228:231], v[96:99]
    ds_read_b64_tr_b16 a[104:105], v7 offset:34080
    ds_read_b64_tr_b16 a[106:107], v7 offset:38304
    v_mfma_f32_16x16x32_bf16 v[100:103], a[152:155], v[224:227], v[100:103]
    v_exp_f32 v245, v173
    v_mfma_f32_16x16x32_bf16 v[100:103], a[156:159], v[228:231], v[100:103]
    ds_read_b64_tr_b16 a[108:109], v7 offset:42528
    v_cvt_pk_bf16_f32 v214, v244, v245
    v_mfma_f32_16x16x32_bf16 v[104:107], a[160:163], v[224:227], v[104:107]
    v_exp_f32 v246, v174
    v_mfma_f32_16x16x32_bf16 v[104:107], a[164:167], v[228:231], v[104:107]
    ds_read_b64_tr_b16 a[110:111], v7 offset:46752
    v_or3_b32 v11, v11, v213, v214
    v_mfma_f32_16x16x32_bf16 v[108:111], a[168:171], v[224:227], v[108:111]
    v_exp_f32 v247, v175
    v_mfma_f32_16x16x32_bf16 v[108:111], a[172:175], v[228:231], v[108:111]
    ds_read_b64_tr_b16 a[144:145], v7 offset:34304
    v_cvt_pk_bf16_f32 v215, v246, v247
    v_mfma_f32_16x16x32_bf16 a[248:251], a[252:255], v[224:227], a[248:251]
    v_bitop3_b32 v11, v11, v215, s47 bitop3:0xa8
    v_cmp_ne_u32 vcc, 0, v11
    v_mfma_f32_16x16x32_bf16 a[248:251], a[252:255], v[228:231], a[248:251]
    ds_read_b64_tr_b16 a[146:147], v7 offset:38528
    ds_read_b64_tr_b16 a[148:149], v7 offset:42752
    v_mfma_f32_16x16x32_bf16 v[192:195], a[176:179], v[144:147], v[240:243]
    v_exp_f32 v244, v176
    v_mfma_f32_16x16x32_bf16 v[192:195], a[180:183], v[148:151], v[192:195]
    ds_read_b64_tr_b16 a[150:151], v7 offset:46976
    s_cbranch_vccnz L_st4_0
L_bk4_0:
    v_mfma_f32_16x16x32_bf16 v[192:195], a[184:187], v[152:155], v[192:195]
    v_exp_f32 v245, v177
    s_add_u32 m0, s52, 16960
    v_mfma_f32_16x16x32_bf16 v[192:195], a[188:191], v[156:159], v[192:195]
    buffer_load_dwordx4 v2, s[28:31], s49 offen offset:2048 nt lds
    v_cvt_pk_bf16_f32 v216, v244, v245
    v_mfma_f32_16x16x32_bf16 v[196:199], a[192:195], v[144:147], v[240:243]
    v_exp_f32 v246, v178
    v_mfma_f32_16x16x32_bf16 v[196:199], a[196:199], v[148:151], v[196:199]
    ds_read_b64_tr_b16 a[152:153], v7 offset:34336
    ds_read_b64_tr_b16 a[154:155], v7 offset:38560
    v_mfma_f32_16x16x32_bf16 v[196:199], a[200:203], v[152:155], v[196:199]
    v_exp_f32 v247, v179
    v_mfma_f32_16x16x32_bf16 v[196:199], a[204:207], v[156:159], v[196:199]
    ds_read_b64_tr_b16 a[156:157], v7 offset:42784
    v_cvt_pk_bf16_f32 v217, v246, v247
    v_mfma_f32_16x16x32_bf16 v[200:203], a[208:211], v[144:147], v[240:243]
    v_exp_f32 v244, v180
    v_mfma_f32_16x16x32_bf16 v[200:203], a[212:215], v[148:151], v[200:203]
    ds_read_b64_tr_b16 a[158:159], v7 offset:47008
    ds_read_b64_tr_b16 a[160:161], v7 offset:34560
    v_mfma_f32_16x16x32_bf16 v[200:203], a[216:219], v[152:155], v[200:203]
    v_exp_f32 v245, v181
    v_mfma_f32_16x16x32_bf16 v[200:203], a[220:223], v[156:159], v[200:203]
    ds_read_b64_tr_b16 a[162:163], v7 offset:38784
    v_cvt_pk_bf16_f32 v218, v244, v245
    v_mfma_f32_16x16x32_bf16 v[204:207], a[224:227], v[144:147], v[240:243]
    v_exp_f32 v246, v182
    v_mfma_f32_16x16x32_bf16 v[204:207], a[228:231], v[148:151], v[204:207]
    ds_read_b64_tr_b16 a[164:165], v7 offset:43008
    v_or3_b32 v11, v216, v217, v218
    v_mfma_f32_16x16x32_bf16 v[204:207], a[232:235], v[152:155], v[204:207]
    v_exp_f32 v247, v183
    s_add_u32 m0, s52, 16992
    v_mfma_f32_16x16x32_bf16 v[204:207], a[236:239], v[156:159], v[204:207]
    buffer_load_dwordx4 v2, s[28:31], s49 offen offset:3072 nt lds
    v_cvt_pk_bf16_f32 v219, v246, v247
    s_waitcnt lgkmcnt(11)
    v_mfma_f32_16x16x32_bf16 v[16:19], a[80:83], v[208:211], v[16:19]
    v_exp_f32 v244, v184
    v_mfma_f32_16x16x32_bf16 v[16:19], a[84:87], v[212:215], v[16:19]
    ds_read_b64_tr_b16 a[166:167], v7 offset:47232
    ds_read_b64_tr_b16 a[168:169], v7 offset:34592
    v_mfma_f32_16x16x32_bf16 v[20:23], a[88:91], v[208:211], v[20:23]
    v_exp_f32 v245, v185
    v_mfma_f32_16x16x32_bf16 v[20:23], a[92:95], v[212:215], v[20:23]
    ds_read_b64_tr_b16 a[170:171], v7 offset:38816
    v_cvt_pk_bf16_f32 v220, v244, v245
    v_mfma_f32_16x16x32_bf16 v[24:27], a[96:99], v[208:211], v[24:27]
    ds_read_b64_tr_b16 a[172:173], v7 offset:43040
    ds_read_b64_tr_b16 a[174:175], v7 offset:47264
    v_exp_f32 v246, v186
    v_mfma_f32_16x16x32_bf16 v[24:27], a[100:103], v[212:215], v[24:27]
    ds_read_b128 a[176:179], v6 offset:0
    v_or3_b32 v11, v11, v219, v220
    v_mfma_f32_16x16x32_bf16 v[28:31], a[104:107], v[208:211], v[28:31]
    v_exp_f32 v247, v187
    v_mfma_f32_16x16x32_bf16 v[28:31], a[108:111], v[212:215], v[28:31]
    ds_read_b128 a[180:183], v6 offset:256
    v_cvt_pk_bf16_f32 v221, v246, v247
    s_waitcnt lgkmcnt(10)
    v_mfma_f32_16x16x32_bf16 v[32:35], a[144:147], v[208:211], v[32:35]
    v_exp_f32 v244, v188
    v_mfma_f32_16x16x32_bf16 v[32:35], a[148:151], v[212:215], v[32:35]
    ds_read_b128 a[184:187], v6 offset:512
    ds_read_b128 a[188:191], v6 offset:768
    v_mfma_f32_16x16x32_bf16 v[36:39], a[152:155], v[208:211], v[36:39]
    v_exp_f32 v245, v189
    s_add_u32 m0, s52, 33792
    s_mov_b32 s49, 114688
    v_mfma_f32_16x16x32_bf16 v[36:39], a[156:159], v[212:215], v[36:39]
    buffer_load_dwordx4 v2, s[24:27], s49 offen offset:0 nt lds
    v_cvt_pk_bf16_f32 v222, v244, v245
    s_waitcnt lgkmcnt(4)
    v_mfma_f32_16x16x32_bf16 v[40:43], a[160:163], v[208:211], v[40:43]
    v_exp_f32 v246, v190
    v_mfma_f32_16x16x32_bf16 v[40:43], a[164:167], v[212:215], v[40:43]
    ds_read_b128 a[192:195], v6 offset:4224
    v_or3_b32 v11, v11, v221, v222
    v_mfma_f32_16x16x32_bf16 v[44:47], a[168:171], v[208:211], v[44:47]
    ds_read_b128 a[196:199], v6 offset:4480
    ds_read_b128 a[200:203], v6 offset:4736
    ds_read_b128 a[204:207], v6 offset:4992
    v_exp_f32 v247, v191
    v_mfma_f32_16x16x32_bf16 v[44:47], a[172:175], v[212:215], v[44:47]
    ds_read_b128 a[208:211], v6 offset:8448
    v_cvt_pk_bf16_f32 v223, v246, v247
    v_mfma_f32_16x16x32_bf16 a[240:243], a[252:255], v[208:211], a[240:243]
    v_bitop3_b32 v11, v11, v223, s47 bitop3:0xa8
    v_cmp_ne_u32 vcc, 0, v11
    v_mfma_f32_16x16x32_bf16 a[240:243], a[252:255], v[212:215], a[240:243]
    ds_read_b128 a[212:215], v6 offset:8704
    ds_read_b128 a[216:219], v6 offset:8960
    s_waitcnt lgkmcnt(7)
    v_mfma_f32_16x16x32_bf16 v[160:163], a[176:179], v[112:115], v[232:235]
    ds_read_b128 a[220:223], v6 offset:9216
    v_exp_f32 v244, v192
    v_mfma_f32_16x16x32_bf16 v[160:163], a[180:183], v[116:119], v[160:163]
    ds_read_b128 a[224:227], v6 offset:12672
    s_cbranch_vccnz L_st4_1
L_bk4_1:
    v_mfma_f32_16x16x32_bf16 v[160:163], a[184:187], v[120:123], v[160:163]
    v_exp_f32 v245, v193
    v_mfma_f32_16x16x32_bf16 v[160:163], a[188:191], v[124:127], v[160:163]
    ds_read_b128 a[228:231], v6 offset:12928
    v_cvt_pk_bf16_f32 v224, v244, v245
    s_waitcnt lgkmcnt(6)
    v_mfma_f32_16x16x32_bf16 v[164:167], a[192:195], v[112:115], v[232:235]
    ds_read_b128 a[232:235], v6 offset:13184
    ds_read_b128 a[236:239], v6 offset:13440
    v_exp_f32 v246, v194
    v_mfma_f32_16x16x32_bf16 v[164:167], a[196:199], v[116:119], v[164:167]
    v_mfma_f32_16x16x32_bf16 v[164:167], a[200:203], v[120:123], v[164:167]
    v_exp_f32 v247, v195
    v_mfma_f32_16x16x32_bf16 v[164:167], a[204:207], v[124:127], v[164:167]
    v_cvt_pk_bf16_f32 v225, v246, v247
    s_waitcnt lgkmcnt(4)
    v_mfma_f32_16x16x32_bf16 v[168:171], a[208:211], v[112:115], v[232:235]
    v_exp_f32 v244, v196
    s_add_u32 m0, s52, 33824
    v_mfma_f32_16x16x32_bf16 v[168:171], a[212:215], v[116:119], v[168:171]
    buffer_load_dwordx4 v2, s[24:27], s49 offen offset:1024 nt lds
    v_mfma_f32_16x16x32_bf16 v[168:171], a[216:219], v[120:123], v[168:171]
    v_exp_f32 v245, v197
    v_mfma_f32_16x16x32_bf16 v[168:171], a[220:223], v[124:127], v[168:171]
    v_cvt_pk_bf16_f32 v226, v244, v245
    s_waitcnt lgkmcnt(0)
    v_mfma_f32_16x16x32_bf16 v[172:175], a[224:227], v[112:115], v[232:235]
    v_exp_f32 v246, v198
    v_mfma_f32_16x16x32_bf16 v[172:175], a[228:231], v[116:119], v[172:175]
    v_or3_b32 v11, v224, v225, v226
    v_mfma_f32_16x16x32_bf16 v[172:175], a[232:235], v[120:123], v[172:175]
    v_exp_f32 v247, v199
    v_mfma_f32_16x16x32_bf16 v[172:175], a[236:239], v[124:127], v[172:175]
    v_cvt_pk_bf16_f32 v227, v246, v247
    v_mfma_f32_16x16x32_bf16 v[48:51], a[80:83], v[216:219], v[48:51]
    v_exp_f32 v244, v200
    v_mfma_f32_16x16x32_bf16 v[48:51], a[84:87], v[220:223], v[48:51]
    v_mfma_f32_16x16x32_bf16 v[52:55], a[88:91], v[216:219], v[52:55]
    v_exp_f32 v245, v201
    s_add_u32 m0, s52, 33856
    v_mfma_f32_16x16x32_bf16 v[52:55], a[92:95], v[220:223], v[52:55]
    buffer_load_dwordx4 v2, s[24:27], s49 offen offset:2048 nt lds
    v_cvt_pk_bf16_f32 v228, v244, v245
    v_mfma_f32_16x16x32_bf16 v[56:59], a[96:99], v[216:219], v[56:59]
    v_exp_f32 v246, v202
    v_mfma_f32_16x16x32_bf16 v[56:59], a[100:103], v[220:223], v[56:59]
    v_or3_b32 v11, v11, v227, v228
    v_mfma_f32_16x16x32_bf16 v[60:63], a[104:107], v[216:219], v[60:63]
    v_exp_f32 v247, v203
    v_mfma_f32_16x16x32_bf16 v[60:63], a[108:111], v[220:223], v[60:63]
    v_cvt_pk_bf16_f32 v229, v246, v247
    v_mfma_f32_16x16x32_bf16 v[64:67], a[144:147], v[216:219], v[64:67]
    v_exp_f32 v244, v204
    v_mfma_f32_16x16x32_bf16 v[64:67], a[148:151], v[220:223], v[64:67]
    v_mfma_f32_16x16x32_bf16 v[68:71], a[152:155], v[216:219], v[68:71]
    v_exp_f32 v245, v205
    v_mfma_f32_16x16x32_bf16 v[68:71], a[156:159], v[220:223], v[68:71]
    v_cvt_pk_bf16_f32 v230, v244, v245
    v_mfma_f32_16x16x32_bf16 v[72:75], a[160:163], v[216:219], v[72:75]
    v_exp_f32 v246, v206
    s_add_u32 m0, s52, 33888
    v_mfma_f32_16x16x32_bf16 v[72:75], a[164:167], v[220:223], v[72:75]
    buffer_load_dwordx4 v2, s[24:27], s49 offen offset:3072 nt lds
    v_or3_b32 v11, v11, v229, v230
    v_mfma_f32_16x16x32_bf16 v[76:79], a[168:171], v[216:219], v[76:79]
    v_exp_f32 v247, v207
    v_mfma_f32_16x16x32_bf16 v[76:79], a[172:175], v[220:223], v[76:79]
    v_cvt_pk_bf16_f32 v231, v246, v247
    v_mfma_f32_16x16x32_bf16 a[244:247], a[252:255], v[216:219], a[244:247]
    v_bitop3_b32 v11, v11, v231, s47 bitop3:0xa8
    v_cmp_ne_u32 vcc, 0, v11
    v_mfma_f32_16x16x32_bf16 a[244:247], a[252:255], v[220:223], a[244:247]
    v_mfma_f32_16x16x32_bf16 v[176:179], a[176:179], v[128:131], v[236:239]
    v_exp_f32 v244, v160
    v_mfma_f32_16x16x32_bf16 v[176:179], a[180:183], v[132:135], v[176:179]
    s_cbranch_vccnz L_st4_2
L_bk4_2:
    v_mfma_f32_16x16x32_bf16 v[176:179], a[184:187], v[136:139], v[176:179]
    v_exp_f32 v245, v161
    s_waitcnt vmcnt(8)
    s_barrier
    v_mfma_f32_16x16x32_bf16 v[176:179], a[188:191], v[140:143], v[176:179]
    ds_read_b64_tr_b16 a[112:113], v8 offset:0
    v_cvt_pk_bf16_f32 v208, v244, v245
    v_mfma_f32_16x16x32_bf16 v[180:183], a[192:195], v[128:131], v[236:239]
    v_exp_f32 v246, v162
    v_mfma_f32_16x16x32_bf16 v[180:183], a[196:199], v[132:135], v[180:183]
    ds_read_b64_tr_b16 a[114:115], v8 offset:4224
    ds_read_b64_tr_b16 a[116:117], v8 offset:8448
    v_mfma_f32_16x16x32_bf16 v[180:183], a[200:203], v[136:139], v[180:183]
    v_exp_f32 v247, v163
    v_mfma_f32_16x16x32_bf16 v[180:183], a[204:207], v[140:143], v[180:183]
    ds_read_b64_tr_b16 a[118:119], v8 offset:12672
    v_cvt_pk_bf16_f32 v209, v246, v247
    v_mfma_f32_16x16x32_bf16 v[184:187], a[208:211], v[128:131], v[236:239]
    v_exp_f32 v244, v164
    v_mfma_f32_16x16x32_bf16 v[184:187], a[212:215], v[132:135], v[184:187]
    ds_read_b64_tr_b16 a[120:121], v8 offset:32
    ds_read_b64_tr_b16 a[122:123], v8 offset:4256
    v_mfma_f32_16x16x32_bf16 v[184:187], a[216:219], v[136:139], v[184:187]
    v_exp_f32 v245, v165
    s_add_u32 m0, s52, 50688
    s_mov_b32 s49, 114688
    v_mfma_f32_16x16x32_bf16 v[184:187], a[220:223], v[140:143], v[184:187]
    buffer_load_dwordx4 v2, s[28:31], s49 offen offset:0 nt lds
    v_cvt_pk_bf16_f32 v210, v244, v245
    v_mfma_f32_16x16x32_bf16 v[188:191], a[224:227], v[128:131], v[236:239]
    v_exp_f32 v246, v166
    v_mfma_f32_16x16x32_bf16 v[188:191], a[228:231], v[132:135], v[188:191]
    ds_read_b64_tr_b16 a[124:125], v8 offset:8480
    v_or3_b32 v11, v208, v209, v210
    v_mfma_f32_16x16x32_bf16 v[188:191], a[232:235], v[136:139], v[188:191]
    v_exp_f32 v247, v167
    v_mfma_f32_16x16x32_bf16 v[188:191], a[236:239], v[140:143], v[188:191]
    ds_read_b64_tr_b16 a[126:127], v8 offset:12704
    v_cvt_pk_bf16_f32 v211, v246, v247
    v_mfma_f32_16x16x32_bf16 v[80:83], a[80:83], v[224:227], v[80:83]
    v_exp_f32 v244, v168
    v_mfma_f32_16x16x32_bf16 v[80:83], a[84:87], v[228:231], v[80:83]
    ds_read_b64_tr_b16 a[128:129], v8 offset:256
    ds_read_b64_tr_b16 a[130:131], v8 offset:4480
    v_mfma_f32_16x16x32_bf16 v[84:87], a[88:91], v[224:227], v[84:87]
    v_exp_f32 v245, v169
    v_mfma_f32_16x16x32_bf16 v[84:87], a[92:95], v[228:231], v[84:87]
    ds_read_b64_tr_b16 a[132:133], v8 offset:8704
    v_cvt_pk_bf16_f32 v212, v244, v245
    v_mfma_f32_16x16x32_bf16 v[88:91], a[96:99], v[224:227], v[88:91]
    v_exp_f32 v246, v170
    v_mfma_f32_16x16x32_bf16 v[88:91], a[100:103], v[228:231], v[88:91]
    ds_read_b64_tr_b16 a[134:135], v8 offset:12928
    v_or3_b32 v11, v11, v211, v212
    v_mfma_f32_16x16x32_bf16 v[92:95], a[104:107], v[224:227], v[92:95]
    v_exp_f32 v247, v171
    s_add_u32 m0, s52, 50720
    v_mfma_f32_16x16x32_bf16 v[92:95], a[108:111], v[228:231], v[92:95]
    buffer_load_dwordx4 v2, s[28:31], s49 offen offset:1024 nt lds
    v_cvt_pk_bf16_f32 v213, v246, v247
    v_mfma_f32_16x16x32_bf16 v[96:99], a[144:147], v[224:227], v[96:99]
    v_exp_f32 v244, v172
    v_mfma_f32_16x16x32_bf16 v[96:99], a[148:151], v[228:231], v[96:99]
    ds_read_b64_tr_b16 a[136:137], v8 offset:288
    ds_read_b64_tr_b16 a[138:139], v8 offset:4512
    v_mfma_f32_16x16x32_bf16 v[100:103], a[152:155], v[224:227], v[100:103]
    v_exp_f32 v245, v173
    v_mfma_f32_16x16x32_bf16 v[100:103], a[156:159], v[228:231], v[100:103]
    ds_read_b64_tr_b16 a[140:141], v8 offset:8736
    v_cvt_pk_bf16_f32 v214, v244, v245
    v_mfma_f32_16x16x32_bf16 v[104:107], a[160:163], v[224:227], v[104:107]
    v_exp_f32 v246, v174
    v_mfma_f32_16x16x32_bf16 v[104:107], a[164:167], v[228:231], v[104:107]
    ds_read_b64_tr_b16 a[142:143], v8 offset:12960
    v_or3_b32 v11, v11, v213, v214
    v_mfma_f32_16x16x32_bf16 v[108:111], a[168:171], v[224:227], v[108:111]
    v_exp_f32 v247, v175
    v_mfma_f32_16x16x32_bf16 v[108:111], a[172:175], v[228:231], v[108:111]
    ds_read_b64_tr_b16 a[144:145], v8 offset:512
    v_cvt_pk_bf16_f32 v215, v246, v247
    v_mfma_f32_16x16x32_bf16 a[248:251], a[252:255], v[224:227], a[248:251]
    v_bitop3_b32 v11, v11, v215, s47 bitop3:0xa8
    v_cmp_ne_u32 vcc, 0, v11
    v_mfma_f32_16x16x32_bf16 a[248:251], a[252:255], v[228:231], a[248:251]
    ds_read_b64_tr_b16 a[146:147], v8 offset:4736
    ds_read_b64_tr_b16 a[148:149], v8 offset:8960
    v_mfma_f32_16x16x32_bf16 v[192:195], a[176:179], v[144:147], v[240:243]
    v_exp_f32 v244, v176
    v_mfma_f32_16x16x32_bf16 v[192:195], a[180:183], v[148:151], v[192:195]
    ds_read_b64_tr_b16 a[150:151], v8 offset:13184
    s_cbranch_vccnz L_st5_0
L_bk5_0:
    v_mfma_f32_16x16x32_bf16 v[192:195], a[184:187], v[152:155], v[192:195]
    v_exp_f32 v245, v177
    s_add_u32 m0, s52, 50752
    v_mfma_f32_16x16x32_bf16 v[192:195], a[188:191], v[156:159], v[192:195]
    buffer_load_dwordx4 v2, s[28:31], s49 offen offset:2048 nt lds
    v_cvt_pk_bf16_f32 v216, v244, v245
    v_mfma_f32_16x16x32_bf16 v[196:199], a[192:195], v[144:147], v[240:243]
    v_exp_f32 v246, v178
    v_mfma_f32_16x16x32_bf16 v[196:199], a[196:199], v[148:151], v[196:199]
    ds_read_b64_tr_b16 a[152:153], v8 offset:544
    ds_read_b64_tr_b16 a[154:155], v8 offset:4768
    v_mfma_f32_16x16x32_bf16 v[196:199], a[200:203], v[152:155], v[196:199]
    v_exp_f32 v247, v179
    v_mfma_f32_16x16x32_bf16 v[196:199], a[204:207], v[156:159], v[196:199]
    ds_read_b64_tr_b16 a[156:157], v8 offset:8992
    v_cvt_pk_bf16_f32 v217, v246, v247
    v_mfma_f32_16x16x32_bf16 v[200:203], a[208:211], v[144:147], v[240:243]
    v_exp_f32 v244, v180
    v_mfma_f32_16x16x32_bf16 v[200:203], a[212:215], v[148:151], v[200:203]
    ds_read_b64_tr_b16 a[158:159], v8 offset:13216
    ds_read_b64_tr_b16 a[160:161], v8 offset:768
    v_mfma_f32_16x16x32_bf16 v[200:203], a[216:219], v[152:155], v[200:203]
    v_exp_f32 v245, v181
    v_mfma_f32_16x16x32_bf16 v[200:203], a[220:223], v[156:159], v[200:203]
    ds_read_b64_tr_b16 a[162:163], v8 offset:4992
    v_cvt_pk_bf16_f32 v218, v244, v245
    v_mfma_f32_16x16x32_bf16 v[204:207], a[224:227], v[144:147], v[240:243]
    v_exp_f32 v246, v182
    v_mfma_f32_16x16x32_bf16 v[204:207], a[228:231], v[148:151], v[204:207]
    ds_read_b64_tr_b16 a[164:165], v8 offset:9216
    v_or3_b32 v11, v216, v217, v218
    v_mfma_f32_16x16x32_bf16 v[204:207], a[232:235], v[152:155], v[204:207]
    v_exp_f32 v247, v183
    s_add_u32 m0, s52, 50784
    v_mfma_f32_16x16x32_bf16 v[204:207], a[236:239], v[156:159], v[204:207]
    buffer_load_dwordx4 v2, s[28:31], s49 offen offset:3072 nt lds
    v_cvt_pk_bf16_f32 v219, v246, v247
    s_waitcnt lgkmcnt(11)
    v_mfma_f32_16x16x32_bf16 v[16:19], a[112:115], v[208:211], v[16:19]
    v_exp_f32 v244, v184
    v_mfma_f32_16x16x32_bf16 v[16:19], a[116:119], v[212:215], v[16:19]
    ds_read_b64_tr_b16 a[166:167], v8 offset:13440
    ds_read_b64_tr_b16 a[168:169], v8 offset:800
    v_mfma_f32_16x16x32_bf16 v[20:23], a[120:123], v[208:211], v[20:23]
    v_exp_f32 v245, v185
    v_mfma_f32_16x16x32_bf16 v[20:23], a[124:127], v[212:215], v[20:23]
    ds_read_b64_tr_b16 a[170:171], v8 offset:5024
    v_cvt_pk_bf16_f32 v220, v244, v245
    v_mfma_f32_16x16x32_bf16 v[24:27], a[128:131], v[208:211], v[24:27]
    ds_read_b64_tr_b16 a[172:173], v8 offset:9248
    ds_read_b64_tr_b16 a[174:175], v8 offset:13472
    v_exp_f32 v246, v186
    v_mfma_f32_16x16x32_bf16 v[24:27], a[132:135], v[212:215], v[24:27]
    ds_read_b128 a[176:179], v5 offset:0
    v_or3_b32 v11, v11, v219, v220
    v_mfma_f32_16x16x32_bf16 v[28:31], a[136:139], v[208:211], v[28:31]
    v_exp_f32 v247, v187
    v_mfma_f32_16x16x32_bf16 v[28:31], a[140:143], v[212:215], v[28:31]
    ds_read_b128 a[180:183], v5 offset:256
    v_cvt_pk_bf16_f32 v221, v246, v247
    s_waitcnt lgkmcnt(10)
    v_mfma_f32_16x16x32_bf16 v[32:35], a[144:147], v[208:211], v[32:35]
    v_exp_f32 v244, v188
    v_mfma_f32_16x16x32_bf16 v[32:35], a[148:151], v[212:215], v[32:35]
    ds_read_b128 a[184:187], v5 offset:512
    ds_read_b128 a[188:191], v5 offset:768
    v_mfma_f32_16x16x32_bf16 v[36:39], a[152:155], v[208:211], v[36:39]
    v_exp_f32 v245, v189
    s_add_u32 m0, s52, 67584
    s_mov_b32 s49, 131072
    v_mfma_f32_16x16x32_bf16 v[36:39], a[156:159], v[212:215], v[36:39]
    buffer_load_dwordx4 v2, s[24:27], s49 offen offset:0 nt lds
    v_cvt_pk_bf16_f32 v222, v244, v245
    s_waitcnt lgkmcnt(4)
    v_mfma_f32_16x16x32_bf16 v[40:43], a[160:163], v[208:211], v[40:43]
    v_exp_f32 v246, v190
    v_mfma_f32_16x16x32_bf16 v[40:43], a[164:167], v[212:215], v[40:43]
    ds_read_b128 a[192:195], v5 offset:4224
    v_or3_b32 v11, v11, v221, v222
    v_mfma_f32_16x16x32_bf16 v[44:47], a[168:171], v[208:211], v[44:47]
    ds_read_b128 a[196:199], v5 offset:4480
    ds_read_b128 a[200:203], v5 offset:4736
    ds_read_b128 a[204:207], v5 offset:4992
    v_exp_f32 v247, v191
    v_mfma_f32_16x16x32_bf16 v[44:47], a[172:175], v[212:215], v[44:47]
    ds_read_b128 a[208:211], v5 offset:8448
    v_cvt_pk_bf16_f32 v223, v246, v247
    v_mfma_f32_16x16x32_bf16 a[240:243], a[252:255], v[208:211], a[240:243]
    v_bitop3_b32 v11, v11, v223, s47 bitop3:0xa8
    v_cmp_ne_u32 vcc, 0, v11
    v_mfma_f32_16x16x32_bf16 a[240:243], a[252:255], v[212:215], a[240:243]
    ds_read_b128 a[212:215], v5 offset:8704
    ds_read_b128 a[216:219], v5 offset:8960
    s_waitcnt lgkmcnt(7)
    v_mfma_f32_16x16x32_bf16 v[160:163], a[176:179], v[112:115], v[232:235]
    ds_read_b128 a[220:223], v5 offset:9216
    v_exp_f32 v244, v192
    v_mfma_f32_16x16x32_bf16 v[160:163], a[180:183], v[116:119], v[160:163]
    ds_read_b128 a[224:227], v5 offset:12672
    s_cbranch_vccnz L_st5_1
L_bk5_1:
    v_mfma_f32_16x16x32_bf16 v[160:163], a[184:187], v[120:123], v[160:163]
    v_exp_f32 v245, v193
    v_mfma_f32_16x16x32_bf16 v[160:163], a[188:191], v[124:127], v[160:163]
    ds_read_b128 a[228:231], v5 offset:12928
    v_cvt_pk_bf16_f32 v224, v244, v245
    s_waitcnt lgkmcnt(6)
    v_mfma_f32_16x16x32_bf16 v[164:167], a[192:195], v[112:115], v[232:235]
    ds_read_b128 a[232:235], v5 offset:13184
    ds_read_b128 a[236:239], v5 offset:13440
    v_exp_f32 v246, v194
    v_mfma_f32_16x16x32_bf16 v[164:167], a[196:199], v[116:119], v[164:167]
    v_mfma_f32_16x16x32_bf16 v[164:167], a[200:203], v[120:123], v[164:167]
    v_exp_f32 v247, v195
    v_mfma_f32_16x16x32_bf16 v[164:167], a[204:207], v[124:127], v[164:167]
    v_cvt_pk_bf16_f32 v225, v246, v247
    s_waitcnt lgkmcnt(4)
    v_mfma_f32_16x16x32_bf16 v[168:171], a[208:211], v[112:115], v[232:235]
    v_exp_f32 v244, v196
    s_add_u32 m0, s52, 67616
    v_mfma_f32_16x16x32_bf16 v[168:171], a[212:215], v[116:119], v[168:171]
    buffer_load_dwordx4 v2, s[24:27], s49 offen offset:1024 nt lds
    v_mfma_f32_16x16x32_bf16 v[168:171], a[216:219], v[120:123], v[168:171]
    v_exp_f32 v245, v197
    v_mfma_f32_16x16x32_bf16 v[168:171], a[220:223], v[124:127], v[168:171]
    v_cvt_pk_bf16_f32 v226, v244, v245
    s_waitcnt lgkmcnt(0)
    v_mfma_f32_16x16x32_bf16 v[172:175], a[224:227], v[112:115], v[232:235]
    v_exp_f32 v246, v198
    v_mfma_f32_16x16x32_bf16 v[172:175], a[228:231], v[116:119], v[172:175]
    v_or3_b32 v11, v224, v225, v226
    v_mfma_f32_16x16x32_bf16 v[172:175], a[232:235], v[120:123], v[172:175]
    v_exp_f32 v247, v199
    v_mfma_f32_16x16x32_bf16 v[172:175], a[236:239], v[124:127], v[172:175]
    v_cvt_pk_bf16_f32 v227, v246, v247
    v_mfma_f32_16x16x32_bf16 v[48:51], a[112:115], v[216:219], v[48:51]
    v_exp_f32 v244, v200
    v_mfma_f32_16x16x32_bf16 v[48:51], a[116:119], v[220:223], v[48:51]
    v_mfma_f32_16x16x32_bf16 v[52:55], a[120:123], v[216:219], v[52:55]
    v_exp_f32 v245, v201
    s_add_u32 m0, s52, 67648
    v_mfma_f32_16x16x32_bf16 v[52:55], a[124:127], v[220:223], v[52:55]
    buffer_load_dwordx4 v2, s[24:27], s49 offen offset:2048 nt lds
    v_cvt_pk_bf16_f32 v228, v244, v245
    v_mfma_f32_16x16x32_bf16 v[56:59], a[128:131], v[216:219], v[56:59]
    v_exp_f32 v246, v202
    v_mfma_f32_16x16x32_bf16 v[56:59], a[132:135], v[220:223], v[56:59]
    v_or3_b32 v11, v11, v227, v228
    v_mfma_f32_16x16x32_bf16 v[60:63], a[136:139], v[216:219], v[60:63]
    v_exp_f32 v247, v203
    v_mfma_f32_16x16x32_bf16 v[60:63], a[140:143], v[220:223], v[60:63]
    v_cvt_pk_bf16_f32 v229, v246, v247
    v_mfma_f32_16x16x32_bf16 v[64:67], a[144:147], v[216:219], v[64:67]
    v_exp_f32 v244, v204
    v_mfma_f32_16x16x32_bf16 v[64:67], a[148:151], v[220:223], v[64:67]
    v_mfma_f32_16x16x32_bf16 v[68:71], a[152:155], v[216:219], v[68:71]
    v_exp_f32 v245, v205
    v_mfma_f32_16x16x32_bf16 v[68:71], a[156:159], v[220:223], v[68:71]
    v_cvt_pk_bf16_f32 v230, v244, v245
    v_mfma_f32_16x16x32_bf16 v[72:75], a[160:163], v[216:219], v[72:75]
    v_exp_f32 v246, v206
    s_add_u32 m0, s52, 67680
    v_mfma_f32_16x16x32_bf16 v[72:75], a[164:167], v[220:223], v[72:75]
    buffer_load_dwordx4 v2, s[24:27], s49 offen offset:3072 nt lds
    v_or3_b32 v11, v11, v229, v230
    v_mfma_f32_16x16x32_bf16 v[76:79], a[168:171], v[216:219], v[76:79]
    v_exp_f32 v247, v207
    v_mfma_f32_16x16x32_bf16 v[76:79], a[172:175], v[220:223], v[76:79]
    v_cvt_pk_bf16_f32 v231, v246, v247
    v_mfma_f32_16x16x32_bf16 a[244:247], a[252:255], v[216:219], a[244:247]
    v_bitop3_b32 v11, v11, v231, s47 bitop3:0xa8
    v_cmp_ne_u32 vcc, 0, v11
    v_mfma_f32_16x16x32_bf16 a[244:247], a[252:255], v[220:223], a[244:247]
    v_mfma_f32_16x16x32_bf16 v[176:179], a[176:179], v[128:131], v[236:239]
    v_exp_f32 v244, v160
    v_mfma_f32_16x16x32_bf16 v[176:179], a[180:183], v[132:135], v[176:179]
    s_cbranch_vccnz L_st5_2
L_bk5_2:
    v_mfma_f32_16x16x32_bf16 v[176:179], a[184:187], v[136:139], v[176:179]
    v_exp_f32 v245, v161
    s_waitcnt vmcnt(8)
    s_barrier
    v_mfma_f32_16x16x32_bf16 v[176:179], a[188:191], v[140:143], v[176:179]
    ds_read_b64_tr_b16 a[80:81], v7 offset:0
    v_cvt_pk_bf16_f32 v208, v244, v245
    v_mfma_f32_16x16x32_bf16 v[180:183], a[192:195], v[128:131], v[236:239]
    v_exp_f32 v246, v162
    v_mfma_f32_16x16x32_bf16 v[180:183], a[196:199], v[132:135], v[180:183]
    ds_read_b64_tr_b16 a[82:83], v7 offset:4224
    ds_read_b64_tr_b16 a[84:85], v7 offset:8448
    v_mfma_f32_16x16x32_bf16 v[180:183], a[200:203], v[136:139], v[180:183]
    v_exp_f32 v247, v163
    v_mfma_f32_16x16x32_bf16 v[180:183], a[204:207], v[140:143], v[180:183]
    ds_read_b64_tr_b16 a[86:87], v7 offset:12672
    v_cvt_pk_bf16_f32 v209, v246, v247
    v_mfma_f32_16x16x32_bf16 v[184:187], a[208:211], v[128:131], v[236:239]
    v_exp_f32 v244, v164
    v_mfma_f32_16x16x32_bf16 v[184:187], a[212:215], v[132:135], v[184:187]
    ds_read_b64_tr_b16 a[88:89], v7 offset:32
    ds_read_b64_tr_b16 a[90:91], v7 offset:4256
    v_mfma_f32_16x16x32_bf16 v[184:187], a[216:219], v[136:139], v[184:187]
    v_exp_f32 v245, v165
    s_add_u32 m0, s52, 84480
    s_mov_b32 s49, 131072
    v_mfma_f32_16x16x32_bf16 v[184:187], a[220:223], v[140:143], v[184:187]
    s_waitcnt vmcnt(5)
    buffer_load_dwordx4 v2, s[28:31], s49 offen offset:0 nt lds
    v_cvt_pk_bf16_f32 v210, v244, v245
    v_mfma_f32_16x16x32_bf16 v[188:191], a[224:227], v[128:131], v[236:239]
    v_exp_f32 v246, v166
    v_mfma_f32_16x16x32_bf16 v[188:191], a[228:231], v[132:135], v[188:191]
    ds_read_b64_tr_b16 a[92:93], v7 offset:8480
    v_or3_b32 v11, v208, v209, v210
    v_mfma_f32_16x16x32_bf16 v[188:191], a[232:235], v[136:139], v[188:191]
    v_exp_f32 v247, v167
    v_mfma_f32_16x16x32_bf16 v[188:191], a[236:239], v[140:143], v[188:191]
    ds_read_b64_tr_b16 a[94:95], v7 offset:12704
    v_cvt_pk_bf16_f32 v211, v246, v247
    v_mfma_f32_16x16x32_bf16 v[80:83], a[112:115], v[224:227], v[80:83]
    v_exp_f32 v244, v168
    v_mfma_f32_16x16x32_bf16 v[80:83], a[116:119], v[228:231], v[80:83]
    ds_read_b64_tr_b16 a[96:97], v7 offset:256
    ds_read_b64_tr_b16 a[98:99], v7 offset:4480
    v_mfma_f32_16x16x32_bf16 v[84:87], a[120:123], v[224:227], v[84:87]
    v_exp_f32 v245, v169
    v_mfma_f32_16x16x32_bf16 v[84:87], a[124:127], v[228:231], v[84:87]
    ds_read_b64_tr_b16 a[100:101], v7 offset:8704
    v_cvt_pk_bf16_f32 v212, v244, v245
    v_mfma_f32_16x16x32_bf16 v[88:91], a[128:131], v[224:227], v[88:91]
    v_exp_f32 v246, v170
    v_mfma_f32_16x16x32_bf16 v[88:91], a[132:135], v[228:231], v[88:91]
    ds_read_b64_tr_b16 a[102:103], v7 offset:12928
    v_or3_b32 v11, v11, v211, v212
    v_mfma_f32_16x16x32_bf16 v[92:95], a[136:139], v[224:227], v[92:95]
    v_exp_f32 v247, v171
    s_add_u32 m0, s52, 84512
    v_mfma_f32_16x16x32_bf16 v[92:95], a[140:143], v[228:231], v[92:95]
    s_waitcnt vmcnt(5)
    buffer_load_dwordx4 v2, s[28:31], s49 offen offset:1024 nt lds
    v_cvt_pk_bf16_f32 v213, v246, v247
    v_mfma_f32_16x16x32_bf16 v[96:99], a[144:147], v[224:227], v[96:99]
    v_exp_f32 v244, v172
    v_mfma_f32_16x16x32_bf16 v[96:99], a[148:151], v[228:231], v[96:99]
    ds_read_b64_tr_b16 a[104:105], v7 offset:288
    ds_read_b64_tr_b16 a[106:107], v7 offset:4512
    v_mfma_f32_16x16x32_bf16 v[100:103], a[152:155], v[224:227], v[100:103]
    v_exp_f32 v245, v173
    v_mfma_f32_16x16x32_bf16 v[100:103], a[156:159], v[228:231], v[100:103]
    ds_read_b64_tr_b16 a[108:109], v7 offset:8736
    v_cvt_pk_bf16_f32 v214, v244, v245
    v_mfma_f32_16x16x32_bf16 v[104:107], a[160:163], v[224:227], v[104:107]
    v_exp_f32 v246, v174
    v_mfma_f32_16x16x32_bf16 v[104:107], a[164:167], v[228:231], v[104:107]
    ds_read_b64_tr_b16 a[110:111], v7 offset:12960
    v_or3_b32 v11, v11, v213, v214
    v_mfma_f32_16x16x32_bf16 v[108:111], a[168:171], v[224:227], v[108:111]
    v_exp_f32 v247, v175
    v_mfma_f32_16x16x32_bf16 v[108:111], a[172:175], v[228:231], v[108:111]
    ds_read_b64_tr_b16 a[144:145], v7 offset:512
    v_cvt_pk_bf16_f32 v215, v246, v247
    v_mfma_f32_16x16x32_bf16 a[248:251], a[252:255], v[224:227], a[248:251]
    v_bitop3_b32 v11, v11, v215, s47 bitop3:0xa8
    v_cmp_ne_u32 vcc, 0, v11
    v_mfma_f32_16x16x32_bf16 a[248:251], a[252:255], v[228:231], a[248:251]
    ds_read_b64_tr_b16 a[146:147], v7 offset:4736
    ds_read_b64_tr_b16 a[148:149], v7 offset:8960
    v_mfma_f32_16x16x32_bf16 v[192:195], a[176:179], v[144:147], v[240:243]
    v_exp_f32 v244, v176
    v_mfma_f32_16x16x32_bf16 v[192:195], a[180:183], v[148:151], v[192:195]
    ds_read_b64_tr_b16 a[150:151], v7 offset:13184
    s_cbranch_vccnz L_st6_0
L_bk6_0:
    v_mfma_f32_16x16x32_bf16 v[192:195], a[184:187], v[152:155], v[192:195]
    v_exp_f32 v245, v177
    s_add_u32 m0, s52, 84544
    v_mfma_f32_16x16x32_bf16 v[192:195], a[188:191], v[156:159], v[192:195]
    s_waitcnt vmcnt(5)
    buffer_load_dwordx4 v2, s[28:31], s49 offen offset:2048 nt lds
    v_cvt_pk_bf16_f32 v216, v244, v245
    v_mfma_f32_16x16x32_bf16 v[196:199], a[192:195], v[144:147], v[240:243]
    v_exp_f32 v246, v178
    v_mfma_f32_16x16x32_bf16 v[196:199], a[196:199], v[148:151], v[196:199]
    ds_read_b64_tr_b16 a[152:153], v7 offset:544
    ds_read_b64_tr_b16 a[154:155], v7 offset:4768
    v_mfma_f32_16x16x32_bf16 v[196:199], a[200:203], v[152:155], v[196:199]
    v_exp_f32 v247, v179
    v_mfma_f32_16x16x32_bf16 v[196:199], a[204:207], v[156:159], v[196:199]
    ds_read_b64_tr_b16 a[156:157], v7 offset:8992
    v_cvt_pk_bf16_f32 v217, v246, v247
    v_mfma_f32_16x16x32_bf16 v[200:203], a[208:211], v[144:147], v[240:243]
    v_exp_f32 v244, v180
    v_mfma_f32_16x16x32_bf16 v[200:203], a[212:215], v[148:151], v[200:203]
    ds_read_b64_tr_b16 a[158:159], v7 offset:13216
    ds_read_b64_tr_b16 a[160:161], v7 offset:768
    v_mfma_f32_16x16x32_bf16 v[200:203], a[216:219], v[152:155], v[200:203]
    v_exp_f32 v245, v181
    v_mfma_f32_16x16x32_bf16 v[200:203], a[220:223], v[156:159], v[200:203]
    ds_read_b64_tr_b16 a[162:163], v7 offset:4992
    v_cvt_pk_bf16_f32 v218, v244, v245
    v_mfma_f32_16x16x32_bf16 v[204:207], a[224:227], v[144:147], v[240:243]
    v_exp_f32 v246, v182
    v_mfma_f32_16x16x32_bf16 v[204:207], a[228:231], v[148:151], v[204:207]
    ds_read_b64_tr_b16 a[164:165], v7 offset:9216
    v_or3_b32 v11, v216, v217, v218
    v_mfma_f32_16x16x32_bf16 v[204:207], a[232:235], v[152:155], v[204:207]
    v_exp_f32 v247, v183
    s_add_u32 m0, s52, 84576
    v_mfma_f32_16x16x32_bf16 v[204:207], a[236:239], v[156:159], v[204:207]
    s_waitcnt vmcnt(5)
    buffer_load_dwordx4 v2, s[28:31], s49 offen offset:3072 nt lds
    v_cvt_pk_bf16_f32 v219, v246, v247
    s_waitcnt lgkmcnt(11)
    v_mfma_f32_16x16x32_bf16 v[16:19], a[80:83], v[208:211], v[16:19]
    v_exp_f32 v244, v184
    v_mfma_f32_16x16x32_bf16 v[16:19], a[84:87], v[212:215], v[16:19]
    ds_read_b64_tr_b16 a[166:167], v7 offset:13440
    ds_read_b64_tr_b16 a[168:169], v7 offset:800
    v_mfma_f32_16x16x32_bf16 v[20:23], a[88:91], v[208:211], v[20:23]
    v_exp_f32 v245, v185
    v_mfma_f32_16x16x32_bf16 v[20:23], a[92:95], v[212:215], v[20:23]
    ds_read_b64_tr_b16 a[170:171], v7 offset:5024
    v_cvt_pk_bf16_f32 v220, v244, v245
    v_mfma_f32_16x16x32_bf16 v[24:27], a[96:99], v[208:211], v[24:27]
    ds_read_b64_tr_b16 a[172:173], v7 offset:9248
    ds_read_b64_tr_b16 a[174:175], v7 offset:13472
    v_exp_f32 v246, v186
    v_mfma_f32_16x16x32_bf16 v[24:27], a[100:103], v[212:215], v[24:27]
    ds_read_b128 a[176:179], v5 offset:33792
    v_or3_b32 v11, v11, v219, v220
    v_mfma_f32_16x16x32_bf16 v[28:31], a[104:107], v[208:211], v[28:31]
    v_exp_f32 v247, v187
    v_mfma_f32_16x16x32_bf16 v[28:31], a[108:111], v[212:215], v[28:31]
    ds_read_b128 a[180:183], v5 offset:34048
    v_cvt_pk_bf16_f32 v221, v246, v247
    s_waitcnt lgkmcnt(10)
    v_mfma_f32_16x16x32_bf16 v[32:35], a[144:147], v[208:211], v[32:35]
    v_exp_f32 v244, v188
    v_mfma_f32_16x16x32_bf16 v[32:35], a[148:151], v[212:215], v[32:35]
    ds_read_b128 a[184:187], v5 offset:34304
    ds_read_b128 a[188:191], v5 offset:34560
    v_mfma_f32_16x16x32_bf16 v[36:39], a[152:155], v[208:211], v[36:39]
    v_exp_f32 v245, v189
    s_add_u32 m0, s52, 0
    s_mov_b32 s49, 147456
    v_mfma_f32_16x16x32_bf16 v[36:39], a[156:159], v[212:215], v[36:39]
    s_waitcnt vmcnt(5)
    buffer_load_dwordx4 v2, s[24:27], s49 offen offset:0 nt lds
    v_cvt_pk_bf16_f32 v222, v244, v245
    s_waitcnt lgkmcnt(4)
    v_mfma_f32_16x16x32_bf16 v[40:43], a[160:163], v[208:211], v[40:43]
    v_exp_f32 v246, v190
    v_mfma_f32_16x16x32_bf16 v[40:43], a[164:167], v[212:215], v[40:43]
    ds_read_b128 a[192:195], v5 offset:38016
    v_or3_b32 v11, v11, v221, v222
    v_mfma_f32_16x16x32_bf16 v[44:47], a[168:171], v[208:211], v[44:47]
    ds_read_b128 a[196:199], v5 offset:38272
    ds_read_b128 a[200:203], v5 offset:38528
    ds_read_b128 a[204:207], v5 offset:38784
    v_exp_f32 v247, v191
    v_mfma_f32_16x16x32_bf16 v[44:47], a[172:175], v[212:215], v[44:47]
    ds_read_b128 a[208:211], v5 offset:42240
    v_cvt_pk_bf16_f32 v223, v246, v247
    v_mfma_f32_16x16x32_bf16 a[240:243], a[252:255], v[208:211], a[240:243]
    v_bitop3_b32 v11, v11, v223, s47 bitop3:0xa8
    v_cmp_ne_u32 vcc, 0, v11
    v_mfma_f32_16x16x32_bf16 a[240:243], a[252:255], v[212:215], a[240:243]
    ds_read_b128 a[212:215], v5 offset:42496
    ds_read_b128 a[216:219], v5 offset:42752
    s_waitcnt lgkmcnt(7)
    v_mfma_f32_16x16x32_bf16 v[160:163], a[176:179], v[112:115], v[232:235]
    ds_read_b128 a[220:223], v5 offset:43008
    v_exp_f32 v244, v192
    v_mfma_f32_16x16x32_bf16 v[160:163], a[180:183], v[116:119], v[160:163]
    ds_read_b128 a[224:227], v5 offset:46464
    s_cbranch_vccnz L_st6_1
L_bk6_1:
    v_mfma_f32_16x16x32_bf16 v[160:163], a[184:187], v[120:123], v[160:163]
    v_exp_f32 v245, v193
    v_mfma_f32_16x16x32_bf16 v[160:163], a[188:191], v[124:127], v[160:163]
    ds_read_b128 a[228:231], v5 offset:46720
    v_cvt_pk_bf16_f32 v224, v244, v245
    s_waitcnt lgkmcnt(6)
    v_mfma_f32_16x16x32_bf16 v[164:167], a[192:195], v[112:115], v[232:235]
    ds_read_b128 a[232:235], v5 offset:46976
    ds_read_b128 a[236:239], v5 offset:47232
    v_exp_f32 v246, v194
    v_mfma_f32_16x16x32_bf16 v[164:167], a[196:199], v[116:119], v[164:167]
    v_mfma_f32_16x16x32_bf16 v[164:167], a[200:203], v[120:123], v[164:167]
    v_exp_f32 v247, v195
    v_mfma_f32_16x16x32_bf16 v[164:167], a[204:207], v[124:127], v[164:167]
    v_cvt_pk_bf16_f32 v225, v246, v247
    s_waitcnt lgkmcnt(4)
    v_mfma_f32_16x16x32_bf16 v[168:171], a[208:211], v[112:115], v[232:235]
    v_exp_f32 v244, v196
    s_add_u32 m0, s52, 32
    v_mfma_f32_16x16x32_bf16 v[168:171], a[212:215], v[116:119], v[168:171]
    s_waitcnt vmcnt(5)
    buffer_load_dwordx4 v2, s[24:27], s49 offen offset:1024 nt lds
    v_mfma_f32_16x16x32_bf16 v[168:171], a[216:219], v[120:123], v[168:171]
    v_exp_f32 v245, v197
    v_mfma_f32_16x16x32_bf16 v[168:171], a[220:223], v[124:127], v[168:171]
    v_cvt_pk_bf16_f32 v226, v244, v245
    s_waitcnt lgkmcnt(0)
    v_mfma_f32_16x16x32_bf16 v[172:175], a[224:227], v[112:115], v[232:235]
    v_exp_f32 v246, v198
    v_mfma_f32_16x16x32_bf16 v[172:175], a[228:231], v[116:119], v[172:175]
    v_or3_b32 v11, v224, v225, v226
    v_mov_b32 v254, 0
    buffer_load_dwordx2 v[252:253], v254, s[4:7], 0 offen
    v_mfma_f32_16x16x32_bf16 v[172:175], a[232:235], v[120:123], v[172:175]
    v_exp_f32 v247, v199
    v_mfma_f32_16x16x32_bf16 v[172:175], a[236:239], v[124:127], v[172:175]
    v_cvt_pk_bf16_f32 v227, v246, v247
    v_mfma_f32_16x16x32_bf16 v[48:51], a[80:83], v[216:219], v[48:51]
    v_exp_f32 v244, v200
    v_mfma_f32_16x16x32_bf16 v[48:51], a[84:87], v[220:223], v[48:51]
    v_mfma_f32_16x16x32_bf16 v[52:55], a[88:91], v[216:219], v[52:55]
    v_exp_f32 v245, v201
    s_add_u32 m0, s52, 64
    v_mfma_f32_16x16x32_bf16 v[52:55], a[92:95], v[220:223], v[52:55]
    s_waitcnt vmcnt(6)
    buffer_load_dwordx4 v2, s[24:27], s49 offen offset:2048 nt lds
    v_cvt_pk_bf16_f32 v228, v244, v245
    v_mfma_f32_16x16x32_bf16 v[56:59], a[96:99], v[216:219], v[56:59]
    v_exp_f32 v246, v202
    v_mfma_f32_16x16x32_bf16 v[56:59], a[100:103], v[220:223], v[56:59]
    v_or3_b32 v11, v11, v227, v228
    v_mfma_f32_16x16x32_bf16 v[60:63], a[104:107], v[216:219], v[60:63]
    v_exp_f32 v247, v203
    v_mfma_f32_16x16x32_bf16 v[60:63], a[108:111], v[220:223], v[60:63]
    v_cvt_pk_bf16_f32 v229, v246, v247
    v_mfma_f32_16x16x32_bf16 v[64:67], a[144:147], v[216:219], v[64:67]
    v_exp_f32 v244, v204
    v_mfma_f32_16x16x32_bf16 v[64:67], a[148:151], v[220:223], v[64:67]
    v_mfma_f32_16x16x32_bf16 v[68:71], a[152:155], v[216:219], v[68:71]
    v_exp_f32 v245, v205
    v_mfma_f32_16x16x32_bf16 v[68:71], a[156:159], v[220:223], v[68:71]
    v_cvt_pk_bf16_f32 v230, v244, v245
    v_mfma_f32_16x16x32_bf16 v[72:75], a[160:163], v[216:219], v[72:75]
    v_exp_f32 v246, v206
    s_add_u32 m0, s52, 96
    v_mfma_f32_16x16x32_bf16 v[72:75], a[164:167], v[220:223], v[72:75]
    s_waitcnt vmcnt(6)
    buffer_load_dwordx4 v2, s[24:27], s49 offen offset:3072 nt lds
    v_or3_b32 v11, v11, v229, v230
    v_mfma_f32_16x16x32_bf16 v[76:79], a[168:171], v[216:219], v[76:79]
    v_exp_f32 v247, v207
    v_mfma_f32_16x16x32_bf16 v[76:79], a[172:175], v[220:223], v[76:79]
    v_cvt_pk_bf16_f32 v231, v246, v247
    v_mfma_f32_16x16x32_bf16 a[244:247], a[252:255], v[216:219], a[244:247]
    v_bitop3_b32 v11, v11, v231, s47 bitop3:0xa8
    v_cmp_ne_u32 vcc, 0, v11
    v_mfma_f32_16x16x32_bf16 a[244:247], a[252:255], v[220:223], a[244:247]
    v_mfma_f32_16x16x32_bf16 v[176:179], a[176:179], v[128:131], v[236:239]
    v_exp_f32 v244, v160
    v_mfma_f32_16x16x32_bf16 v[176:179], a[180:183], v[132:135], v[176:179]
    s_cbranch_vccnz L_st6_2
L_bk6_2:
    v_mfma_f32_16x16x32_bf16 v[176:179], a[184:187], v[136:139], v[176:179]
    v_exp_f32 v245, v161
    s_barrier
    v_mfma_f32_16x16x32_bf16 v[176:179], a[188:191], v[140:143], v[176:179]
    ds_read_b64_tr_b16 a[112:113], v7 offset:33792
    v_cvt_pk_bf16_f32 v208, v244, v245
    v_mfma_f32_16x16x32_bf16 v[180:183], a[192:195], v[128:131], v[236:239]
    v_exp_f32 v246, v162
    v_mfma_f32_16x16x32_bf16 v[180:183], a[196:199], v[132:135], v[180:183]
    ds_read_b64_tr_b16 a[114:115], v7 offset:38016
    ds_read_b64_tr_b16 a[116:117], v7 offset:42240
    v_mfma_f32_16x16x32_bf16 v[180:183], a[200:203], v[136:139], v[180:183]
    v_exp_f32 v247, v163
    v_mfma_f32_16x16x32_bf16 v[180:183], a[204:207], v[140:143], v[180:183]
    ds_read_b64_tr_b16 a[118:119], v7 offset:46464
    v_cvt_pk_bf16_f32 v209, v246, v247
    v_mfma_f32_16x16x32_bf16 v[184:187], a[208:211], v[128:131], v[236:239]
    v_exp_f32 v244, v164
    v_mfma_f32_16x16x32_bf16 v[184:187], a[212:215], v[132:135], v[184:187]
    ds_read_b64_tr_b16 a[120:121], v7 offset:33824
    ds_read_b64_tr_b16 a[122:123], v7 offset:38048
    v_mfma_f32_16x16x32_bf16 v[184:187], a[216:219], v[136:139], v[184:187]
    v_exp_f32 v245, v165
    s_add_u32 m0, s52, 16896
    s_mov_b32 s49, 147456
    v_mfma_f32_16x16x32_bf16 v[184:187], a[220:223], v[140:143], v[184:187]
    s_waitcnt vmcnt(6)
    buffer_load_dwordx4 v2, s[28:31], s49 offen offset:0 nt lds
    v_cvt_pk_bf16_f32 v210, v244, v245
    v_mfma_f32_16x16x32_bf16 v[188:191], a[224:227], v[128:131], v[236:239]
    v_exp_f32 v246, v166
    v_mfma_f32_16x16x32_bf16 v[188:191], a[228:231], v[132:135], v[188:191]
    ds_read_b64_tr_b16 a[124:125], v7 offset:42272
    v_or3_b32 v11, v208, v209, v210
    v_mfma_f32_16x16x32_bf16 v[188:191], a[232:235], v[136:139], v[188:191]
    v_exp_f32 v247, v167
    v_mfma_f32_16x16x32_bf16 v[188:191], a[236:239], v[140:143], v[188:191]
    ds_read_b64_tr_b16 a[126:127], v7 offset:46496
    v_cvt_pk_bf16_f32 v211, v246, v247
    v_mfma_f32_16x16x32_bf16 v[80:83], a[80:83], v[224:227], v[80:83]
    v_exp_f32 v244, v168
    v_mfma_f32_16x16x32_bf16 v[80:83], a[84:87], v[228:231], v[80:83]
    ds_read_b64_tr_b16 a[128:129], v7 offset:34048
    ds_read_b64_tr_b16 a[130:131], v7 offset:38272
    v_mfma_f32_16x16x32_bf16 v[84:87], a[88:91], v[224:227], v[84:87]
    v_exp_f32 v245, v169
    v_mfma_f32_16x16x32_bf16 v[84:87], a[92:95], v[228:231], v[84:87]
    ds_read_b64_tr_b16 a[132:133], v7 offset:42496
    v_cvt_pk_bf16_f32 v212, v244, v245
    v_mfma_f32_16x16x32_bf16 v[88:91], a[96:99], v[224:227], v[88:91]
    v_exp_f32 v246, v170
    v_mfma_f32_16x16x32_bf16 v[88:91], a[100:103], v[228:231], v[88:91]
    ds_read_b64_tr_b16 a[134:135], v7 offset:46720
    v_or3_b32 v11, v11, v211, v212
    v_mfma_f32_16x16x32_bf16 v[92:95], a[104:107], v[224:227], v[92:95]
    v_exp_f32 v247, v171
    s_add_u32 m0, s52, 16928
    v_mfma_f32_16x16x32_bf16 v[92:95], a[108:111], v[228:231], v[92:95]
    s_waitcnt vmcnt(6)
    buffer_load_dwordx4 v2, s[28:31], s49 offen offset:1024 nt lds
    v_cvt_pk_bf16_f32 v213, v246, v247
    v_mfma_f32_16x16x32_bf16 v[96:99], a[144:147], v[224:227], v[96:99]
    v_exp_f32 v244, v172
    v_mfma_f32_16x16x32_bf16 v[96:99], a[148:151], v[228:231], v[96:99]
    ds_read_b64_tr_b16 a[136:137], v7 offset:34080
    ds_read_b64_tr_b16 a[138:139], v7 offset:38304
    v_mfma_f32_16x16x32_bf16 v[100:103], a[152:155], v[224:227], v[100:103]
    v_exp_f32 v245, v173
    v_mfma_f32_16x16x32_bf16 v[100:103], a[156:159], v[228:231], v[100:103]
    ds_read_b64_tr_b16 a[140:141], v7 offset:42528
    v_cvt_pk_bf16_f32 v214, v244, v245
    v_mfma_f32_16x16x32_bf16 v[104:107], a[160:163], v[224:227], v[104:107]
    v_exp_f32 v246, v174
    v_mfma_f32_16x16x32_bf16 v[104:107], a[164:167], v[228:231], v[104:107]
    ds_read_b64_tr_b16 a[142:143], v7 offset:46752
    v_or3_b32 v11, v11, v213, v214
    v_mfma_f32_16x16x32_bf16 v[108:111], a[168:171], v[224:227], v[108:111]
    v_exp_f32 v247, v175
    v_mfma_f32_16x16x32_bf16 v[108:111], a[172:175], v[228:231], v[108:111]
    ds_read_b64_tr_b16 a[144:145], v7 offset:34304
    v_cvt_pk_bf16_f32 v215, v246, v247
    v_mfma_f32_16x16x32_bf16 a[248:251], a[252:255], v[224:227], a[248:251]
    v_bitop3_b32 v11, v11, v215, s47 bitop3:0xa8
    v_cmp_ne_u32 vcc, 0, v11
    v_mfma_f32_16x16x32_bf16 a[248:251], a[252:255], v[228:231], a[248:251]
    ds_read_b64_tr_b16 a[146:147], v7 offset:38528
    ds_read_b64_tr_b16 a[148:149], v7 offset:42752
    v_mfma_f32_16x16x32_bf16 v[192:195], a[176:179], v[144:147], v[240:243]
    v_exp_f32 v244, v176
    v_mfma_f32_16x16x32_bf16 v[192:195], a[180:183], v[148:151], v[192:195]
    ds_read_b64_tr_b16 a[150:151], v7 offset:46976
    s_cbranch_vccnz L_st7_0
L_bk7_0:
    v_mfma_f32_16x16x32_bf16 v[192:195], a[184:187], v[152:155], v[192:195]
    v_exp_f32 v245, v177
    s_add_u32 m0, s52, 16960
    v_mfma_f32_16x16x32_bf16 v[192:195], a[188:191], v[156:159], v[192:195]
    s_waitcnt vmcnt(6)
    buffer_load_dwordx4 v2, s[28:31], s49 offen offset:2048 nt lds
    v_cvt_pk_bf16_f32 v216, v244, v245
    v_mfma_f32_16x16x32_bf16 v[196:199], a[192:195], v[144:147], v[240:243]
    v_exp_f32 v246, v178
    v_mfma_f32_16x16x32_bf16 v[196:199], a[196:199], v[148:151], v[196:199]
    ds_read_b64_tr_b16 a[152:153], v7 offset:34336
    ds_read_b64_tr_b16 a[154:155], v7 offset:38560
    v_mfma_f32_16x16x32_bf16 v[196:199], a[200:203], v[152:155], v[196:199]
    v_exp_f32 v247, v179
    v_mfma_f32_16x16x32_bf16 v[196:199], a[204:207], v[156:159], v[196:199]
    ds_read_b64_tr_b16 a[156:157], v7 offset:42784
    v_cvt_pk_bf16_f32 v217, v246, v247
    v_mfma_f32_16x16x32_bf16 v[200:203], a[208:211], v[144:147], v[240:243]
    v_exp_f32 v244, v180
    v_mfma_f32_16x16x32_bf16 v[200:203], a[212:215], v[148:151], v[200:203]
    ds_read_b64_tr_b16 a[158:159], v7 offset:47008
    ds_read_b64_tr_b16 a[160:161], v7 offset:34560
    v_mfma_f32_16x16x32_bf16 v[200:203], a[216:219], v[152:155], v[200:203]
    v_exp_f32 v245, v181
    v_mfma_f32_16x16x32_bf16 v[200:203], a[220:223], v[156:159], v[200:203]
    ds_read_b64_tr_b16 a[162:163], v7 offset:38784
    v_cvt_pk_bf16_f32 v218, v244, v245
    v_mfma_f32_16x16x32_bf16 v[204:207], a[224:227], v[144:147], v[240:243]
    v_exp_f32 v246, v182
    v_mfma_f32_16x16x32_bf16 v[204:207], a[228:231], v[148:151], v[204:207]
    ds_read_b64_tr_b16 a[164:165], v7 offset:43008
    v_or3_b32 v11, v216, v217, v218
    v_mfma_f32_16x16x32_bf16 v[204:207], a[232:235], v[152:155], v[204:207]
    v_exp_f32 v247, v183
    s_add_u32 m0, s52, 16992
    v_mfma_f32_16x16x32_bf16 v[204:207], a[236:239], v[156:159], v[204:207]
    s_waitcnt vmcnt(6)
    buffer_load_dwordx4 v2, s[28:31], s49 offen offset:3072 nt lds
    v_cvt_pk_bf16_f32 v219, v246, v247
    s_waitcnt lgkmcnt(11)
    v_mfma_f32_16x16x32_bf16 v[16:19], a[112:115], v[208:211], v[16:19]
    v_exp_f32 v244, v184
    v_mfma_f32_16x16x32_bf16 v[16:19], a[116:119], v[212:215], v[16:19]
    ds_read_b64_tr_b16 a[166:167], v7 offset:47232
    ds_read_b64_tr_b16 a[168:169], v7 offset:34592
    v_mfma_f32_16x16x32_bf16 v[20:23], a[120:123], v[208:211], v[20:23]
    v_exp_f32 v245, v185
    v_mfma_f32_16x16x32_bf16 v[20:23], a[124:127], v[212:215], v[20:23]
    ds_read_b64_tr_b16 a[170:171], v7 offset:38816
    v_cvt_pk_bf16_f32 v220, v244, v245
    v_mfma_f32_16x16x32_bf16 v[24:27], a[128:131], v[208:211], v[24:27]
    ds_read_b64_tr_b16 a[172:173], v7 offset:43040
    ds_read_b64_tr_b16 a[174:175], v7 offset:47264
    v_exp_f32 v246, v186
    v_mfma_f32_16x16x32_bf16 v[24:27], a[132:135], v[212:215], v[24:27]
    ds_read_b128 a[176:179], v6 offset:0
    v_or3_b32 v11, v11, v219, v220
    v_mfma_f32_16x16x32_bf16 v[28:31], a[136:139], v[208:211], v[28:31]
    v_exp_f32 v247, v187
    v_mfma_f32_16x16x32_bf16 v[28:31], a[140:143], v[212:215], v[28:31]
    ds_read_b128 a[180:183], v6 offset:256
    v_cvt_pk_bf16_f32 v221, v246, v247
    s_waitcnt lgkmcnt(10)
    v_mfma_f32_16x16x32_bf16 v[32:35], a[144:147], v[208:211], v[32:35]
    v_exp_f32 v244, v188
    v_mfma_f32_16x16x32_bf16 v[32:35], a[148:151], v[212:215], v[32:35]
    ds_read_b128 a[184:187], v6 offset:512
    ds_read_b128 a[188:191], v6 offset:768
    v_mfma_f32_16x16x32_bf16 v[36:39], a[152:155], v[208:211], v[36:39]
    v_exp_f32 v245, v189
    s_add_u32 m0, s52, 33792
    s_mov_b32 s49, 163840
    v_mfma_f32_16x16x32_bf16 v[36:39], a[156:159], v[212:215], v[36:39]
    s_waitcnt vmcnt(5)
    buffer_load_dwordx4 v2, s[24:27], s49 offen offset:0 nt lds
    v_cvt_pk_bf16_f32 v222, v244, v245
    s_waitcnt lgkmcnt(4)
    v_mfma_f32_16x16x32_bf16 v[40:43], a[160:163], v[208:211], v[40:43]
    v_exp_f32 v246, v190
    v_mfma_f32_16x16x32_bf16 v[40:43], a[164:167], v[212:215], v[40:43]
    ds_read_b128 a[192:195], v6 offset:4224
    v_or3_b32 v11, v11, v221, v222
    v_mfma_f32_16x16x32_bf16 v[44:47], a[168:171], v[208:211], v[44:47]
    ds_read_b128 a[196:199], v6 offset:4480
    ds_read_b128 a[200:203], v6 offset:4736
    ds_read_b128 a[204:207], v6 offset:4992
    v_exp_f32 v247, v191
    v_mfma_f32_16x16x32_bf16 v[44:47], a[172:175], v[212:215], v[44:47]
    ds_read_b128 a[208:211], v6 offset:8448
    v_cvt_pk_bf16_f32 v223, v246, v247
    v_mfma_f32_16x16x32_bf16 a[240:243], a[252:255], v[208:211], a[240:243]
    v_bitop3_b32 v11, v11, v223, s47 bitop3:0xa8
    v_cmp_ne_u32 vcc, 0, v11
    v_mfma_f32_16x16x32_bf16 a[240:243], a[252:255], v[212:215], a[240:243]
    ds_read_b128 a[212:215], v6 offset:8704
    ds_read_b128 a[216:219], v6 offset:8960
    s_waitcnt lgkmcnt(7)
    v_mfma_f32_16x16x32_bf16 v[160:163], a[176:179], v[112:115], v[232:235]
    ds_read_b128 a[220:223], v6 offset:9216
    v_exp_f32 v244, v192
    v_mfma_f32_16x16x32_bf16 v[160:163], a[180:183], v[116:119], v[160:163]
    ds_read_b128 a[224:227], v6 offset:12672
    s_cbranch_vccnz L_st7_1
L_bk7_1:
    v_mfma_f32_16x16x32_bf16 v[160:163], a[184:187], v[120:123], v[160:163]
    v_exp_f32 v245, v193
    v_mfma_f32_16x16x32_bf16 v[160:163], a[188:191], v[124:127], v[160:163]
    ds_read_b128 a[228:231], v6 offset:12928
    v_cvt_pk_bf16_f32 v224, v244, v245
    s_waitcnt lgkmcnt(6)
    v_mfma_f32_16x16x32_bf16 v[164:167], a[192:195], v[112:115], v[232:235]
    ds_read_b128 a[232:235], v6 offset:13184
    ds_read_b128 a[236:239], v6 offset:13440
    v_exp_f32 v246, v194
    v_mfma_f32_16x16x32_bf16 v[164:167], a[196:199], v[116:119], v[164:167]
    v_mfma_f32_16x16x32_bf16 v[164:167], a[200:203], v[120:123], v[164:167]
    v_exp_f32 v247, v195
    v_mfma_f32_16x16x32_bf16 v[164:167], a[204:207], v[124:127], v[164:167]
    v_cvt_pk_bf16_f32 v225, v246, v247
    s_waitcnt lgkmcnt(4)
    v_mfma_f32_16x16x32_bf16 v[168:171], a[208:211], v[112:115], v[232:235]
    v_exp_f32 v244, v196
    s_add_u32 m0, s52, 33824
    v_mfma_f32_16x16x32_bf16 v[168:171], a[212:215], v[116:119], v[168:171]
    s_waitcnt vmcnt(5)
    buffer_load_dwordx4 v2, s[24:27], s49 offen offset:1024 nt lds
    v_mfma_f32_16x16x32_bf16 v[168:171], a[216:219], v[120:123], v[168:171]
    v_exp_f32 v245, v197
    v_mfma_f32_16x16x32_bf16 v[168:171], a[220:223], v[124:127], v[168:171]
    v_cvt_pk_bf16_f32 v226, v244, v245
    s_waitcnt lgkmcnt(0)
    v_mfma_f32_16x16x32_bf16 v[172:175], a[224:227], v[112:115], v[232:235]
    v_exp_f32 v246, v198
    v_mfma_f32_16x16x32_bf16 v[172:175], a[228:231], v[116:119], v[172:175]
    v_or3_b32 v11, v224, v225, v226
    v_mfma_f32_16x16x32_bf16 v[172:175], a[232:235], v[120:123], v[172:175]
    v_exp_f32 v247, v199
    v_mfma_f32_16x16x32_bf16 v[172:175], a[236:239], v[124:127], v[172:175]
    v_cvt_pk_bf16_f32 v227, v246, v247
    v_mfma_f32_16x16x32_bf16 v[48:51], a[112:115], v[216:219], v[48:51]
    v_exp_f32 v244, v200
    v_mfma_f32_16x16x32_bf16 v[48:51], a[116:119], v[220:223], v[48:51]
    v_mfma_f32_16x16x32_bf16 v[52:55], a[120:123], v[216:219], v[52:55]
    v_exp_f32 v245, v201
    s_add_u32 m0, s52, 33856
    v_mfma_f32_16x16x32_bf16 v[52:55], a[124:127], v[220:223], v[52:55]
    s_waitcnt vmcnt(5)
    buffer_load_dwordx4 v2, s[24:27], s49 offen offset:2048 nt lds
    v_cvt_pk_bf16_f32 v228, v244, v245
    v_mfma_f32_16x16x32_bf16 v[56:59], a[128:131], v[216:219], v[56:59]
    v_exp_f32 v246, v202
    v_mfma_f32_16x16x32_bf16 v[56:59], a[132:135], v[220:223], v[56:59]
    v_or3_b32 v11, v11, v227, v228
    v_mfma_f32_16x16x32_bf16 v[60:63], a[136:139], v[216:219], v[60:63]
    v_exp_f32 v247, v203
    v_mfma_f32_16x16x32_bf16 v[60:63], a[140:143], v[220:223], v[60:63]
    v_cvt_pk_bf16_f32 v229, v246, v247
    v_mfma_f32_16x16x32_bf16 v[64:67], a[144:147], v[216:219], v[64:67]
    v_exp_f32 v244, v204
    v_mfma_f32_16x16x32_bf16 v[64:67], a[148:151], v[220:223], v[64:67]
    v_mfma_f32_16x16x32_bf16 v[68:71], a[152:155], v[216:219], v[68:71]
    v_exp_f32 v245, v205
    v_mfma_f32_16x16x32_bf16 v[68:71], a[156:159], v[220:223], v[68:71]
    v_cvt_pk_bf16_f32 v230, v244, v245
    v_mfma_f32_16x16x32_bf16 v[72:75], a[160:163], v[216:219], v[72:75]
    v_exp_f32 v246, v206
    s_add_u32 m0, s52, 33888
    v_mfma_f32_16x16x32_bf16 v[72:75], a[164:167], v[220:223], v[72:75]
    s_waitcnt vmcnt(5)
    buffer_load_dwordx4 v2, s[24:27], s49 offen offset:3072 nt lds
    v_or3_b32 v11, v11, v229, v230
    v_mfma_f32_16x16x32_bf16 v[76:79], a[168:171], v[216:219], v[76:79]
    v_exp_f32 v247, v207
    v_mfma_f32_16x16x32_bf16 v[76:79], a[172:175], v[220:223], v[76:79]
    v_cvt_pk_bf16_f32 v231, v246, v247
    v_mfma_f32_16x16x32_bf16 a[244:247], a[252:255], v[216:219], a[244:247]
    v_bitop3_b32 v11, v11, v231, s47 bitop3:0xa8
    v_cmp_ne_u32 vcc, 0, v11
    v_mfma_f32_16x16x32_bf16 a[244:247], a[252:255], v[220:223], a[244:247]
    v_mfma_f32_16x16x32_bf16 v[176:179], a[176:179], v[128:131], v[236:239]
    v_exp_f32 v244, v160
    v_mfma_f32_16x16x32_bf16 v[176:179], a[180:183], v[132:135], v[176:179]
    s_cbranch_vccnz L_st7_2
L_bk7_2:
    v_mfma_f32_16x16x32_bf16 v[176:179], a[184:187], v[136:139], v[176:179]
    v_exp_f32 v245, v161
    s_barrier
    v_mfma_f32_16x16x32_bf16 v[176:179], a[188:191], v[140:143], v[176:179]
    ds_read_b64_tr_b16 a[80:81], v8 offset:0
    v_cvt_pk_bf16_f32 v208, v244, v245
    v_mfma_f32_16x16x32_bf16 v[180:183], a[192:195], v[128:131], v[236:239]
    v_exp_f32 v246, v162
    v_mfma_f32_16x16x32_bf16 v[180:183], a[196:199], v[132:135], v[180:183]
    ds_read_b64_tr_b16 a[82:83], v8 offset:4224
    ds_read_b64_tr_b16 a[84:85], v8 offset:8448
    v_mfma_f32_16x16x32_bf16 v[180:183], a[200:203], v[136:139], v[180:183]
    v_exp_f32 v247, v163
    v_mfma_f32_16x16x32_bf16 v[180:183], a[204:207], v[140:143], v[180:183]
    ds_read_b64_tr_b16 a[86:87], v8 offset:12672
    v_cvt_pk_bf16_f32 v209, v246, v247
    v_mfma_f32_16x16x32_bf16 v[184:187], a[208:211], v[128:131], v[236:239]
    v_exp_f32 v244, v164
    v_mfma_f32_16x16x32_bf16 v[184:187], a[212:215], v[132:135], v[184:187]
    ds_read_b64_tr_b16 a[88:89], v8 offset:32
    ds_read_b64_tr_b16 a[90:91], v8 offset:4256
    v_mfma_f32_16x16x32_bf16 v[184:187], a[216:219], v[136:139], v[184:187]
    v_exp_f32 v245, v165
    s_add_u32 m0, s52, 50688
    s_mov_b32 s49, 163840
    v_mfma_f32_16x16x32_bf16 v[184:187], a[220:223], v[140:143], v[184:187]
    s_waitcnt vmcnt(5)
    buffer_load_dwordx4 v2, s[28:31], s49 offen offset:0 nt lds
    v_cvt_pk_bf16_f32 v210, v244, v245
    v_mfma_f32_16x16x32_bf16 v[188:191], a[224:227], v[128:131], v[236:239]
    v_exp_f32 v246, v166
    v_mfma_f32_16x16x32_bf16 v[188:191], a[228:231], v[132:135], v[188:191]
    ds_read_b64_tr_b16 a[92:93], v8 offset:8480
    v_or3_b32 v11, v208, v209, v210
    v_mfma_f32_16x16x32_bf16 v[188:191], a[232:235], v[136:139], v[188:191]
    v_exp_f32 v247, v167
    v_mfma_f32_16x16x32_bf16 v[188:191], a[236:239], v[140:143], v[188:191]
    ds_read_b64_tr_b16 a[94:95], v8 offset:12704
    v_cvt_pk_bf16_f32 v211, v246, v247
    v_mfma_f32_16x16x32_bf16 v[80:83], a[112:115], v[224:227], v[80:83]
    v_exp_f32 v244, v168
    v_mfma_f32_16x16x32_bf16 v[80:83], a[116:119], v[228:231], v[80:83]
    ds_read_b64_tr_b16 a[96:97], v8 offset:256
    ds_read_b64_tr_b16 a[98:99], v8 offset:4480
    v_mfma_f32_16x16x32_bf16 v[84:87], a[120:123], v[224:227], v[84:87]
    v_exp_f32 v245, v169
    v_mfma_f32_16x16x32_bf16 v[84:87], a[124:127], v[228:231], v[84:87]
    ds_read_b64_tr_b16 a[100:101], v8 offset:8704
    v_cvt_pk_bf16_f32 v212, v244, v245
    v_mfma_f32_16x16x32_bf16 v[88:91], a[128:131], v[224:227], v[88:91]
    v_exp_f32 v246, v170
    v_mfma_f32_16x16x32_bf16 v[88:91], a[132:135], v[228:231], v[88:91]
    ds_read_b64_tr_b16 a[102:103], v8 offset:12928
    v_or3_b32 v11, v11, v211, v212
    v_mfma_f32_16x16x32_bf16 v[92:95], a[136:139], v[224:227], v[92:95]
    v_exp_f32 v247, v171
    s_add_u32 m0, s52, 50720
    v_mfma_f32_16x16x32_bf16 v[92:95], a[140:143], v[228:231], v[92:95]
    s_waitcnt vmcnt(5)
    buffer_load_dwordx4 v2, s[28:31], s49 offen offset:1024 nt lds
    v_cvt_pk_bf16_f32 v213, v246, v247
    v_mfma_f32_16x16x32_bf16 v[96:99], a[144:147], v[224:227], v[96:99]
    v_exp_f32 v244, v172
    v_mfma_f32_16x16x32_bf16 v[96:99], a[148:151], v[228:231], v[96:99]
    ds_read_b64_tr_b16 a[104:105], v8 offset:288
    ds_read_b64_tr_b16 a[106:107], v8 offset:4512
    v_mfma_f32_16x16x32_bf16 v[100:103], a[152:155], v[224:227], v[100:103]
    v_exp_f32 v245, v173
    v_mfma_f32_16x16x32_bf16 v[100:103], a[156:159], v[228:231], v[100:103]
    ds_read_b64_tr_b16 a[108:109], v8 offset:8736
    v_cvt_pk_bf16_f32 v214, v244, v245
    v_mfma_f32_16x16x32_bf16 v[104:107], a[160:163], v[224:227], v[104:107]
    v_exp_f32 v246, v174
    v_mfma_f32_16x16x32_bf16 v[104:107], a[164:167], v[228:231], v[104:107]
    ds_read_b64_tr_b16 a[110:111], v8 offset:12960
    v_or3_b32 v11, v11, v213, v214
    v_mfma_f32_16x16x32_bf16 v[108:111], a[168:171], v[224:227], v[108:111]
    v_exp_f32 v247, v175
    v_mfma_f32_16x16x32_bf16 v[108:111], a[172:175], v[228:231], v[108:111]
    ds_read_b64_tr_b16 a[144:145], v8 offset:512
    v_cvt_pk_bf16_f32 v215, v246, v247
    v_mfma_f32_16x16x32_bf16 a[248:251], a[252:255], v[224:227], a[248:251]
    v_bitop3_b32 v11, v11, v215, s47 bitop3:0xa8
    v_cmp_ne_u32 vcc, 0, v11
    v_mfma_f32_16x16x32_bf16 a[248:251], a[252:255], v[228:231], a[248:251]
    ds_read_b64_tr_b16 a[146:147], v8 offset:4736
    ds_read_b64_tr_b16 a[148:149], v8 offset:8960
    v_mfma_f32_16x16x32_bf16 v[192:195], a[176:179], v[144:147], v[240:243]
    v_exp_f32 v244, v176
    v_mfma_f32_16x16x32_bf16 v[192:195], a[180:183], v[148:151], v[192:195]
    ds_read_b64_tr_b16 a[150:151], v8 offset:13184
    s_cbranch_vccnz L_st8_0
L_bk8_0:
    v_mfma_f32_16x16x32_bf16 v[192:195], a[184:187], v[152:155], v[192:195]
    v_exp_f32 v245, v177
    s_add_u32 m0, s52, 50752
    v_mfma_f32_16x16x32_bf16 v[192:195], a[188:191], v[156:159], v[192:195]
    s_waitcnt vmcnt(5)
    buffer_load_dwordx4 v2, s[28:31], s49 offen offset:2048 nt lds
    v_cvt_pk_bf16_f32 v216, v244, v245
    v_mfma_f32_16x16x32_bf16 v[196:199], a[192:195], v[144:147], v[240:243]
    v_exp_f32 v246, v178
    v_mfma_f32_16x16x32_bf16 v[196:199], a[196:199], v[148:151], v[196:199]
    ds_read_b64_tr_b16 a[152:153], v8 offset:544
    ds_read_b64_tr_b16 a[154:155], v8 offset:4768
    v_mfma_f32_16x16x32_bf16 v[196:199], a[200:203], v[152:155], v[196:199]
    v_exp_f32 v247, v179
    v_mfma_f32_16x16x32_bf16 v[196:199], a[204:207], v[156:159], v[196:199]
    ds_read_b64_tr_b16 a[156:157], v8 offset:8992
    v_cvt_pk_bf16_f32 v217, v246, v247
    v_mfma_f32_16x16x32_bf16 v[200:203], a[208:211], v[144:147], v[240:243]
    v_exp_f32 v244, v180
    v_mfma_f32_16x16x32_bf16 v[200:203], a[212:215], v[148:151], v[200:203]
    ds_read_b64_tr_b16 a[158:159], v8 offset:13216
    ds_read_b64_tr_b16 a[160:161], v8 offset:768
    v_mfma_f32_16x16x32_bf16 v[200:203], a[216:219], v[152:155], v[200:203]
    v_exp_f32 v245, v181
    v_mfma_f32_16x16x32_bf16 v[200:203], a[220:223], v[156:159], v[200:203]
    ds_read_b64_tr_b16 a[162:163], v8 offset:4992
    v_cvt_pk_bf16_f32 v218, v244, v245
    v_mfma_f32_16x16x32_bf16 v[204:207], a[224:227], v[144:147], v[240:243]
    v_exp_f32 v246, v182
    v_mfma_f32_16x16x32_bf16 v[204:207], a[228:231], v[148:151], v[204:207]
    ds_read_b64_tr_b16 a[164:165], v8 offset:9216
    v_or3_b32 v11, v216, v217, v218
    v_mfma_f32_16x16x32_bf16 v[204:207], a[232:235], v[152:155], v[204:207]
    v_exp_f32 v247, v183
    s_add_u32 m0, s52, 50784
    v_mfma_f32_16x16x32_bf16 v[204:207], a[236:239], v[156:159], v[204:207]
    s_waitcnt vmcnt(5)
    buffer_load_dwordx4 v2, s[28:31], s49 offen offset:3072 nt lds
    v_cvt_pk_bf16_f32 v219, v246, v247
    s_waitcnt lgkmcnt(11)
    v_mfma_f32_16x16x32_bf16 v[16:19], a[80:83], v[208:211], v[16:19]
    v_exp_f32 v244, v184
    v_mfma_f32_16x16x32_bf16 v[16:19], a[84:87], v[212:215], v[16:19]
    ds_read_b64_tr_b16 a[166:167], v8 offset:13440
    ds_read_b64_tr_b16 a[168:169], v8 offset:800
    v_mfma_f32_16x16x32_bf16 v[20:23], a[88:91], v[208:211], v[20:23]
    v_exp_f32 v245, v185
    v_mfma_f32_16x16x32_bf16 v[20:23], a[92:95], v[212:215], v[20:23]
    ds_read_b64_tr_b16 a[170:171], v8 offset:5024
    v_cvt_pk_bf16_f32 v220, v244, v245
    v_mfma_f32_16x16x32_bf16 v[24:27], a[96:99], v[208:211], v[24:27]
    ds_read_b64_tr_b16 a[172:173], v8 offset:9248
    ds_read_b64_tr_b16 a[174:175], v8 offset:13472
    v_exp_f32 v246, v186
    v_mfma_f32_16x16x32_bf16 v[24:27], a[100:103], v[212:215], v[24:27]
    ds_read_b128 a[176:179], v5 offset:0
    v_or3_b32 v11, v11, v219, v220
    v_mfma_f32_16x16x32_bf16 v[28:31], a[104:107], v[208:211], v[28:31]
    v_exp_f32 v247, v187
    v_mfma_f32_16x16x32_bf16 v[28:31], a[108:111], v[212:215], v[28:31]
    ds_read_b128 a[180:183], v5 offset:256
    v_cvt_pk_bf16_f32 v221, v246, v247
    s_waitcnt lgkmcnt(10)
    v_mfma_f32_16x16x32_bf16 v[32:35], a[144:147], v[208:211], v[32:35]
    v_exp_f32 v244, v188
    v_mfma_f32_16x16x32_bf16 v[32:35], a[148:151], v[212:215], v[32:35]
    ds_read_b128 a[184:187], v5 offset:512
    ds_read_b128 a[188:191], v5 offset:768
    v_mfma_f32_16x16x32_bf16 v[36:39], a[152:155], v[208:211], v[36:39]
    v_exp_f32 v245, v189
    s_add_u32 m0, s52, 67584
    s_mov_b32 s49, 180224
    v_mfma_f32_16x16x32_bf16 v[36:39], a[156:159], v[212:215], v[36:39]
    s_waitcnt vmcnt(5)
    buffer_load_dwordx4 v2, s[24:27], s49 offen offset:0 nt lds
    v_cvt_pk_bf16_f32 v222, v244, v245
    s_waitcnt lgkmcnt(4)
    v_mfma_f32_16x16x32_bf16 v[40:43], a[160:163], v[208:211], v[40:43]
    v_exp_f32 v246, v190
    v_mfma_f32_16x16x32_bf16 v[40:43], a[164:167], v[212:215], v[40:43]
    ds_read_b128 a[192:195], v5 offset:4224
    v_or3_b32 v11, v11, v221, v222
    v_mfma_f32_16x16x32_bf16 v[44:47], a[168:171], v[208:211], v[44:47]
    ds_read_b128 a[196:199], v5 offset:4480
    ds_read_b128 a[200:203], v5 offset:4736
    ds_read_b128 a[204:207], v5 offset:4992
    v_exp_f32 v247, v191
    v_mfma_f32_16x16x32_bf16 v[44:47], a[172:175], v[212:215], v[44:47]
    ds_read_b128 a[208:211], v5 offset:8448
    v_cvt_pk_bf16_f32 v223, v246, v247
    v_mfma_f32_16x16x32_bf16 a[240:243], a[252:255], v[208:211], a[240:243]
    v_bitop3_b32 v11, v11, v223, s47 bitop3:0xa8
    v_cmp_ne_u32 vcc, 0, v11
    v_mfma_f32_16x16x32_bf16 a[240:243], a[252:255], v[212:215], a[240:243]
    ds_read_b128 a[212:215], v5 offset:8704
    ds_read_b128 a[216:219], v5 offset:8960
    s_waitcnt lgkmcnt(7)
    v_mfma_f32_16x16x32_bf16 v[160:163], a[176:179], v[112:115], v[232:235]
    ds_read_b128 a[220:223], v5 offset:9216
    v_exp_f32 v244, v192
    v_mfma_f32_16x16x32_bf16 v[160:163], a[180:183], v[116:119], v[160:163]
    ds_read_b128 a[224:227], v5 offset:12672
    s_cbranch_vccnz L_st8_1
L_bk8_1:
    v_mfma_f32_16x16x32_bf16 v[160:163], a[184:187], v[120:123], v[160:163]
    v_exp_f32 v245, v193
    v_mfma_f32_16x16x32_bf16 v[160:163], a[188:191], v[124:127], v[160:163]
    ds_read_b128 a[228:231], v5 offset:12928
    v_cvt_pk_bf16_f32 v224, v244, v245
    s_waitcnt lgkmcnt(6)
    v_mfma_f32_16x16x32_bf16 v[164:167], a[192:195], v[112:115], v[232:235]
    ds_read_b128 a[232:235], v5 offset:13184
    ds_read_b128 a[236:239], v5 offset:13440
    v_exp_f32 v246, v194
    v_mfma_f32_16x16x32_bf16 v[164:167], a[196:199], v[116:119], v[164:167]
    v_mfma_f32_16x16x32_bf16 v[164:167], a[200:203], v[120:123], v[164:167]
    v_exp_f32 v247, v195
    v_mfma_f32_16x16x32_bf16 v[164:167], a[204:207], v[124:127], v[164:167]
    v_cvt_pk_bf16_f32 v225, v246, v247
    s_waitcnt lgkmcnt(4)
    v_mfma_f32_16x16x32_bf16 v[168:171], a[208:211], v[112:115], v[232:235]
    v_exp_f32 v244, v196
    s_add_u32 m0, s52, 67616
    v_mfma_f32_16x16x32_bf16 v[168:171], a[212:215], v[116:119], v[168:171]
    s_waitcnt vmcnt(5)
    buffer_load_dwordx4 v2, s[24:27], s49 offen offset:1024 nt lds
    v_mfma_f32_16x16x32_bf16 v[168:171], a[216:219], v[120:123], v[168:171]
    v_exp_f32 v245, v197
    v_mfma_f32_16x16x32_bf16 v[168:171], a[220:223], v[124:127], v[168:171]
    v_cvt_pk_bf16_f32 v226, v244, v245
    s_waitcnt lgkmcnt(0)
    v_mfma_f32_16x16x32_bf16 v[172:175], a[224:227], v[112:115], v[232:235]
    v_exp_f32 v246, v198
    v_mfma_f32_16x16x32_bf16 v[172:175], a[228:231], v[116:119], v[172:175]
    v_or3_b32 v11, v224, v225, v226
    s_lshl_b32 s56, s40, 14
    s_mul_i32 s55, s97, 788736
    s_add_u32 s55, s55, s56
    s_lshl_b32 s56, s42, 16
    s_add_u32 s55, s55, s56
    s_add_u32 s16, s36, s55
    s_addc_u32 s17, s37, 0
    s_mov_b32 s18, 673664
    v_mfma_f32_16x16x32_bf16 v[172:175], a[232:235], v[120:123], v[172:175]
    v_exp_f32 v247, v199
    v_mfma_f32_16x16x32_bf16 v[172:175], a[236:239], v[124:127], v[172:175]
    v_cvt_pk_bf16_f32 v227, v246, v247
    v_mfma_f32_16x16x32_bf16 v[48:51], a[80:83], v[216:219], v[48:51]
    v_exp_f32 v244, v200
    v_mfma_f32_16x16x32_bf16 v[48:51], a[84:87], v[220:223], v[48:51]
    v_mfma_f32_16x16x32_bf16 v[52:55], a[88:91], v[216:219], v[52:55]
    v_exp_f32 v245, v201
    s_add_u32 m0, s52, 67648
    v_mfma_f32_16x16x32_bf16 v[52:55], a[92:95], v[220:223], v[52:55]
    s_waitcnt vmcnt(5)
    buffer_load_dwordx4 v2, s[24:27], s49 offen offset:2048 nt lds
    v_cvt_pk_bf16_f32 v228, v244, v245
    v_mfma_f32_16x16x32_bf16 v[56:59], a[96:99], v[216:219], v[56:59]
    v_exp_f32 v246, v202
    v_mfma_f32_16x16x32_bf16 v[56:59], a[100:103], v[220:223], v[56:59]
    v_or3_b32 v11, v11, v227, v228
    v_mfma_f32_16x16x32_bf16 v[60:63], a[104:107], v[216:219], v[60:63]
    v_exp_f32 v247, v203
    v_mfma_f32_16x16x32_bf16 v[60:63], a[108:111], v[220:223], v[60:63]
    v_cvt_pk_bf16_f32 v229, v246, v247
    v_mfma_f32_16x16x32_bf16 v[64:67], a[144:147], v[216:219], v[64:67]
    v_exp_f32 v244, v204
    v_mfma_f32_16x16x32_bf16 v[64:67], a[148:151], v[220:223], v[64:67]
    v_mfma_f32_16x16x32_bf16 v[68:71], a[152:155], v[216:219], v[68:71]
    v_exp_f32 v245, v205
    v_mfma_f32_16x16x32_bf16 v[68:71], a[156:159], v[220:223], v[68:71]
    v_cvt_pk_bf16_f32 v230, v244, v245
    v_mfma_f32_16x16x32_bf16 v[72:75], a[160:163], v[216:219], v[72:75]
    v_exp_f32 v246, v206
    s_add_u32 m0, s52, 67680
    v_mfma_f32_16x16x32_bf16 v[72:75], a[164:167], v[220:223], v[72:75]
    s_waitcnt vmcnt(5)
    buffer_load_dwordx4 v2, s[24:27], s49 offen offset:3072 nt lds
    v_or3_b32 v11, v11, v229, v230
    v_mfma_f32_16x16x32_bf16 v[76:79], a[168:171], v[216:219], v[76:79]
    v_exp_f32 v247, v207
    v_mfma_f32_16x16x32_bf16 v[76:79], a[172:175], v[220:223], v[76:79]
    v_cvt_pk_bf16_f32 v231, v246, v247
    v_mfma_f32_16x16x32_bf16 a[244:247], a[252:255], v[216:219], a[244:247]
    v_bitop3_b32 v11, v11, v231, s47 bitop3:0xa8
    v_cmp_ne_u32 vcc, 0, v11
    v_mfma_f32_16x16x32_bf16 a[244:247], a[252:255], v[220:223], a[244:247]
    v_mfma_f32_16x16x32_bf16 v[176:179], a[176:179], v[128:131], v[236:239]
    v_exp_f32 v244, v160
    v_mfma_f32_16x16x32_bf16 v[176:179], a[180:183], v[132:135], v[176:179]
    s_cbranch_vccnz L_st8_2
L_bk8_2:
    v_mfma_f32_16x16x32_bf16 v[176:179], a[184:187], v[136:139], v[176:179]
    v_exp_f32 v245, v161
    s_barrier
    v_mfma_f32_16x16x32_bf16 v[176:179], a[188:191], v[140:143], v[176:179]
    ds_read_b64_tr_b16 a[112:113], v7 offset:0
    v_cvt_pk_bf16_f32 v208, v244, v245
    v_mfma_f32_16x16x32_bf16 v[180:183], a[192:195], v[128:131], v[236:239]
    v_exp_f32 v246, v162
    v_mfma_f32_16x16x32_bf16 v[180:183], a[196:199], v[132:135], v[180:183]
    ds_read_b64_tr_b16 a[114:115], v7 offset:4224
    ds_read_b64_tr_b16 a[116:117], v7 offset:8448
    v_mfma_f32_16x16x32_bf16 v[180:183], a[200:203], v[136:139], v[180:183]
    v_exp_f32 v247, v163
    v_mfma_f32_16x16x32_bf16 v[180:183], a[204:207], v[140:143], v[180:183]
    ds_read_b64_tr_b16 a[118:119], v7 offset:12672
    v_cvt_pk_bf16_f32 v209, v246, v247
    v_mfma_f32_16x16x32_bf16 v[184:187], a[208:211], v[128:131], v[236:239]
    v_exp_f32 v244, v164
    v_mfma_f32_16x16x32_bf16 v[184:187], a[212:215], v[132:135], v[184:187]
    ds_read_b64_tr_b16 a[120:121], v7 offset:32
    ds_read_b64_tr_b16 a[122:123], v7 offset:4256
    v_mfma_f32_16x16x32_bf16 v[184:187], a[216:219], v[136:139], v[184:187]
    v_exp_f32 v245, v165
    s_add_u32 m0, s52, 84480
    s_mov_b32 s49, 180224
    v_mfma_f32_16x16x32_bf16 v[184:187], a[220:223], v[140:143], v[184:187]
    s_waitcnt vmcnt(4)
    buffer_load_dwordx4 v2, s[28:31], s49 offen offset:0 nt lds
    v_cvt_pk_bf16_f32 v210, v244, v245
    v_mfma_f32_16x16x32_bf16 v[188:191], a[224:227], v[128:131], v[236:239]
    v_exp_f32 v246, v166
    v_mfma_f32_16x16x32_bf16 v[188:191], a[228:231], v[132:135], v[188:191]
    ds_read_b64_tr_b16 a[124:125], v7 offset:8480
    v_or3_b32 v11, v208, v209, v210
    v_mfma_f32_16x16x32_bf16 v[188:191], a[232:235], v[136:139], v[188:191]
    v_exp_f32 v247, v167
    v_mfma_f32_16x16x32_bf16 v[188:191], a[236:239], v[140:143], v[188:191]
    ds_read_b64_tr_b16 a[126:127], v7 offset:12704
    v_cvt_pk_bf16_f32 v211, v246, v247
    v_mfma_f32_16x16x32_bf16 v[80:83], a[80:83], v[224:227], v[80:83]
    v_exp_f32 v244, v168
    v_mfma_f32_16x16x32_bf16 v[80:83], a[84:87], v[228:231], v[80:83]
    ds_read_b64_tr_b16 a[128:129], v7 offset:256
    ds_read_b64_tr_b16 a[130:131], v7 offset:4480
    v_mfma_f32_16x16x32_bf16 v[84:87], a[88:91], v[224:227], v[84:87]
    v_exp_f32 v245, v169
    v_mfma_f32_16x16x32_bf16 v[84:87], a[92:95], v[228:231], v[84:87]
    ds_read_b64_tr_b16 a[132:133], v7 offset:8704
    v_cvt_pk_bf16_f32 v212, v244, v245
    v_mfma_f32_16x16x32_bf16 v[88:91], a[96:99], v[224:227], v[88:91]
    v_exp_f32 v246, v170
    v_mfma_f32_16x16x32_bf16 v[88:91], a[100:103], v[228:231], v[88:91]
    ds_read_b64_tr_b16 a[134:135], v7 offset:12928
    v_or3_b32 v11, v11, v211, v212
    v_mfma_f32_16x16x32_bf16 v[92:95], a[104:107], v[224:227], v[92:95]
    v_exp_f32 v247, v171
    s_add_u32 m0, s52, 84512
    v_mfma_f32_16x16x32_bf16 v[92:95], a[108:111], v[228:231], v[92:95]
    s_waitcnt vmcnt(4)
    buffer_load_dwordx4 v2, s[28:31], s49 offen offset:1024 nt lds
    v_cvt_pk_bf16_f32 v213, v246, v247
    v_mfma_f32_16x16x32_bf16 v[96:99], a[144:147], v[224:227], v[96:99]
    v_exp_f32 v244, v172
    v_mfma_f32_16x16x32_bf16 v[96:99], a[148:151], v[228:231], v[96:99]
    ds_read_b64_tr_b16 a[136:137], v7 offset:288
    ds_read_b64_tr_b16 a[138:139], v7 offset:4512
    v_mfma_f32_16x16x32_bf16 v[100:103], a[152:155], v[224:227], v[100:103]
    v_exp_f32 v245, v173
    v_mfma_f32_16x16x32_bf16 v[100:103], a[156:159], v[228:231], v[100:103]
    ds_read_b64_tr_b16 a[140:141], v7 offset:8736
    v_cvt_pk_bf16_f32 v214, v244, v245
    v_mfma_f32_16x16x32_bf16 v[104:107], a[160:163], v[224:227], v[104:107]
    v_exp_f32 v246, v174
    v_mfma_f32_16x16x32_bf16 v[104:107], a[164:167], v[228:231], v[104:107]
    ds_read_b64_tr_b16 a[142:143], v7 offset:12960
    v_or3_b32 v11, v11, v213, v214
    v_mfma_f32_16x16x32_bf16 v[108:111], a[168:171], v[224:227], v[108:111]
    v_exp_f32 v247, v175
    v_mfma_f32_16x16x32_bf16 v[108:111], a[172:175], v[228:231], v[108:111]
    ds_read_b64_tr_b16 a[144:145], v7 offset:512
    v_cvt_pk_bf16_f32 v215, v246, v247
    v_mfma_f32_16x16x32_bf16 a[248:251], a[252:255], v[224:227], a[248:251]
    v_bitop3_b32 v11, v11, v215, s47 bitop3:0xa8
    v_cmp_ne_u32 vcc, 0, v11
    v_mfma_f32_16x16x32_bf16 a[248:251], a[252:255], v[228:231], a[248:251]
    ds_read_b64_tr_b16 a[146:147], v7 offset:4736
    ds_read_b64_tr_b16 a[148:149], v7 offset:8960
    v_mfma_f32_16x16x32_bf16 v[192:195], a[176:179], v[144:147], v[240:243]
    v_exp_f32 v244, v176
    v_mfma_f32_16x16x32_bf16 v[192:195], a[180:183], v[148:151], v[192:195]
    ds_read_b64_tr_b16 a[150:151], v7 offset:13184
    s_cbranch_vccnz L_st9_0
L_bk9_0:
    v_mfma_f32_16x16x32_bf16 v[192:195], a[184:187], v[152:155], v[192:195]
    v_exp_f32 v245, v177
    s_add_u32 m0, s52, 84544
    v_mfma_f32_16x16x32_bf16 v[192:195], a[188:191], v[156:159], v[192:195]
    s_waitcnt vmcnt(4)
    buffer_load_dwordx4 v2, s[28:31], s49 offen offset:2048 nt lds
    v_cvt_pk_bf16_f32 v216, v244, v245
    v_mfma_f32_16x16x32_bf16 v[196:199], a[192:195], v[144:147], v[240:243]
    v_exp_f32 v246, v178
    v_mfma_f32_16x16x32_bf16 v[196:199], a[196:199], v[148:151], v[196:199]
    ds_read_b64_tr_b16 a[152:153], v7 offset:544
    ds_read_b64_tr_b16 a[154:155], v7 offset:4768
    v_mfma_f32_16x16x32_bf16 v[196:199], a[200:203], v[152:155], v[196:199]
    v_exp_f32 v247, v179
    v_mfma_f32_16x16x32_bf16 v[196:199], a[204:207], v[156:159], v[196:199]
    ds_read_b64_tr_b16 a[156:157], v7 offset:8992
    v_cvt_pk_bf16_f32 v217, v246, v247
    v_mfma_f32_16x16x32_bf16 v[200:203], a[208:211], v[144:147], v[240:243]
    v_exp_f32 v244, v180
    v_mfma_f32_16x16x32_bf16 v[200:203], a[212:215], v[148:151], v[200:203]
    ds_read_b64_tr_b16 a[158:159], v7 offset:13216
    ds_read_b64_tr_b16 a[160:161], v7 offset:768
    v_mfma_f32_16x16x32_bf16 v[200:203], a[216:219], v[152:155], v[200:203]
    v_exp_f32 v245, v181
    v_mfma_f32_16x16x32_bf16 v[200:203], a[220:223], v[156:159], v[200:203]
    ds_read_b64_tr_b16 a[162:163], v7 offset:4992
    v_cvt_pk_bf16_f32 v218, v244, v245
    v_mfma_f32_16x16x32_bf16 v[204:207], a[224:227], v[144:147], v[240:243]
    v_exp_f32 v246, v182
    v_mfma_f32_16x16x32_bf16 v[204:207], a[228:231], v[148:151], v[204:207]
    ds_read_b64_tr_b16 a[164:165], v7 offset:9216
    v_or3_b32 v11, v216, v217, v218
    v_mfma_f32_16x16x32_bf16 v[204:207], a[232:235], v[152:155], v[204:207]
    v_exp_f32 v247, v183
    s_add_u32 m0, s52, 84576
    v_mfma_f32_16x16x32_bf16 v[204:207], a[236:239], v[156:159], v[204:207]
    s_waitcnt vmcnt(4)
    buffer_load_dwordx4 v2, s[28:31], s49 offen offset:3072 nt lds
    v_cvt_pk_bf16_f32 v219, v246, v247
    s_waitcnt lgkmcnt(11)
    v_mfma_f32_16x16x32_bf16 v[16:19], a[112:115], v[208:211], v[16:19]
    v_exp_f32 v244, v184
    v_mfma_f32_16x16x32_bf16 v[16:19], a[116:119], v[212:215], v[16:19]
    ds_read_b64_tr_b16 a[166:167], v7 offset:13440
    ds_read_b64_tr_b16 a[168:169], v7 offset:800
    v_mfma_f32_16x16x32_bf16 v[20:23], a[120:123], v[208:211], v[20:23]
    v_exp_f32 v245, v185
    v_mfma_f32_16x16x32_bf16 v[20:23], a[124:127], v[212:215], v[20:23]
    ds_read_b64_tr_b16 a[170:171], v7 offset:5024
    v_cvt_pk_bf16_f32 v220, v244, v245
    v_mfma_f32_16x16x32_bf16 v[24:27], a[128:131], v[208:211], v[24:27]
    ds_read_b64_tr_b16 a[172:173], v7 offset:9248
    ds_read_b64_tr_b16 a[174:175], v7 offset:13472
    v_exp_f32 v246, v186
    v_mfma_f32_16x16x32_bf16 v[24:27], a[132:135], v[212:215], v[24:27]
    ds_read_b128 a[176:179], v5 offset:33792
    v_or3_b32 v11, v11, v219, v220
    v_mfma_f32_16x16x32_bf16 v[28:31], a[136:139], v[208:211], v[28:31]
    v_exp_f32 v247, v187
    v_mfma_f32_16x16x32_bf16 v[28:31], a[140:143], v[212:215], v[28:31]
    ds_read_b128 a[180:183], v5 offset:34048
    v_cvt_pk_bf16_f32 v221, v246, v247
    s_waitcnt lgkmcnt(10)
    v_mfma_f32_16x16x32_bf16 v[32:35], a[144:147], v[208:211], v[32:35]
    v_exp_f32 v244, v188
    v_mfma_f32_16x16x32_bf16 v[32:35], a[148:151], v[212:215], v[32:35]
    ds_read_b128 a[184:187], v5 offset:34304
    ds_read_b128 a[188:191], v5 offset:34560
    v_mfma_f32_16x16x32_bf16 v[36:39], a[152:155], v[208:211], v[36:39]
    v_exp_f32 v245, v189
    s_add_u32 m0, s52, 0
    s_mov_b32 s49, 196608
    v_mfma_f32_16x16x32_bf16 v[36:39], a[156:159], v[212:215], v[36:39]
    s_waitcnt vmcnt(4)
    buffer_load_dwordx4 v2, s[24:27], s49 offen offset:0 nt lds
    v_cvt_pk_bf16_f32 v222, v244, v245
    s_waitcnt lgkmcnt(4)
    v_mfma_f32_16x16x32_bf16 v[40:43], a[160:163], v[208:211], v[40:43]
    v_exp_f32 v246, v190
    v_mfma_f32_16x16x32_bf16 v[40:43], a[164:167], v[212:215], v[40:43]
    ds_read_b128 a[192:195], v5 offset:38016
    v_or3_b32 v11, v11, v221, v222
    v_mfma_f32_16x16x32_bf16 v[44:47], a[168:171], v[208:211], v[44:47]
    ds_read_b128 a[196:199], v5 offset:38272
    ds_read_b128 a[200:203], v5 offset:38528
    ds_read_b128 a[204:207], v5 offset:38784
    v_exp_f32 v247, v191
    v_mfma_f32_16x16x32_bf16 v[44:47], a[172:175], v[212:215], v[44:47]
    ds_read_b128 a[208:211], v5 offset:42240
    v_cvt_pk_bf16_f32 v223, v246, v247
    v_mfma_f32_16x16x32_bf16 a[240:243], a[252:255], v[208:211], a[240:243]
    v_bitop3_b32 v11, v11, v223, s47 bitop3:0xa8
    v_cmp_ne_u32 vcc, 0, v11
    v_mfma_f32_16x16x32_bf16 a[240:243], a[252:255], v[212:215], a[240:243]
    ds_read_b128 a[212:215], v5 offset:42496
    ds_read_b128 a[216:219], v5 offset:42752
    s_waitcnt lgkmcnt(7)
    v_mfma_f32_16x16x32_bf16 v[160:163], a[176:179], v[112:115], v[232:235]
    ds_read_b128 a[220:223], v5 offset:43008
    v_exp_f32 v244, v192
    v_mfma_f32_16x16x32_bf16 v[160:163], a[180:183], v[116:119], v[160:163]
    ds_read_b128 a[224:227], v5 offset:46464
    s_cbranch_vccnz L_st9_1
L_bk9_1:
    v_mfma_f32_16x16x32_bf16 v[160:163], a[184:187], v[120:123], v[160:163]
    v_exp_f32 v245, v193
    v_mfma_f32_16x16x32_bf16 v[160:163], a[188:191], v[124:127], v[160:163]
    ds_read_b128 a[228:231], v5 offset:46720
    v_cvt_pk_bf16_f32 v224, v244, v245
    s_waitcnt lgkmcnt(6)
    v_mfma_f32_16x16x32_bf16 v[164:167], a[192:195], v[112:115], v[232:235]
    ds_read_b128 a[232:235], v5 offset:46976
    ds_read_b128 a[236:239], v5 offset:47232
    v_exp_f32 v246, v194
    v_mfma_f32_16x16x32_bf16 v[164:167], a[196:199], v[116:119], v[164:167]
    v_mfma_f32_16x16x32_bf16 v[164:167], a[200:203], v[120:123], v[164:167]
    v_exp_f32 v247, v195
    v_mfma_f32_16x16x32_bf16 v[164:167], a[204:207], v[124:127], v[164:167]
    v_cvt_pk_bf16_f32 v225, v246, v247
    s_waitcnt lgkmcnt(4)
    v_mfma_f32_16x16x32_bf16 v[168:171], a[208:211], v[112:115], v[232:235]
    v_exp_f32 v244, v196
    s_add_u32 m0, s52, 32
    v_mfma_f32_16x16x32_bf16 v[168:171], a[212:215], v[116:119], v[168:171]
    s_waitcnt vmcnt(4)
    buffer_load_dwordx4 v2, s[24:27], s49 offen offset:1024 nt lds
    v_mfma_f32_16x16x32_bf16 v[168:171], a[216:219], v[120:123], v[168:171]
    v_exp_f32 v245, v197
    v_mfma_f32_16x16x32_bf16 v[168:171], a[220:223], v[124:127], v[168:171]
    v_cvt_pk_bf16_f32 v226, v244, v245
    s_waitcnt lgkmcnt(0)
    v_mfma_f32_16x16x32_bf16 v[172:175], a[224:227], v[112:115], v[232:235]
    v_exp_f32 v246, v198
    v_mfma_f32_16x16x32_bf16 v[172:175], a[228:231], v[116:119], v[172:175]
    v_or3_b32 v11, v224, v225, v226
    s_lshl_b32 s57, s43, 2
    s_add_u32 s57, s57, s40
    s_mul_i32 s57, s57, 394368
    s_lshl_b32 s56, s44, 12
    s_add_u32 s57, s57, s56
    v_mfma_f32_16x16x32_bf16 v[172:175], a[232:235], v[120:123], v[172:175]
    v_exp_f32 v247, v199
    v_mfma_f32_16x16x32_bf16 v[172:175], a[236:239], v[124:127], v[172:175]
    v_cvt_pk_bf16_f32 v227, v246, v247
    v_mfma_f32_16x16x32_bf16 v[48:51], a[112:115], v[216:219], v[48:51]
    v_exp_f32 v244, v200
    v_mfma_f32_16x16x32_bf16 v[48:51], a[116:119], v[220:223], v[48:51]
    v_mfma_f32_16x16x32_bf16 v[52:55], a[120:123], v[216:219], v[52:55]
    v_exp_f32 v245, v201
    s_add_u32 m0, s52, 64
    v_mfma_f32_16x16x32_bf16 v[52:55], a[124:127], v[220:223], v[52:55]
    s_waitcnt vmcnt(4)
    buffer_load_dwordx4 v2, s[24:27], s49 offen offset:2048 nt lds
    v_cvt_pk_bf16_f32 v228, v244, v245
    v_mfma_f32_16x16x32_bf16 v[56:59], a[128:131], v[216:219], v[56:59]
    v_exp_f32 v246, v202
    v_mfma_f32_16x16x32_bf16 v[56:59], a[132:135], v[220:223], v[56:59]
    v_or3_b32 v11, v11, v227, v228
    v_mfma_f32_16x16x32_bf16 v[60:63], a[136:139], v[216:219], v[60:63]
    v_exp_f32 v247, v203
    v_mfma_f32_16x16x32_bf16 v[60:63], a[140:143], v[220:223], v[60:63]
    v_cvt_pk_bf16_f32 v229, v246, v247
    v_mfma_f32_16x16x32_bf16 v[64:67], a[144:147], v[216:219], v[64:67]
    v_exp_f32 v244, v204
    v_mfma_f32_16x16x32_bf16 v[64:67], a[148:151], v[220:223], v[64:67]
    v_mfma_f32_16x16x32_bf16 v[68:71], a[152:155], v[216:219], v[68:71]
    v_exp_f32 v245, v205
    v_mfma_f32_16x16x32_bf16 v[68:71], a[156:159], v[220:223], v[68:71]
    v_cvt_pk_bf16_f32 v230, v244, v245
    v_mfma_f32_16x16x32_bf16 v[72:75], a[160:163], v[216:219], v[72:75]
    v_exp_f32 v246, v206
    s_add_u32 m0, s52, 96
    v_mfma_f32_16x16x32_bf16 v[72:75], a[164:167], v[220:223], v[72:75]
    s_waitcnt vmcnt(4)
    buffer_load_dwordx4 v2, s[24:27], s49 offen offset:3072 nt lds
    v_or3_b32 v11, v11, v229, v230
    v_mfma_f32_16x16x32_bf16 v[76:79], a[168:171], v[216:219], v[76:79]
    v_exp_f32 v247, v207
    v_mfma_f32_16x16x32_bf16 v[76:79], a[172:175], v[220:223], v[76:79]
    v_cvt_pk_bf16_f32 v231, v246, v247
    v_mfma_f32_16x16x32_bf16 a[244:247], a[252:255], v[216:219], a[244:247]
    v_bitop3_b32 v11, v11, v231, s47 bitop3:0xa8
    v_cmp_ne_u32 vcc, 0, v11
    v_mfma_f32_16x16x32_bf16 a[244:247], a[252:255], v[220:223], a[244:247]
    v_mfma_f32_16x16x32_bf16 v[176:179], a[176:179], v[128:131], v[236:239]
    v_exp_f32 v244, v160
    v_mfma_f32_16x16x32_bf16 v[176:179], a[180:183], v[132:135], v[176:179]
    s_cbranch_vccnz L_st9_2
L_bk9_2:
    v_mfma_f32_16x16x32_bf16 v[176:179], a[184:187], v[136:139], v[176:179]
    v_exp_f32 v245, v161
    s_barrier
    v_mfma_f32_16x16x32_bf16 v[176:179], a[188:191], v[140:143], v[176:179]
    ds_read_b64_tr_b16 a[80:81], v7 offset:33792
    v_cvt_pk_bf16_f32 v208, v244, v245
    v_mfma_f32_16x16x32_bf16 v[180:183], a[192:195], v[128:131], v[236:239]
    v_exp_f32 v246, v162
    v_mfma_f32_16x16x32_bf16 v[180:183], a[196:199], v[132:135], v[180:183]
    ds_read_b64_tr_b16 a[82:83], v7 offset:38016
    ds_read_b64_tr_b16 a[84:85], v7 offset:42240
    v_mfma_f32_16x16x32_bf16 v[180:183], a[200:203], v[136:139], v[180:183]
    v_exp_f32 v247, v163
    v_mfma_f32_16x16x32_bf16 v[180:183], a[204:207], v[140:143], v[180:183]
    ds_read_b64_tr_b16 a[86:87], v7 offset:46464
    v_cvt_pk_bf16_f32 v209, v246, v247
    v_mfma_f32_16x16x32_bf16 v[184:187], a[208:211], v[128:131], v[236:239]
    v_exp_f32 v244, v164
    v_mfma_f32_16x16x32_bf16 v[184:187], a[212:215], v[132:135], v[184:187]
    ds_read_b64_tr_b16 a[88:89], v7 offset:33824
    ds_read_b64_tr_b16 a[90:91], v7 offset:38048
    v_mfma_f32_16x16x32_bf16 v[184:187], a[216:219], v[136:139], v[184:187]
    v_exp_f32 v245, v165
    s_add_u32 m0, s52, 16896
    s_mov_b32 s49, 196608
    v_mfma_f32_16x16x32_bf16 v[184:187], a[220:223], v[140:143], v[184:187]
    s_waitcnt vmcnt(4)
    buffer_load_dwordx4 v2, s[28:31], s49 offen offset:0 nt lds
    v_cvt_pk_bf16_f32 v210, v244, v245
    v_mfma_f32_16x16x32_bf16 v[188:191], a[224:227], v[128:131], v[236:239]
    v_exp_f32 v246, v166
    v_mfma_f32_16x16x32_bf16 v[188:191], a[228:231], v[132:135], v[188:191]
    ds_read_b64_tr_b16 a[92:93], v7 offset:42272
    v_or3_b32 v11, v208, v209, v210
    v_mfma_f32_16x16x32_bf16 v[188:191], a[232:235], v[136:139], v[188:191]
    v_exp_f32 v247, v167
    v_mfma_f32_16x16x32_bf16 v[188:191], a[236:239], v[140:143], v[188:191]
    ds_read_b64_tr_b16 a[94:95], v7 offset:46496
    v_cvt_pk_bf16_f32 v211, v246, v247
    v_mfma_f32_16x16x32_bf16 v[80:83], a[112:115], v[224:227], v[80:83]
    v_exp_f32 v244, v168
    v_mfma_f32_16x16x32_bf16 v[80:83], a[116:119], v[228:231], v[80:83]
    ds_read_b64_tr_b16 a[96:97], v7 offset:34048
    ds_read_b64_tr_b16 a[98:99], v7 offset:38272
    v_mfma_f32_16x16x32_bf16 v[84:87], a[120:123], v[224:227], v[84:87]
    v_exp_f32 v245, v169
    v_mfma_f32_16x16x32_bf16 v[84:87], a[124:127], v[228:231], v[84:87]
    ds_read_b64_tr_b16 a[100:101], v7 offset:42496
    v_cvt_pk_bf16_f32 v212, v244, v245
    v_mfma_f32_16x16x32_bf16 v[88:91], a[128:131], v[224:227], v[88:91]
    v_exp_f32 v246, v170
    v_mfma_f32_16x16x32_bf16 v[88:91], a[132:135], v[228:231], v[88:91]
    ds_read_b64_tr_b16 a[102:103], v7 offset:46720
    v_or3_b32 v11, v11, v211, v212
    v_mfma_f32_16x16x32_bf16 v[92:95], a[136:139], v[224:227], v[92:95]
    v_exp_f32 v247, v171
    s_add_u32 m0, s52, 16928
    v_mfma_f32_16x16x32_bf16 v[92:95], a[140:143], v[228:231], v[92:95]
    s_waitcnt vmcnt(4)
    buffer_load_dwordx4 v2, s[28:31], s49 offen offset:1024 nt lds
    v_cvt_pk_bf16_f32 v213, v246, v247
    v_mfma_f32_16x16x32_bf16 v[96:99], a[144:147], v[224:227], v[96:99]
    v_exp_f32 v244, v172
    v_mfma_f32_16x16x32_bf16 v[96:99], a[148:151], v[228:231], v[96:99]
    ds_read_b64_tr_b16 a[104:105], v7 offset:34080
    ds_read_b64_tr_b16 a[106:107], v7 offset:38304
    v_mfma_f32_16x16x32_bf16 v[100:103], a[152:155], v[224:227], v[100:103]
    v_exp_f32 v245, v173
    v_mfma_f32_16x16x32_bf16 v[100:103], a[156:159], v[228:231], v[100:103]
    ds_read_b64_tr_b16 a[108:109], v7 offset:42528
    v_cvt_pk_bf16_f32 v214, v244, v245
    v_mfma_f32_16x16x32_bf16 v[104:107], a[160:163], v[224:227], v[104:107]
    v_exp_f32 v246, v174
    v_mfma_f32_16x16x32_bf16 v[104:107], a[164:167], v[228:231], v[104:107]
    ds_read_b64_tr_b16 a[110:111], v7 offset:46752
    v_or3_b32 v11, v11, v213, v214
    v_mfma_f32_16x16x32_bf16 v[108:111], a[168:171], v[224:227], v[108:111]
    v_exp_f32 v247, v175
    v_mfma_f32_16x16x32_bf16 v[108:111], a[172:175], v[228:231], v[108:111]
    ds_read_b64_tr_b16 a[144:145], v7 offset:34304
    v_cvt_pk_bf16_f32 v215, v246, v247
    v_mfma_f32_16x16x32_bf16 a[248:251], a[252:255], v[224:227], a[248:251]
    v_bitop3_b32 v11, v11, v215, s47 bitop3:0xa8
    v_cmp_ne_u32 vcc, 0, v11
    v_mfma_f32_16x16x32_bf16 a[248:251], a[252:255], v[228:231], a[248:251]
    ds_read_b64_tr_b16 a[146:147], v7 offset:38528
    ds_read_b64_tr_b16 a[148:149], v7 offset:42752
    v_mfma_f32_16x16x32_bf16 v[192:195], a[176:179], v[144:147], v[240:243]
    v_exp_f32 v244, v176
    v_mfma_f32_16x16x32_bf16 v[192:195], a[180:183], v[148:151], v[192:195]
    ds_read_b64_tr_b16 a[150:151], v7 offset:46976
    s_cbranch_vccnz L_st10_0
L_bk10_0:
    v_mfma_f32_16x16x32_bf16 v[192:195], a[184:187], v[152:155], v[192:195]
    v_exp_f32 v245, v177
    s_add_u32 m0, s52, 16960
    v_mfma_f32_16x16x32_bf16 v[192:195], a[188:191], v[156:159], v[192:195]
    s_waitcnt vmcnt(4)
    buffer_load_dwordx4 v2, s[28:31], s49 offen offset:2048 nt lds
    v_cvt_pk_bf16_f32 v216, v244, v245
    v_mfma_f32_16x16x32_bf16 v[196:199], a[192:195], v[144:147], v[240:243]
    v_exp_f32 v246, v178
    v_mfma_f32_16x16x32_bf16 v[196:199], a[196:199], v[148:151], v[196:199]
    ds_read_b64_tr_b16 a[152:153], v7 offset:34336
    ds_read_b64_tr_b16 a[154:155], v7 offset:38560
    v_mfma_f32_16x16x32_bf16 v[196:199], a[200:203], v[152:155], v[196:199]
    v_exp_f32 v247, v179
    v_mfma_f32_16x16x32_bf16 v[196:199], a[204:207], v[156:159], v[196:199]
    ds_read_b64_tr_b16 a[156:157], v7 offset:42784
    v_cvt_pk_bf16_f32 v217, v246, v247
    v_mfma_f32_16x16x32_bf16 v[200:203], a[208:211], v[144:147], v[240:243]
    v_exp_f32 v244, v180
    v_mfma_f32_16x16x32_bf16 v[200:203], a[212:215], v[148:151], v[200:203]
    ds_read_b64_tr_b16 a[158:159], v7 offset:47008
    ds_read_b64_tr_b16 a[160:161], v7 offset:34560
    v_mfma_f32_16x16x32_bf16 v[200:203], a[216:219], v[152:155], v[200:203]
    v_exp_f32 v245, v181
    v_mfma_f32_16x16x32_bf16 v[200:203], a[220:223], v[156:159], v[200:203]
    ds_read_b64_tr_b16 a[162:163], v7 offset:38784
    v_cvt_pk_bf16_f32 v218, v244, v245
    v_mfma_f32_16x16x32_bf16 v[204:207], a[224:227], v[144:147], v[240:243]
    v_exp_f32 v246, v182
    v_mfma_f32_16x16x32_bf16 v[204:207], a[228:231], v[148:151], v[204:207]
    ds_read_b64_tr_b16 a[164:165], v7 offset:43008
    v_or3_b32 v11, v216, v217, v218
    v_mfma_f32_16x16x32_bf16 v[204:207], a[232:235], v[152:155], v[204:207]
    v_exp_f32 v247, v183
    s_add_u32 m0, s52, 16992
    v_mfma_f32_16x16x32_bf16 v[204:207], a[236:239], v[156:159], v[204:207]
    s_waitcnt vmcnt(4)
    buffer_load_dwordx4 v2, s[28:31], s49 offen offset:3072 nt lds
    v_cvt_pk_bf16_f32 v219, v246, v247
    s_waitcnt lgkmcnt(11)
    v_mfma_f32_16x16x32_bf16 v[16:19], a[80:83], v[208:211], v[16:19]
    v_exp_f32 v244, v184
    v_mfma_f32_16x16x32_bf16 v[16:19], a[84:87], v[212:215], v[16:19]
    ds_read_b64_tr_b16 a[166:167], v7 offset:47232
    ds_read_b64_tr_b16 a[168:169], v7 offset:34592
    v_mfma_f32_16x16x32_bf16 v[20:23], a[88:91], v[208:211], v[20:23]
    v_exp_f32 v245, v185
    v_mfma_f32_16x16x32_bf16 v[20:23], a[92:95], v[212:215], v[20:23]
    ds_read_b64_tr_b16 a[170:171], v7 offset:38816
    v_cvt_pk_bf16_f32 v220, v244, v245
    v_mfma_f32_16x16x32_bf16 v[24:27], a[96:99], v[208:211], v[24:27]
    ds_read_b64_tr_b16 a[172:173], v7 offset:43040
    ds_read_b64_tr_b16 a[174:175], v7 offset:47264
    v_exp_f32 v246, v186
    v_mfma_f32_16x16x32_bf16 v[24:27], a[100:103], v[212:215], v[24:27]
    ds_read_b128 a[176:179], v6 offset:0
    v_or3_b32 v11, v11, v219, v220
    v_mfma_f32_16x16x32_bf16 v[28:31], a[104:107], v[208:211], v[28:31]
    v_exp_f32 v247, v187
    v_mfma_f32_16x16x32_bf16 v[28:31], a[108:111], v[212:215], v[28:31]
    ds_read_b128 a[180:183], v6 offset:256
    v_cvt_pk_bf16_f32 v221, v246, v247
    s_waitcnt lgkmcnt(10)
    v_mfma_f32_16x16x32_bf16 v[32:35], a[144:147], v[208:211], v[32:35]
    v_exp_f32 v244, v188
    v_mfma_f32_16x16x32_bf16 v[32:35], a[148:151], v[212:215], v[32:35]
    ds_read_b128 a[184:187], v6 offset:512
    ds_read_b128 a[188:191], v6 offset:768
    v_mfma_f32_16x16x32_bf16 v[36:39], a[152:155], v[208:211], v[36:39]
    v_exp_f32 v245, v189
    s_add_u32 m0, s52, 33792
    s_mov_b32 s49, 212992
    v_mfma_f32_16x16x32_bf16 v[36:39], a[156:159], v[212:215], v[36:39]
    s_waitcnt vmcnt(4)
    buffer_load_dwordx4 v2, s[24:27], s49 offen offset:0 nt lds
    v_cvt_pk_bf16_f32 v222, v244, v245
    s_waitcnt lgkmcnt(4)
    v_mfma_f32_16x16x32_bf16 v[40:43], a[160:163], v[208:211], v[40:43]
    v_exp_f32 v246, v190
    v_mfma_f32_16x16x32_bf16 v[40:43], a[164:167], v[212:215], v[40:43]
    ds_read_b128 a[192:195], v6 offset:4224
    v_or3_b32 v11, v11, v221, v222
    v_mfma_f32_16x16x32_bf16 v[44:47], a[168:171], v[208:211], v[44:47]
    ds_read_b128 a[196:199], v6 offset:4480
    ds_read_b128 a[200:203], v6 offset:4736
    ds_read_b128 a[204:207], v6 offset:4992
    v_exp_f32 v247, v191
    v_mfma_f32_16x16x32_bf16 v[44:47], a[172:175], v[212:215], v[44:47]
    ds_read_b128 a[208:211], v6 offset:8448
    v_cvt_pk_bf16_f32 v223, v246, v247
    v_mfma_f32_16x16x32_bf16 a[240:243], a[252:255], v[208:211], a[240:243]
    v_bitop3_b32 v11, v11, v223, s47 bitop3:0xa8
    v_cmp_ne_u32 vcc, 0, v11
    v_mfma_f32_16x16x32_bf16 a[240:243], a[252:255], v[212:215], a[240:243]
    ds_read_b128 a[212:215], v6 offset:8704
    ds_read_b128 a[216:219], v6 offset:8960
    s_waitcnt lgkmcnt(7)
    v_mfma_f32_16x16x32_bf16 v[160:163], a[176:179], v[112:115], v[232:235]
    ds_read_b128 a[220:223], v6 offset:9216
    v_exp_f32 v244, v192
    v_mfma_f32_16x16x32_bf16 v[160:163], a[180:183], v[116:119], v[160:163]
    ds_read_b128 a[224:227], v6 offset:12672
    s_cbranch_vccnz L_st10_1
L_bk10_1:
    v_mfma_f32_16x16x32_bf16 v[160:163], a[184:187], v[120:123], v[160:163]
    v_exp_f32 v245, v193
    v_mfma_f32_16x16x32_bf16 v[160:163], a[188:191], v[124:127], v[160:163]
    ds_read_b128 a[228:231], v6 offset:12928
    v_cvt_pk_bf16_f32 v224, v244, v245
    s_waitcnt lgkmcnt(6)
    v_mfma_f32_16x16x32_bf16 v[164:167], a[192:195], v[112:115], v[232:235]
    ds_read_b128 a[232:235], v6 offset:13184
    ds_read_b128 a[236:239], v6 offset:13440
    v_exp_f32 v246, v194
    v_mfma_f32_16x16x32_bf16 v[164:167], a[196:199], v[116:119], v[164:167]
    v_mfma_f32_16x16x32_bf16 v[164:167], a[200:203], v[120:123], v[164:167]
    v_exp_f32 v247, v195
    v_mfma_f32_16x16x32_bf16 v[164:167], a[204:207], v[124:127], v[164:167]
    v_cvt_pk_bf16_f32 v225, v246, v247
    s_waitcnt lgkmcnt(4)
    v_mfma_f32_16x16x32_bf16 v[168:171], a[208:211], v[112:115], v[232:235]
    v_exp_f32 v244, v196
    s_add_u32 m0, s52, 33824
    v_mfma_f32_16x16x32_bf16 v[168:171], a[212:215], v[116:119], v[168:171]
    s_waitcnt vmcnt(4)
    buffer_load_dwordx4 v2, s[24:27], s49 offen offset:1024 nt lds
    v_mfma_f32_16x16x32_bf16 v[168:171], a[216:219], v[120:123], v[168:171]
    v_exp_f32 v245, v197
    v_mfma_f32_16x16x32_bf16 v[168:171], a[220:223], v[124:127], v[168:171]
    v_cvt_pk_bf16_f32 v226, v244, v245
    s_waitcnt lgkmcnt(0)
    v_mfma_f32_16x16x32_bf16 v[172:175], a[224:227], v[112:115], v[232:235]
    v_exp_f32 v246, v198
    v_mfma_f32_16x16x32_bf16 v[172:175], a[228:231], v[116:119], v[172:175]
    v_or3_b32 v11, v224, v225, v226
    v_readfirstlane_b32 s92, v252
    v_readfirstlane_b32 s93, v253
    v_mfma_f32_16x16x32_bf16 v[172:175], a[232:235], v[120:123], v[172:175]
    v_exp_f32 v247, v199
    v_mfma_f32_16x16x32_bf16 v[172:175], a[236:239], v[124:127], v[172:175]
    v_cvt_pk_bf16_f32 v227, v246, v247
    s_cmp_eq_u32 s92, 0
    s_cbranch_scc1 L_ncslow
L_ncok:
    v_mfma_f32_16x16x32_bf16 v[48:51], a[80:83], v[216:219], v[48:51]
    v_exp_f32 v244, v200
    v_mfma_f32_16x16x32_bf16 v[48:51], a[84:87], v[220:223], v[48:51]
    v_mfma_f32_16x16x32_bf16 v[52:55], a[88:91], v[216:219], v[52:55]
    v_exp_f32 v245, v201
    s_add_u32 m0, s52, 33856
    v_mfma_f32_16x16x32_bf16 v[52:55], a[92:95], v[220:223], v[52:55]
    s_waitcnt vmcnt(4)
    buffer_load_dwordx4 v2, s[24:27], s49 offen offset:2048 nt lds
    v_cvt_pk_bf16_f32 v228, v244, v245
    v_mfma_f32_16x16x32_bf16 v[56:59], a[96:99], v[216:219], v[56:59]
    v_exp_f32 v246, v202
    v_mfma_f32_16x16x32_bf16 v[56:59], a[100:103], v[220:223], v[56:59]
    v_or3_b32 v11, v11, v227, v228
    v_mfma_f32_16x16x32_bf16 v[60:63], a[104:107], v[216:219], v[60:63]
    v_exp_f32 v247, v203
    v_mfma_f32_16x16x32_bf16 v[60:63], a[108:111], v[220:223], v[60:63]
    v_cvt_pk_bf16_f32 v229, v246, v247
    v_mfma_f32_16x16x32_bf16 v[64:67], a[144:147], v[216:219], v[64:67]
    v_exp_f32 v244, v204
    v_mfma_f32_16x16x32_bf16 v[64:67], a[148:151], v[220:223], v[64:67]
    v_mfma_f32_16x16x32_bf16 v[68:71], a[152:155], v[216:219], v[68:71]
    v_exp_f32 v245, v205
    v_mfma_f32_16x16x32_bf16 v[68:71], a[156:159], v[220:223], v[68:71]
    v_cvt_pk_bf16_f32 v230, v244, v245
    v_mfma_f32_16x16x32_bf16 v[72:75], a[160:163], v[216:219], v[72:75]
    v_exp_f32 v246, v206
    s_add_u32 m0, s52, 33888
    v_mfma_f32_16x16x32_bf16 v[72:75], a[164:167], v[220:223], v[72:75]
    s_waitcnt vmcnt(4)
    buffer_load_dwordx4 v2, s[24:27], s49 offen offset:3072 nt lds
    v_or3_b32 v11, v11, v229, v230
    v_mfma_f32_16x16x32_bf16 v[76:79], a[168:171], v[216:219], v[76:79]
    v_exp_f32 v247, v207
    v_mfma_f32_16x16x32_bf16 v[76:79], a[172:175], v[220:223], v[76:79]
    v_cvt_pk_bf16_f32 v231, v246, v247
    v_mfma_f32_16x16x32_bf16 a[244:247], a[252:255], v[216:219], a[244:247]
    v_bitop3_b32 v11, v11, v231, s47 bitop3:0xa8
    v_cmp_ne_u32 vcc, 0, v11
    v_mfma_f32_16x16x32_bf16 a[244:247], a[252:255], v[220:223], a[244:247]
    v_mfma_f32_16x16x32_bf16 v[176:179], a[176:179], v[128:131], v[236:239]
    v_exp_f32 v244, v160
    v_mfma_f32_16x16x32_bf16 v[176:179], a[180:183], v[132:135], v[176:179]
    s_cbranch_vccnz L_st10_2
L_bk10_2:
    v_mfma_f32_16x16x32_bf16 v[176:179], a[184:187], v[136:139], v[176:179]
    v_exp_f32 v245, v161
    s_barrier
    v_mfma_f32_16x16x32_bf16 v[176:179], a[188:191], v[140:143], v[176:179]
    ds_read_b64_tr_b16 a[112:113], v8 offset:0
    v_cvt_pk_bf16_f32 v208, v244, v245
    v_mfma_f32_16x16x32_bf16 v[180:183], a[192:195], v[128:131], v[236:239]
    v_exp_f32 v246, v162
    v_mfma_f32_16x16x32_bf16 v[180:183], a[196:199], v[132:135], v[180:183]
    ds_read_b64_tr_b16 a[114:115], v8 offset:4224
    ds_read_b64_tr_b16 a[116:117], v8 offset:8448
    v_mfma_f32_16x16x32_bf16 v[180:183], a[200:203], v[136:139], v[180:183]
    v_exp_f32 v247, v163
    v_mfma_f32_16x16x32_bf16 v[180:183], a[204:207], v[140:143], v[180:183]
    ds_read_b64_tr_b16 a[118:119], v8 offset:12672
    v_cvt_pk_bf16_f32 v209, v246, v247
    v_mfma_f32_16x16x32_bf16 v[184:187], a[208:211], v[128:131], v[236:239]
    v_exp_f32 v244, v164
    v_mfma_f32_16x16x32_bf16 v[184:187], a[212:215], v[132:135], v[184:187]
    ds_read_b64_tr_b16 a[120:121], v8 offset:32
    ds_read_b64_tr_b16 a[122:123], v8 offset:4256
    v_mfma_f32_16x16x32_bf16 v[184:187], a[216:219], v[136:139], v[184:187]
    v_exp_f32 v245, v165
    s_add_u32 m0, s52, 50688
    s_mov_b32 s49, 212992
    v_mfma_f32_16x16x32_bf16 v[184:187], a[220:223], v[140:143], v[184:187]
    s_waitcnt vmcnt(4)
    buffer_load_dwordx4 v2, s[28:31], s49 offen offset:0 nt lds
    v_cvt_pk_bf16_f32 v210, v244, v245
    v_mfma_f32_16x16x32_bf16 v[188:191], a[224:227], v[128:131], v[236:239]
    v_exp_f32 v246, v166
    v_mfma_f32_16x16x32_bf16 v[188:191], a[228:231], v[132:135], v[188:191]
    ds_read_b64_tr_b16 a[124:125], v8 offset:8480
    v_or3_b32 v11, v208, v209, v210
    v_mfma_f32_16x16x32_bf16 v[188:191], a[232:235], v[136:139], v[188:191]
    v_exp_f32 v247, v167
    v_mfma_f32_16x16x32_bf16 v[188:191], a[236:239], v[140:143], v[188:191]
    ds_read_b64_tr_b16 a[126:127], v8 offset:12704
    v_cvt_pk_bf16_f32 v211, v246, v247
    v_mfma_f32_16x16x32_bf16 v[80:83], a[80:83], v[224:227], v[80:83]
    v_exp_f32 v244, v168
    v_mfma_f32_16x16x32_bf16 v[80:83], a[84:87], v[228:231], v[80:83]
    ds_read_b64_tr_b16 a[128:129], v8 offset:256
    ds_read_b64_tr_b16 a[130:131], v8 offset:4480
    v_mfma_f32_16x16x32_bf16 v[84:87], a[88:91], v[224:227], v[84:87]
    v_exp_f32 v245, v169
    v_mfma_f32_16x16x32_bf16 v[84:87], a[92:95], v[228:231], v[84:87]
    ds_read_b64_tr_b16 a[132:133], v8 offset:8704
    v_cvt_pk_bf16_f32 v212, v244, v245
    v_mfma_f32_16x16x32_bf16 v[88:91], a[96:99], v[224:227], v[88:91]
    v_exp_f32 v246, v170
    v_mfma_f32_16x16x32_bf16 v[88:91], a[100:103], v[228:231], v[88:91]
    ds_read_b64_tr_b16 a[134:135], v8 offset:12928
    v_or3_b32 v11, v11, v211, v212
    v_mfma_f32_16x16x32_bf16 v[92:95], a[104:107], v[224:227], v[92:95]
    v_exp_f32 v247, v171
    s_add_u32 m0, s52, 50720
    v_mfma_f32_16x16x32_bf16 v[92:95], a[108:111], v[228:231], v[92:95]
    s_waitcnt vmcnt(4)
    buffer_load_dwordx4 v2, s[28:31], s49 offen offset:1024 nt lds
    v_cvt_pk_bf16_f32 v213, v246, v247
    v_mfma_f32_16x16x32_bf16 v[96:99], a[144:147], v[224:227], v[96:99]
    v_exp_f32 v244, v172
    v_mfma_f32_16x16x32_bf16 v[96:99], a[148:151], v[228:231], v[96:99]
    ds_read_b64_tr_b16 a[136:137], v8 offset:288
    ds_read_b64_tr_b16 a[138:139], v8 offset:4512
    v_mfma_f32_16x16x32_bf16 v[100:103], a[152:155], v[224:227], v[100:103]
    v_exp_f32 v245, v173
    v_mfma_f32_16x16x32_bf16 v[100:103], a[156:159], v[228:231], v[100:103]
    ds_read_b64_tr_b16 a[140:141], v8 offset:8736
    v_cvt_pk_bf16_f32 v214, v244, v245
    v_mfma_f32_16x16x32_bf16 v[104:107], a[160:163], v[224:227], v[104:107]
    v_exp_f32 v246, v174
    v_mfma_f32_16x16x32_bf16 v[104:107], a[164:167], v[228:231], v[104:107]
    ds_read_b64_tr_b16 a[142:143], v8 offset:12960
    v_or3_b32 v11, v11, v213, v214
    v_mfma_f32_16x16x32_bf16 v[108:111], a[168:171], v[224:227], v[108:111]
    v_exp_f32 v247, v175
    v_mfma_f32_16x16x32_bf16 v[108:111], a[172:175], v[228:231], v[108:111]
    ds_read_b64_tr_b16 a[144:145], v8 offset:512
    v_cvt_pk_bf16_f32 v215, v246, v247
    v_mfma_f32_16x16x32_bf16 a[248:251], a[252:255], v[224:227], a[248:251]
    v_bitop3_b32 v11, v11, v215, s47 bitop3:0xa8
    v_cmp_ne_u32 vcc, 0, v11
    v_mfma_f32_16x16x32_bf16 a[248:251], a[252:255], v[228:231], a[248:251]
    ds_read_b64_tr_b16 a[146:147], v8 offset:4736
    ds_read_b64_tr_b16 a[148:149], v8 offset:8960
    v_mfma_f32_16x16x32_bf16 v[192:195], a[176:179], v[144:147], v[240:243]
    v_exp_f32 v244, v176
    v_mfma_f32_16x16x32_bf16 v[192:195], a[180:183], v[148:151], v[192:195]
    ds_read_b64_tr_b16 a[150:151], v8 offset:13184
    s_cbranch_vccnz L_st11_0
L_bk11_0:
    v_mfma_f32_16x16x32_bf16 v[192:195], a[184:187], v[152:155], v[192:195]
    v_exp_f32 v245, v177
    s_add_u32 m0, s52, 50752
    v_mfma_f32_16x16x32_bf16 v[192:195], a[188:191], v[156:159], v[192:195]
    s_waitcnt vmcnt(4)
    buffer_load_dwordx4 v2, s[28:31], s49 offen offset:2048 nt lds
    v_cvt_pk_bf16_f32 v216, v244, v245
    v_mfma_f32_16x16x32_bf16 v[196:199], a[192:195], v[144:147], v[240:243]
    v_exp_f32 v246, v178
    v_mfma_f32_16x16x32_bf16 v[196:199], a[196:199], v[148:151], v[196:199]
    ds_read_b64_tr_b16 a[152:153], v8 offset:544
    ds_read_b64_tr_b16 a[154:155], v8 offset:4768
    v_mfma_f32_16x16x32_bf16 v[196:199], a[200:203], v[152:155], v[196:199]
    v_exp_f32 v247, v179
    v_mfma_f32_16x16x32_bf16 v[196:199], a[204:207], v[156:159], v[196:199]
    ds_read_b64_tr_b16 a[156:157], v8 offset:8992
    v_cvt_pk_bf16_f32 v217, v246, v247
    v_mfma_f32_16x16x32_bf16 v[200:203], a[208:211], v[144:147], v[240:243]
    v_exp_f32 v244, v180
    v_mfma_f32_16x16x32_bf16 v[200:203], a[212:215], v[148:151], v[200:203]
    ds_read_b64_tr_b16 a[158:159], v8 offset:13216
    ds_read_b64_tr_b16 a[160:161], v8 offset:768
    v_mfma_f32_16x16x32_bf16 v[200:203], a[216:219], v[152:155], v[200:203]
    v_exp_f32 v245, v181
    v_mfma_f32_16x16x32_bf16 v[200:203], a[220:223], v[156:159], v[200:203]
    ds_read_b64_tr_b16 a[162:163], v8 offset:4992
    v_cvt_pk_bf16_f32 v218, v244, v245
    v_mfma_f32_16x16x32_bf16 v[204:207], a[224:227], v[144:147], v[240:243]
    v_exp_f32 v246, v182
    v_mfma_f32_16x16x32_bf16 v[204:207], a[228:231], v[148:151], v[204:207]
    ds_read_b64_tr_b16 a[164:165], v8 offset:9216
    v_or3_b32 v11, v216, v217, v218
    v_mfma_f32_16x16x32_bf16 v[204:207], a[232:235], v[152:155], v[204:207]
    v_exp_f32 v247, v183
    s_add_u32 m0, s52, 50784
    v_mfma_f32_16x16x32_bf16 v[204:207], a[236:239], v[156:159], v[204:207]
    s_waitcnt vmcnt(4)
    buffer_load_dwordx4 v2, s[28:31], s49 offen offset:3072 nt lds
    v_cvt_pk_bf16_f32 v219, v246, v247
    s_waitcnt lgkmcnt(11)
    v_mfma_f32_16x16x32_bf16 v[16:19], a[112:115], v[208:211], v[16:19]
    v_exp_f32 v244, v184
    v_mfma_f32_16x16x32_bf16 v[16:19], a[116:119], v[212:215], v[16:19]
    ds_read_b64_tr_b16 a[166:167], v8 offset:13440
    ds_read_b64_tr_b16 a[168:169], v8 offset:800
    v_mfma_f32_16x16x32_bf16 v[20:23], a[120:123], v[208:211], v[20:23]
    v_exp_f32 v245, v185
    v_mfma_f32_16x16x32_bf16 v[20:23], a[124:127], v[212:215], v[20:23]
    ds_read_b64_tr_b16 a[170:171], v8 offset:5024
    v_cvt_pk_bf16_f32 v220, v244, v245
    v_mfma_f32_16x16x32_bf16 v[24:27], a[128:131], v[208:211], v[24:27]
    ds_read_b64_tr_b16 a[172:173], v8 offset:9248
    ds_read_b64_tr_b16 a[174:175], v8 offset:13472
    v_exp_f32 v246, v186
    v_mfma_f32_16x16x32_bf16 v[24:27], a[132:135], v[212:215], v[24:27]
    ds_read_b128 a[176:179], v5 offset:0
    v_or3_b32 v11, v11, v219, v220
    v_mfma_f32_16x16x32_bf16 v[28:31], a[136:139], v[208:211], v[28:31]
    v_exp_f32 v247, v187
    v_mfma_f32_16x16x32_bf16 v[28:31], a[140:143], v[212:215], v[28:31]
    ds_read_b128 a[180:183], v5 offset:256
    v_cvt_pk_bf16_f32 v221, v246, v247
    s_waitcnt lgkmcnt(10)
    v_mfma_f32_16x16x32_bf16 v[32:35], a[144:147], v[208:211], v[32:35]
    v_exp_f32 v244, v188
    v_mfma_f32_16x16x32_bf16 v[32:35], a[148:151], v[212:215], v[32:35]
    ds_read_b128 a[184:187], v5 offset:512
    ds_read_b128 a[188:191], v5 offset:768
    v_mfma_f32_16x16x32_bf16 v[36:39], a[152:155], v[208:211], v[36:39]
    v_exp_f32 v245, v189
    s_add_u32 m0, s52, 67584
    s_mov_b32 s49, 229376
    v_mfma_f32_16x16x32_bf16 v[36:39], a[156:159], v[212:215], v[36:39]
    s_waitcnt vmcnt(4)
    buffer_load_dwordx4 v2, s[24:27], s49 offen offset:0 nt lds
    v_cvt_pk_bf16_f32 v222, v244, v245
    s_waitcnt lgkmcnt(4)
    v_mfma_f32_16x16x32_bf16 v[40:43], a[160:163], v[208:211], v[40:43]
    v_exp_f32 v246, v190
    v_mfma_f32_16x16x32_bf16 v[40:43], a[164:167], v[212:215], v[40:43]
    ds_read_b128 a[192:195], v5 offset:4224
    v_or3_b32 v11, v11, v221, v222
    v_mfma_f32_16x16x32_bf16 v[44:47], a[168:171], v[208:211], v[44:47]
    ds_read_b128 a[196:199], v5 offset:4480
    ds_read_b128 a[200:203], v5 offset:4736
    ds_read_b128 a[204:207], v5 offset:4992
    v_exp_f32 v247, v191
    v_mfma_f32_16x16x32_bf16 v[44:47], a[172:175], v[212:215], v[44:47]
    ds_read_b128 a[208:211], v5 offset:8448
    v_cvt_pk_bf16_f32 v223, v246, v247
    v_mfma_f32_16x16x32_bf16 a[240:243], a[252:255], v[208:211], a[240:243]
    v_bitop3_b32 v11, v11, v223, s47 bitop3:0xa8
    v_cmp_ne_u32 vcc, 0, v11
    v_mfma_f32_16x16x32_bf16 a[240:243], a[252:255], v[212:215], a[240:243]
    ds_read_b128 a[212:215], v5 offset:8704
    ds_read_b128 a[216:219], v5 offset:8960
    s_waitcnt lgkmcnt(7)
    v_mfma_f32_16x16x32_bf16 v[160:163], a[176:179], v[112:115], v[232:235]
    ds_read_b128 a[220:223], v5 offset:9216
    v_exp_f32 v244, v192
    v_mfma_f32_16x16x32_bf16 v[160:163], a[180:183], v[116:119], v[160:163]
    ds_read_b128 a[224:227], v5 offset:12672
    s_cbranch_vccnz L_st11_1
L_bk11_1:
    v_mfma_f32_16x16x32_bf16 v[160:163], a[184:187], v[120:123], v[160:163]
    v_exp_f32 v245, v193
    v_mfma_f32_16x16x32_bf16 v[160:163], a[188:191], v[124:127], v[160:163]
    ds_read_b128 a[228:231], v5 offset:12928
    v_cvt_pk_bf16_f32 v224, v244, v245
    s_waitcnt lgkmcnt(6)
    v_mfma_f32_16x16x32_bf16 v[164:167], a[192:195], v[112:115], v[232:235]
    ds_read_b128 a[232:235], v5 offset:13184
    ds_read_b128 a[236:239], v5 offset:13440
    v_exp_f32 v246, v194
    v_mfma_f32_16x16x32_bf16 v[164:167], a[196:199], v[116:119], v[164:167]
    v_mfma_f32_16x16x32_bf16 v[164:167], a[200:203], v[120:123], v[164:167]
    v_exp_f32 v247, v195
    v_mfma_f32_16x16x32_bf16 v[164:167], a[204:207], v[124:127], v[164:167]
    v_cvt_pk_bf16_f32 v225, v246, v247
    s_waitcnt lgkmcnt(4)
    v_mfma_f32_16x16x32_bf16 v[168:171], a[208:211], v[112:115], v[232:235]
    v_exp_f32 v244, v196
    s_add_u32 m0, s52, 67616
    v_mfma_f32_16x16x32_bf16 v[168:171], a[212:215], v[116:119], v[168:171]
    s_waitcnt vmcnt(4)
    buffer_load_dwordx4 v2, s[24:27], s49 offen offset:1024 nt lds
    v_mfma_f32_16x16x32_bf16 v[168:171], a[216:219], v[120:123], v[168:171]
    v_exp_f32 v245, v197
    v_mfma_f32_16x16x32_bf16 v[168:171], a[220:223], v[124:127], v[168:171]
    v_cvt_pk_bf16_f32 v226, v244, v245
    s_waitcnt lgkmcnt(0)
    v_mfma_f32_16x16x32_bf16 v[172:175], a[224:227], v[112:115], v[232:235]
    v_exp_f32 v246, v198
    v_mfma_f32_16x16x32_bf16 v[172:175], a[228:231], v[116:119], v[172:175]
    v_or3_b32 v11, v224, v225, v226
    v_mfma_f32_16x16x32_bf16 v[172:175], a[232:235], v[120:123], v[172:175]
    v_exp_f32 v247, v199
    v_mfma_f32_16x16x32_bf16 v[172:175], a[236:239], v[124:127], v[172:175]
    v_cvt_pk_bf16_f32 v227, v246, v247
    v_mfma_f32_16x16x32_bf16 v[48:51], a[112:115], v[216:219], v[48:51]
    v_exp_f32 v244, v200
    v_mfma_f32_16x16x32_bf16 v[48:51], a[116:119], v[220:223], v[48:51]
    v_mfma_f32_16x16x32_bf16 v[52:55], a[120:123], v[216:219], v[52:55]
    v_exp_f32 v245, v201
    s_add_u32 m0, s52, 67648
    v_mfma_f32_16x16x32_bf16 v[52:55], a[124:127], v[220:223], v[52:55]
    s_waitcnt vmcnt(4)
    buffer_load_dwordx4 v2, s[24:27], s49 offen offset:2048 nt lds
    v_cvt_pk_bf16_f32 v228, v244, v245
    v_mfma_f32_16x16x32_bf16 v[56:59], a[128:131], v[216:219], v[56:59]
    v_exp_f32 v246, v202
    v_mfma_f32_16x16x32_bf16 v[56:59], a[132:135], v[220:223], v[56:59]
    v_or3_b32 v11, v11, v227, v228
    v_mfma_f32_16x16x32_bf16 v[60:63], a[136:139], v[216:219], v[60:63]
    v_exp_f32 v247, v203
    v_mfma_f32_16x16x32_bf16 v[60:63], a[140:143], v[220:223], v[60:63]
    v_cvt_pk_bf16_f32 v229, v246, v247
    v_mfma_f32_16x16x32_bf16 v[64:67], a[144:147], v[216:219], v[64:67]
    v_exp_f32 v244, v204
    v_mfma_f32_16x16x32_bf16 v[64:67], a[148:151], v[220:223], v[64:67]
    v_mfma_f32_16x16x32_bf16 v[68:71], a[152:155], v[216:219], v[68:71]
    v_exp_f32 v245, v205
    v_mfma_f32_16x16x32_bf16 v[68:71], a[156:159], v[220:223], v[68:71]
    v_cvt_pk_bf16_f32 v230, v244, v245
    v_mfma_f32_16x16x32_bf16 v[72:75], a[160:163], v[216:219], v[72:75]
    v_exp_f32 v246, v206
    s_add_u32 m0, s52, 67680
    v_mfma_f32_16x16x32_bf16 v[72:75], a[164:167], v[220:223], v[72:75]
    s_waitcnt vmcnt(4)
    buffer_load_dwordx4 v2, s[24:27], s49 offen offset:3072 nt lds
    v_or3_b32 v11, v11, v229, v230
    v_mfma_f32_16x16x32_bf16 v[76:79], a[168:171], v[216:219], v[76:79]
    v_exp_f32 v247, v207
    v_mfma_f32_16x16x32_bf16 v[76:79], a[172:175], v[220:223], v[76:79]
    v_cvt_pk_bf16_f32 v231, v246, v247
    v_mfma_f32_16x16x32_bf16 a[244:247], a[252:255], v[216:219], a[244:247]
    v_bitop3_b32 v11, v11, v231, s47 bitop3:0xa8
    v_cmp_ne_u32 vcc, 0, v11
    v_mfma_f32_16x16x32_bf16 a[244:247], a[252:255], v[220:223], a[244:247]
    v_mfma_f32_16x16x32_bf16 v[176:179], a[176:179], v[128:131], v[236:239]
    v_exp_f32 v244, v160
    v_mfma_f32_16x16x32_bf16 v[176:179], a[180:183], v[132:135], v[176:179]
    s_cbranch_vccnz L_st11_2
L_bk11_2:
    v_mfma_f32_16x16x32_bf16 v[176:179], a[184:187], v[136:139], v[176:179]
    v_exp_f32 v245, v161
    s_barrier
    v_mfma_f32_16x16x32_bf16 v[176:179], a[188:191], v[140:143], v[176:179]
    ds_read_b64_tr_b16 a[80:81], v7 offset:0
    v_cvt_pk_bf16_f32 v208, v244, v245
    v_mfma_f32_16x16x32_bf16 v[180:183], a[192:195], v[128:131], v[236:239]
    v_exp_f32 v246, v162
    v_mfma_f32_16x16x32_bf16 v[180:183], a[196:199], v[132:135], v[180:183]
    ds_read_b64_tr_b16 a[82:83], v7 offset:4224
    ds_read_b64_tr_b16 a[84:85], v7 offset:8448
    v_mfma_f32_16x16x32_bf16 v[180:183], a[200:203], v[136:139], v[180:183]
    v_exp_f32 v247, v163
    v_mfma_f32_16x16x32_bf16 v[180:183], a[204:207], v[140:143], v[180:183]
    ds_read_b64_tr_b16 a[86:87], v7 offset:12672
    v_cvt_pk_bf16_f32 v209, v246, v247
    v_mfma_f32_16x16x32_bf16 v[184:187], a[208:211], v[128:131], v[236:239]
    v_exp_f32 v244, v164
    v_mfma_f32_16x16x32_bf16 v[184:187], a[212:215], v[132:135], v[184:187]
    ds_read_b64_tr_b16 a[88:89], v7 offset:32
    ds_read_b64_tr_b16 a[90:91], v7 offset:4256
    v_mfma_f32_16x16x32_bf16 v[184:187], a[216:219], v[136:139], v[184:187]
    v_exp_f32 v245, v165
    s_add_u32 m0, s52, 84480
    s_mov_b32 s49, 229376
    v_mfma_f32_16x16x32_bf16 v[184:187], a[220:223], v[140:143], v[184:187]
    s_waitcnt vmcnt(3)
    buffer_load_dwordx4 v2, s[28:31], s49 offen offset:0 nt lds
    v_cvt_pk_bf16_f32 v210, v244, v245
    v_mfma_f32_16x16x32_bf16 v[188:191], a[224:227], v[128:131], v[236:239]
    v_exp_f32 v246, v166
    v_mfma_f32_16x16x32_bf16 v[188:191], a[228:231], v[132:135], v[188:191]
    ds_read_b64_tr_b16 a[92:93], v7 offset:8480
    v_or3_b32 v11, v208, v209, v210
    v_mfma_f32_16x16x32_bf16 v[188:191], a[232:235], v[136:139], v[188:191]
    v_exp_f32 v247, v167
    v_mfma_f32_16x16x32_bf16 v[188:191], a[236:239], v[140:143], v[188:191]
    ds_read_b64_tr_b16 a[94:95], v7 offset:12704
    v_cvt_pk_bf16_f32 v211, v246, v247
    v_mfma_f32_16x16x32_bf16 v[80:83], a[112:115], v[224:227], v[80:83]
    v_exp_f32 v244, v168
    v_mfma_f32_16x16x32_bf16 v[80:83], a[116:119], v[228:231], v[80:83]
    ds_read_b64_tr_b16 a[96:97], v7 offset:256
    ds_read_b64_tr_b16 a[98:99], v7 offset:4480
    v_mfma_f32_16x16x32_bf16 v[84:87], a[120:123], v[224:227], v[84:87]
    v_exp_f32 v245, v169
    v_mfma_f32_16x16x32_bf16 v[84:87], a[124:127], v[228:231], v[84:87]
    ds_read_b64_tr_b16 a[100:101], v7 offset:8704
    v_cvt_pk_bf16_f32 v212, v244, v245
    v_mfma_f32_16x16x32_bf16 v[88:91], a[128:131], v[224:227], v[88:91]
    v_exp_f32 v246, v170
    v_mfma_f32_16x16x32_bf16 v[88:91], a[132:135], v[228:231], v[88:91]
    ds_read_b64_tr_b16 a[102:103], v7 offset:12928
    v_or3_b32 v11, v11, v211, v212
    v_mfma_f32_16x16x32_bf16 v[92:95], a[136:139], v[224:227], v[92:95]
    v_exp_f32 v247, v171
    s_add_u32 m0, s52, 84512
    v_mfma_f32_16x16x32_bf16 v[92:95], a[140:143], v[228:231], v[92:95]
    s_waitcnt vmcnt(3)
    buffer_load_dwordx4 v2, s[28:31], s49 offen offset:1024 nt lds
    v_cvt_pk_bf16_f32 v213, v246, v247
    v_mfma_f32_16x16x32_bf16 v[96:99], a[144:147], v[224:227], v[96:99]
    v_exp_f32 v244, v172
    v_mfma_f32_16x16x32_bf16 v[96:99], a[148:151], v[228:231], v[96:99]
    ds_read_b64_tr_b16 a[104:105], v7 offset:288
    ds_read_b64_tr_b16 a[106:107], v7 offset:4512
    v_mfma_f32_16x16x32_bf16 v[100:103], a[152:155], v[224:227], v[100:103]
    v_exp_f32 v245, v173
    v_mfma_f32_16x16x32_bf16 v[100:103], a[156:159], v[228:231], v[100:103]
    ds_read_b64_tr_b16 a[108:109], v7 offset:8736
    v_cvt_pk_bf16_f32 v214, v244, v245
    v_mfma_f32_16x16x32_bf16 v[104:107], a[160:163], v[224:227], v[104:107]
    v_exp_f32 v246, v174
    v_mfma_f32_16x16x32_bf16 v[104:107], a[164:167], v[228:231], v[104:107]
    ds_read_b64_tr_b16 a[110:111], v7 offset:12960
    v_or3_b32 v11, v11, v213, v214
    v_mfma_f32_16x16x32_bf16 v[108:111], a[168:171], v[224:227], v[108:111]
    v_exp_f32 v247, v175
    v_mfma_f32_16x16x32_bf16 v[108:111], a[172:175], v[228:231], v[108:111]
    ds_read_b64_tr_b16 a[144:145], v7 offset:512
    v_cvt_pk_bf16_f32 v215, v246, v247
    v_mfma_f32_16x16x32_bf16 a[248:251], a[252:255], v[224:227], a[248:251]
    v_bitop3_b32 v11, v11, v215, s47 bitop3:0xa8
    v_cmp_ne_u32 vcc, 0, v11
    v_mfma_f32_16x16x32_bf16 a[248:251], a[252:255], v[228:231], a[248:251]
    ds_read_b64_tr_b16 a[146:147], v7 offset:4736
    ds_read_b64_tr_b16 a[148:149], v7 offset:8960
    v_mfma_f32_16x16x32_bf16 v[192:195], a[176:179], v[144:147], v[240:243]
    v_exp_f32 v244, v176
    v_mfma_f32_16x16x32_bf16 v[192:195], a[180:183], v[148:151], v[192:195]
    ds_read_b64_tr_b16 a[150:151], v7 offset:13184
    s_cbranch_vccnz L_st12_0
L_bk12_0:
    v_mfma_f32_16x16x32_bf16 v[192:195], a[184:187], v[152:155], v[192:195]
    v_exp_f32 v245, v177
    s_add_u32 m0, s52, 84544
    v_mfma_f32_16x16x32_bf16 v[192:195], a[188:191], v[156:159], v[192:195]
    s_waitcnt vmcnt(3)
    buffer_load_dwordx4 v2, s[28:31], s49 offen offset:2048 nt lds
    v_cvt_pk_bf16_f32 v216, v244, v245
    v_mfma_f32_16x16x32_bf16 v[196:199], a[192:195], v[144:147], v[240:243]
    v_exp_f32 v246, v178
    v_mfma_f32_16x16x32_bf16 v[196:199], a[196:199], v[148:151], v[196:199]
    ds_read_b64_tr_b16 a[152:153], v7 offset:544
    ds_read_b64_tr_b16 a[154:155], v7 offset:4768
    v_mfma_f32_16x16x32_bf16 v[196:199], a[200:203], v[152:155], v[196:199]
    v_exp_f32 v247, v179
    v_mfma_f32_16x16x32_bf16 v[196:199], a[204:207], v[156:159], v[196:199]
    ds_read_b64_tr_b16 a[156:157], v7 offset:8992
    v_cvt_pk_bf16_f32 v217, v246, v247
    v_mfma_f32_16x16x32_bf16 v[200:203], a[208:211], v[144:147], v[240:243]
    v_exp_f32 v244, v180
    v_mfma_f32_16x16x32_bf16 v[200:203], a[212:215], v[148:151], v[200:203]
    ds_read_b64_tr_b16 a[158:159], v7 offset:13216
    ds_read_b64_tr_b16 a[160:161], v7 offset:768
    v_mfma_f32_16x16x32_bf16 v[200:203], a[216:219], v[152:155], v[200:203]
    v_exp_f32 v245, v181
    v_mfma_f32_16x16x32_bf16 v[200:203], a[220:223], v[156:159], v[200:203]
    ds_read_b64_tr_b16 a[162:163], v7 offset:4992
    v_cvt_pk_bf16_f32 v218, v244, v245
    v_mfma_f32_16x16x32_bf16 v[204:207], a[224:227], v[144:147], v[240:243]
    v_exp_f32 v246, v182
    v_mfma_f32_16x16x32_bf16 v[204:207], a[228:231], v[148:151], v[204:207]
    ds_read_b64_tr_b16 a[164:165], v7 offset:9216
    v_or3_b32 v11, v216, v217, v218
    v_mfma_f32_16x16x32_bf16 v[204:207], a[232:235], v[152:155], v[204:207]
    v_exp_f32 v247, v183
    s_add_u32 m0, s52, 84576
    v_mfma_f32_16x16x32_bf16 v[204:207], a[236:239], v[156:159], v[204:207]
    s_waitcnt vmcnt(3)
    buffer_load_dwordx4 v2, s[28:31], s49 offen offset:3072 nt lds
    v_cvt_pk_bf16_f32 v219, v246, v247
    s_waitcnt lgkmcnt(11)
    v_mfma_f32_16x16x32_bf16 v[16:19], a[80:83], v[208:211], v[16:19]
    v_exp_f32 v244, v184
    v_mfma_f32_16x16x32_bf16 v[16:19], a[84:87], v[212:215], v[16:19]
    ds_read_b64_tr_b16 a[166:167], v7 offset:13440
    ds_read_b64_tr_b16 a[168:169], v7 offset:800
    v_mfma_f32_16x16x32_bf16 v[20:23], a[88:91], v[208:211], v[20:23]
    v_exp_f32 v245, v185
    v_mfma_f32_16x16x32_bf16 v[20:23], a[92:95], v[212:215], v[20:23]
    ds_read_b64_tr_b16 a[170:171], v7 offset:5024
    v_cvt_pk_bf16_f32 v220, v244, v245
    v_mfma_f32_16x16x32_bf16 v[24:27], a[96:99], v[208:211], v[24:27]
    ds_read_b64_tr_b16 a[172:173], v7 offset:9248
    ds_read_b64_tr_b16 a[174:175], v7 offset:13472
    v_exp_f32 v246, v186
    v_mfma_f32_16x16x32_bf16 v[24:27], a[100:103], v[212:215], v[24:27]
    ds_read_b128 a[176:179], v5 offset:33792
    v_or3_b32 v11, v11, v219, v220
    v_mfma_f32_16x16x32_bf16 v[28:31], a[104:107], v[208:211], v[28:31]
    v_exp_f32 v247, v187
    v_mfma_f32_16x16x32_bf16 v[28:31], a[108:111], v[212:215], v[28:31]
    ds_read_b128 a[180:183], v5 offset:34048
    v_cvt_pk_bf16_f32 v221, v246, v247
    s_waitcnt lgkmcnt(10)
    v_mfma_f32_16x16x32_bf16 v[32:35], a[144:147], v[208:211], v[32:35]
    v_exp_f32 v244, v188
    v_mfma_f32_16x16x32_bf16 v[32:35], a[148:151], v[212:215], v[32:35]
    ds_read_b128 a[184:187], v5 offset:34304
    ds_read_b128 a[188:191], v5 offset:34560
    v_mfma_f32_16x16x32_bf16 v[36:39], a[152:155], v[208:211], v[36:39]
    v_exp_f32 v245, v189
    s_add_u32 m0, s52, 0
    s_mov_b32 s49, 245760
    v_mfma_f32_16x16x32_bf16 v[36:39], a[156:159], v[212:215], v[36:39]
    s_waitcnt vmcnt(3)
    buffer_load_dwordx4 v2, s[24:27], s49 offen offset:0 nt lds
    v_cvt_pk_bf16_f32 v222, v244, v245
    s_waitcnt lgkmcnt(4)
    v_mfma_f32_16x16x32_bf16 v[40:43], a[160:163], v[208:211], v[40:43]
    v_exp_f32 v246, v190
    v_mfma_f32_16x16x32_bf16 v[40:43], a[164:167], v[212:215], v[40:43]
    ds_read_b128 a[192:195], v5 offset:38016
    v_or3_b32 v11, v11, v221, v222
    v_mfma_f32_16x16x32_bf16 v[44:47], a[168:171], v[208:211], v[44:47]
    ds_read_b128 a[196:199], v5 offset:38272
    ds_read_b128 a[200:203], v5 offset:38528
    ds_read_b128 a[204:207], v5 offset:38784
    v_exp_f32 v247, v191
    v_mfma_f32_16x16x32_bf16 v[44:47], a[172:175], v[212:215], v[44:47]
    ds_read_b128 a[208:211], v5 offset:42240
    v_cvt_pk_bf16_f32 v223, v246, v247
    v_mfma_f32_16x16x32_bf16 a[240:243], a[252:255], v[208:211], a[240:243]
    v_bitop3_b32 v11, v11, v223, s47 bitop3:0xa8
    v_cmp_ne_u32 vcc, 0, v11
    v_mfma_f32_16x16x32_bf16 a[240:243], a[252:255], v[212:215], a[240:243]
    ds_read_b128 a[212:215], v5 offset:42496
    ds_read_b128 a[216:219], v5 offset:42752
    s_waitcnt lgkmcnt(7)
    v_mfma_f32_16x16x32_bf16 v[160:163], a[176:179], v[112:115], v[232:235]
    ds_read_b128 a[220:223], v5 offset:43008
    v_exp_f32 v244, v192
    v_mfma_f32_16x16x32_bf16 v[160:163], a[180:183], v[116:119], v[160:163]
    ds_read_b128 a[224:227], v5 offset:46464
    s_cbranch_vccnz L_st12_1
L_bk12_1:
    v_mfma_f32_16x16x32_bf16 v[160:163], a[184:187], v[120:123], v[160:163]
    v_exp_f32 v245, v193
    v_mfma_f32_16x16x32_bf16 v[160:163], a[188:191], v[124:127], v[160:163]
    ds_read_b128 a[228:231], v5 offset:46720
    v_cvt_pk_bf16_f32 v224, v244, v245
    s_waitcnt lgkmcnt(6)
    v_mfma_f32_16x16x32_bf16 v[164:167], a[192:195], v[112:115], v[232:235]
    ds_read_b128 a[232:235], v5 offset:46976
    ds_read_b128 a[236:239], v5 offset:47232
    v_exp_f32 v246, v194
    v_mfma_f32_16x16x32_bf16 v[164:167], a[196:199], v[116:119], v[164:167]
    v_mfma_f32_16x16x32_bf16 v[164:167], a[200:203], v[120:123], v[164:167]
    v_exp_f32 v247, v195
    v_mfma_f32_16x16x32_bf16 v[164:167], a[204:207], v[124:127], v[164:167]
    v_cvt_pk_bf16_f32 v225, v246, v247
    s_waitcnt lgkmcnt(4)
    v_mfma_f32_16x16x32_bf16 v[168:171], a[208:211], v[112:115], v[232:235]
    v_exp_f32 v244, v196
    s_add_u32 m0, s52, 32
    v_mfma_f32_16x16x32_bf16 v[168:171], a[212:215], v[116:119], v[168:171]
    s_waitcnt vmcnt(3)
    buffer_load_dwordx4 v2, s[24:27], s49 offen offset:1024 nt lds
    v_mfma_f32_16x16x32_bf16 v[168:171], a[216:219], v[120:123], v[168:171]
    v_exp_f32 v245, v197
    v_mfma_f32_16x16x32_bf16 v[168:171], a[220:223], v[124:127], v[168:171]
    v_cvt_pk_bf16_f32 v226, v244, v245
    s_waitcnt lgkmcnt(0)
    v_mfma_f32_16x16x32_bf16 v[172:175], a[224:227], v[112:115], v[232:235]
    v_exp_f32 v246, v198
    v_mfma_f32_16x16x32_bf16 v[172:175], a[228:231], v[116:119], v[172:175]
    v_or3_b32 v11, v224, v225, v226
    v_mfma_f32_16x16x32_bf16 v[172:175], a[232:235], v[120:123], v[172:175]
    v_exp_f32 v247, v199
    v_mfma_f32_16x16x32_bf16 v[172:175], a[236:239], v[124:127], v[172:175]
    v_cvt_pk_bf16_f32 v227, v246, v247
    v_mfma_f32_16x16x32_bf16 v[48:51], a[80:83], v[216:219], v[48:51]
    v_exp_f32 v244, v200
    v_mfma_f32_16x16x32_bf16 v[48:51], a[84:87], v[220:223], v[48:51]
    v_mfma_f32_16x16x32_bf16 v[52:55], a[88:91], v[216:219], v[52:55]
    v_exp_f32 v245, v201
    s_add_u32 m0, s52, 64
    v_mfma_f32_16x16x32_bf16 v[52:55], a[92:95], v[220:223], v[52:55]
    s_waitcnt vmcnt(3)
    buffer_load_dwordx4 v2, s[24:27], s49 offen offset:2048 nt lds
    v_cvt_pk_bf16_f32 v228, v244, v245
    v_mfma_f32_16x16x32_bf16 v[56:59], a[96:99], v[216:219], v[56:59]
    v_exp_f32 v246, v202
    v_mfma_f32_16x16x32_bf16 v[56:59], a[100:103], v[220:223], v[56:59]
    v_or3_b32 v11, v11, v227, v228
    v_mfma_f32_16x16x32_bf16 v[60:63], a[104:107], v[216:219], v[60:63]
    v_exp_f32 v247, v203
    v_mfma_f32_16x16x32_bf16 v[60:63], a[108:111], v[220:223], v[60:63]
    v_cvt_pk_bf16_f32 v229, v246, v247
    v_mfma_f32_16x16x32_bf16 v[64:67], a[144:147], v[216:219], v[64:67]
    v_exp_f32 v244, v204
    v_mfma_f32_16x16x32_bf16 v[64:67], a[148:151], v[220:223], v[64:67]
    v_mfma_f32_16x16x32_bf16 v[68:71], a[152:155], v[216:219], v[68:71]
    v_exp_f32 v245, v205
    v_mfma_f32_16x16x32_bf16 v[68:71], a[156:159], v[220:223], v[68:71]
    v_cvt_pk_bf16_f32 v230, v244, v245
    v_mfma_f32_16x16x32_bf16 v[72:75], a[160:163], v[216:219], v[72:75]
    v_exp_f32 v246, v206
    s_add_u32 m0, s52, 96
    v_mfma_f32_16x16x32_bf16 v[72:75], a[164:167], v[220:223], v[72:75]
    s_waitcnt vmcnt(3)
    buffer_load_dwordx4 v2, s[24:27], s49 offen offset:3072 nt lds
    v_or3_b32 v11, v11, v229, v230
    v_mfma_f32_16x16x32_bf16 v[76:79], a[168:171], v[216:219], v[76:79]
    v_exp_f32 v247, v207
    v_mfma_f32_16x16x32_bf16 v[76:79], a[172:175], v[220:223], v[76:79]
    v_cvt_pk_bf16_f32 v231, v246, v247
    v_mfma_f32_16x16x32_bf16 a[244:247], a[252:255], v[216:219], a[244:247]
    v_bitop3_b32 v11, v11, v231, s47 bitop3:0xa8
    v_cmp_ne_u32 vcc, 0, v11
    v_mfma_f32_16x16x32_bf16 a[244:247], a[252:255], v[220:223], a[244:247]
    v_mfma_f32_16x16x32_bf16 v[176:179], a[176:179], v[128:131], v[236:239]
    v_exp_f32 v244, v160
    v_mfma_f32_16x16x32_bf16 v[176:179], a[180:183], v[132:135], v[176:179]
    s_cbranch_vccnz L_st12_2
L_bk12_2:
    v_mfma_f32_16x16x32_bf16 v[176:179], a[184:187], v[136:139], v[176:179]
    v_exp_f32 v245, v161
    s_barrier
    v_mfma_f32_16x16x32_bf16 v[176:179], a[188:191], v[140:143], v[176:179]
    ds_read_b64_tr_b16 a[112:113], v7 offset:33792
    v_cvt_pk_bf16_f32 v208, v244, v245
    v_mfma_f32_16x16x32_bf16 v[180:183], a[192:195], v[128:131], v[236:239]
    v_exp_f32 v246, v162
    v_mfma_f32_16x16x32_bf16 v[180:183], a[196:199], v[132:135], v[180:183]
    ds_read_b64_tr_b16 a[114:115], v7 offset:38016
    ds_read_b64_tr_b16 a[116:117], v7 offset:42240
    v_mfma_f32_16x16x32_bf16 v[180:183], a[200:203], v[136:139], v[180:183]
    v_exp_f32 v247, v163
    v_mfma_f32_16x16x32_bf16 v[180:183], a[204:207], v[140:143], v[180:183]
    ds_read_b64_tr_b16 a[118:119], v7 offset:46464
    v_cvt_pk_bf16_f32 v209, v246, v247
    v_mfma_f32_16x16x32_bf16 v[184:187], a[208:211], v[128:131], v[236:239]
    v_exp_f32 v244, v164
    v_mfma_f32_16x16x32_bf16 v[184:187], a[212:215], v[132:135], v[184:187]
    ds_read_b64_tr_b16 a[120:121], v7 offset:33824
    ds_read_b64_tr_b16 a[122:123], v7 offset:38048
    v_mfma_f32_16x16x32_bf16 v[184:187], a[216:219], v[136:139], v[184:187]
    v_exp_f32 v245, v165
    s_add_u32 m0, s52, 16896
    s_mov_b32 s49, 245760
    v_mfma_f32_16x16x32_bf16 v[184:187], a[220:223], v[140:143], v[184:187]
    s_waitcnt vmcnt(3)
    buffer_load_dwordx4 v2, s[28:31], s49 offen offset:0 nt lds
    v_cvt_pk_bf16_f32 v210, v244, v245
    v_mfma_f32_16x16x32_bf16 v[188:191], a[224:227], v[128:131], v[236:239]
    v_exp_f32 v246, v166
    v_mfma_f32_16x16x32_bf16 v[188:191], a[228:231], v[132:135], v[188:191]
    ds_read_b64_tr_b16 a[124:125], v7 offset:42272
    v_or3_b32 v11, v208, v209, v210
    v_mfma_f32_16x16x32_bf16 v[188:191], a[232:235], v[136:139], v[188:191]
    v_exp_f32 v247, v167
    v_mfma_f32_16x16x32_bf16 v[188:191], a[236:239], v[140:143], v[188:191]
    ds_read_b64_tr_b16 a[126:127], v7 offset:46496
    v_cvt_pk_bf16_f32 v211, v246, v247
    v_mfma_f32_16x16x32_bf16 v[80:83], a[80:83], v[224:227], v[80:83]
    v_exp_f32 v244, v168
    v_mfma_f32_16x16x32_bf16 v[80:83], a[84:87], v[228:231], v[80:83]
    ds_read_b64_tr_b16 a[128:129], v7 offset:34048
    ds_read_b64_tr_b16 a[130:131], v7 offset:38272
    v_mfma_f32_16x16x32_bf16 v[84:87], a[88:91], v[224:227], v[84:87]
    v_exp_f32 v245, v169
    v_mfma_f32_16x16x32_bf16 v[84:87], a[92:95], v[228:231], v[84:87]
    ds_read_b64_tr_b16 a[132:133], v7 offset:42496
    v_cvt_pk_bf16_f32 v212, v244, v245
    v_mfma_f32_16x16x32_bf16 v[88:91], a[96:99], v[224:227], v[88:91]
    v_exp_f32 v246, v170
    v_mfma_f32_16x16x32_bf16 v[88:91], a[100:103], v[228:231], v[88:91]
    ds_read_b64_tr_b16 a[134:135], v7 offset:46720
    v_or3_b32 v11, v11, v211, v212
    v_mfma_f32_16x16x32_bf16 v[92:95], a[104:107], v[224:227], v[92:95]
    v_exp_f32 v247, v171
    s_add_u32 m0, s52, 16928
    v_mfma_f32_16x16x32_bf16 v[92:95], a[108:111], v[228:231], v[92:95]
    s_waitcnt vmcnt(3)
    buffer_load_dwordx4 v2, s[28:31], s49 offen offset:1024 nt lds
    v_cvt_pk_bf16_f32 v213, v246, v247
    v_mfma_f32_16x16x32_bf16 v[96:99], a[144:147], v[224:227], v[96:99]
    v_exp_f32 v244, v172
    v_mfma_f32_16x16x32_bf16 v[96:99], a[148:151], v[228:231], v[96:99]
    ds_read_b64_tr_b16 a[136:137], v7 offset:34080
    ds_read_b64_tr_b16 a[138:139], v7 offset:38304
    v_mfma_f32_16x16x32_bf16 v[100:103], a[152:155], v[224:227], v[100:103]
    v_exp_f32 v245, v173
    v_mfma_f32_16x16x32_bf16 v[100:103], a[156:159], v[228:231], v[100:103]
    ds_read_b64_tr_b16 a[140:141], v7 offset:42528
    v_cvt_pk_bf16_f32 v214, v244, v245
    v_mfma_f32_16x16x32_bf16 v[104:107], a[160:163], v[224:227], v[104:107]
    v_exp_f32 v246, v174
    v_mfma_f32_16x16x32_bf16 v[104:107], a[164:167], v[228:231], v[104:107]
    ds_read_b64_tr_b16 a[142:143], v7 offset:46752
    v_or3_b32 v11, v11, v213, v214
    v_mfma_f32_16x16x32_bf16 v[108:111], a[168:171], v[224:227], v[108:111]
    v_exp_f32 v247, v175
    v_mfma_f32_16x16x32_bf16 v[108:111], a[172:175], v[228:231], v[108:111]
    ds_read_b64_tr_b16 a[144:145], v7 offset:34304
    v_cvt_pk_bf16_f32 v215, v246, v247
    v_mfma_f32_16x16x32_bf16 a[248:251], a[252:255], v[224:227], a[248:251]
    v_bitop3_b32 v11, v11, v215, s47 bitop3:0xa8
    v_cmp_ne_u32 vcc, 0, v11
    v_mfma_f32_16x16x32_bf16 a[248:251], a[252:255], v[228:231], a[248:251]
    ds_read_b64_tr_b16 a[146:147], v7 offset:38528
    ds_read_b64_tr_b16 a[148:149], v7 offset:42752
    v_mfma_f32_16x16x32_bf16 v[192:195], a[176:179], v[144:147], v[240:243]
    v_exp_f32 v244, v176
    v_mfma_f32_16x16x32_bf16 v[192:195], a[180:183], v[148:151], v[192:195]
    ds_read_b64_tr_b16 a[150:151], v7 offset:46976
    s_cbranch_vccnz L_st13_0
L_bk13_0:
    v_mfma_f32_16x16x32_bf16 v[192:195], a[184:187], v[152:155], v[192:195]
    v_exp_f32 v245, v177
    s_add_u32 m0, s52, 16960
    v_mfma_f32_16x16x32_bf16 v[192:195], a[188:191], v[156:159], v[192:195]
    s_waitcnt vmcnt(3)
    buffer_load_dwordx4 v2, s[28:31], s49 offen offset:2048 nt lds
    v_cvt_pk_bf16_f32 v216, v244, v245
    v_mfma_f32_16x16x32_bf16 v[196:199], a[192:195], v[144:147], v[240:243]
    v_exp_f32 v246, v178
    v_mfma_f32_16x16x32_bf16 v[196:199], a[196:199], v[148:151], v[196:199]
    ds_read_b64_tr_b16 a[152:153], v7 offset:34336
    ds_read_b64_tr_b16 a[154:155], v7 offset:38560
    v_mfma_f32_16x16x32_bf16 v[196:199], a[200:203], v[152:155], v[196:199]
    v_exp_f32 v247, v179
    v_mfma_f32_16x16x32_bf16 v[196:199], a[204:207], v[156:159], v[196:199]
    ds_read_b64_tr_b16 a[156:157], v7 offset:42784
    v_cvt_pk_bf16_f32 v217, v246, v247
    v_mfma_f32_16x16x32_bf16 v[200:203], a[208:211], v[144:147], v[240:243]
    v_exp_f32 v244, v180
    v_mfma_f32_16x16x32_bf16 v[200:203], a[212:215], v[148:151], v[200:203]
    ds_read_b64_tr_b16 a[158:159], v7 offset:47008
    ds_read_b64_tr_b16 a[160:161], v7 offset:34560
    v_mfma_f32_16x16x32_bf16 v[200:203], a[216:219], v[152:155], v[200:203]
    v_exp_f32 v245, v181
    v_mfma_f32_16x16x32_bf16 v[200:203], a[220:223], v[156:159], v[200:203]
    ds_read_b64_tr_b16 a[162:163], v7 offset:38784
    v_cvt_pk_bf16_f32 v218, v244, v245
    v_mfma_f32_16x16x32_bf16 v[204:207], a[224:227], v[144:147], v[240:243]
    v_exp_f32 v246, v182
    v_mfma_f32_16x16x32_bf16 v[204:207], a[228:231], v[148:151], v[204:207]
    ds_read_b64_tr_b16 a[164:165], v7 offset:43008
    v_or3_b32 v11, v216, v217, v218
    v_mfma_f32_16x16x32_bf16 v[204:207], a[232:235], v[152:155], v[204:207]
    v_exp_f32 v247, v183
    s_add_u32 m0, s52, 16992
    v_mfma_f32_16x16x32_bf16 v[204:207], a[236:239], v[156:159], v[204:207]
    s_waitcnt vmcnt(3)
    buffer_load_dwordx4 v2, s[28:31], s49 offen offset:3072 nt lds
    v_cvt_pk_bf16_f32 v219, v246, v247
    s_waitcnt lgkmcnt(11)
    v_mfma_f32_16x16x32_bf16 v[16:19], a[112:115], v[208:211], v[16:19]
    v_exp_f32 v244, v184
    v_mfma_f32_16x16x32_bf16 v[16:19], a[116:119], v[212:215], v[16:19]
    ds_read_b64_tr_b16 a[166:167], v7 offset:47232
    ds_read_b64_tr_b16 a[168:169], v7 offset:34592
    v_mfma_f32_16x16x32_bf16 v[20:23], a[120:123], v[208:211], v[20:23]
    v_exp_f32 v245, v185
    v_mfma_f32_16x16x32_bf16 v[20:23], a[124:127], v[212:215], v[20:23]
    ds_read_b64_tr_b16 a[170:171], v7 offset:38816
    v_cvt_pk_bf16_f32 v220, v244, v245
    v_mfma_f32_16x16x32_bf16 v[24:27], a[128:131], v[208:211], v[24:27]
    ds_read_b64_tr_b16 a[172:173], v7 offset:43040
    ds_read_b64_tr_b16 a[174:175], v7 offset:47264
    v_exp_f32 v246, v186
    v_mfma_f32_16x16x32_bf16 v[24:27], a[132:135], v[212:215], v[24:27]
    ds_read_b128 a[176:179], v6 offset:0
    v_or3_b32 v11, v11, v219, v220
    v_mfma_f32_16x16x32_bf16 v[28:31], a[136:139], v[208:211], v[28:31]
    v_exp_f32 v247, v187
    v_mfma_f32_16x16x32_bf16 v[28:31], a[140:143], v[212:215], v[28:31]
    ds_read_b128 a[180:183], v6 offset:256
    v_cvt_pk_bf16_f32 v221, v246, v247
    s_waitcnt lgkmcnt(10)
    v_mfma_f32_16x16x32_bf16 v[32:35], a[144:147], v[208:211], v[32:35]
    v_exp_f32 v244, v188
    v_mfma_f32_16x16x32_bf16 v[32:35], a[148:151], v[212:215], v[32:35]
    ds_read_b128 a[184:187], v6 offset:512
    ds_read_b128 a[188:191], v6 offset:768
    v_mfma_f32_16x16x32_bf16 v[36:39], a[152:155], v[208:211], v[36:39]
    v_exp_f32 v245, v189
    v_mfma_f32_16x16x32_bf16 v[36:39], a[156:159], v[212:215], v[36:39]
    ds_read_b128 a[192:195], v6 offset:4224
    v_cvt_pk_bf16_f32 v222, v244, v245
    s_waitcnt lgkmcnt(5)
    v_mfma_f32_16x16x32_bf16 v[40:43], a[160:163], v[208:211], v[40:43]
    v_exp_f32 v246, v190
    v_mfma_f32_16x16x32_bf16 v[40:43], a[164:167], v[212:215], v[40:43]
    ds_read_b128 a[196:199], v6 offset:4480
    v_or3_b32 v11, v11, v221, v222
    v_mfma_f32_16x16x32_bf16 v[44:47], a[168:171], v[208:211], v[44:47]
    ds_read_b128 a[200:203], v6 offset:4736
    ds_read_b128 a[204:207], v6 offset:4992
    v_exp_f32 v247, v191
    v_mfma_f32_16x16x32_bf16 v[44:47], a[172:175], v[212:215], v[44:47]
    ds_read_b128 a[208:211], v6 offset:8448
    v_cvt_pk_bf16_f32 v223, v246, v247
    v_mfma_f32_16x16x32_bf16 a[240:243], a[252:255], v[208:211], a[240:243]
    v_bitop3_b32 v11, v11, v223, s47 bitop3:0xa8
    v_cmp_ne_u32 vcc, 0, v11
    v_mfma_f32_16x16x32_bf16 a[240:243], a[252:255], v[212:215], a[240:243]
    ds_read_b128 a[212:215], v6 offset:8704
    ds_read_b128 a[216:219], v6 offset:8960
    s_waitcnt lgkmcnt(7)
    v_mfma_f32_16x16x32_bf16 v[160:163], a[176:179], v[112:115], v[232:235]
    ds_read_b128 a[220:223], v6 offset:9216
    v_exp_f32 v244, v192
    v_mfma_f32_16x16x32_bf16 v[160:163], a[180:183], v[116:119], v[160:163]
    ds_read_b128 a[224:227], v6 offset:12672
    s_cbranch_vccnz L_st13_1
L_bk13_1:
    v_mfma_f32_16x16x32_bf16 v[160:163], a[184:187], v[120:123], v[160:163]
    v_exp_f32 v245, v193
    v_mfma_f32_16x16x32_bf16 v[160:163], a[188:191], v[124:127], v[160:163]
    ds_read_b128 a[228:231], v6 offset:12928
    v_cvt_pk_bf16_f32 v224, v244, v245
    s_waitcnt lgkmcnt(6)
    s_add_u32 m0, s90, 0
    s_mov_b32 s54, s14
    buffer_load_dwordx4 v4, s[32:35], s54 offen offset:0 lds
    s_add_u32 s54, s54, 7168
    v_mfma_f32_16x16x32_bf16 v[164:167], a[192:195], v[112:115], v[232:235]
    ds_read_b128 a[232:235], v6 offset:13184
    ds_read_b128 a[236:239], v6 offset:13440
    v_exp_f32 v246, v194
    v_mfma_f32_16x16x32_bf16 v[164:167], a[196:199], v[116:119], v[164:167]
    v_mfma_f32_16x16x32_bf16 v[164:167], a[200:203], v[120:123], v[164:167]
    v_exp_f32 v247, v195
    v_mfma_f32_16x16x32_bf16 v[164:167], a[204:207], v[124:127], v[164:167]
    v_cvt_pk_bf16_f32 v225, v246, v247
    s_waitcnt lgkmcnt(4)
    v_mfma_f32_16x16x32_bf16 v[168:171], a[208:211], v[112:115], v[232:235]
    v_exp_f32 v244, v196
    v_mfma_f32_16x16x32_bf16 v[168:171], a[212:215], v[116:119], v[168:171]
    v_mfma_f32_16x16x32_bf16 v[168:171], a[216:219], v[120:123], v[168:171]
    v_exp_f32 v245, v197
    buffer_load_dwordx4 v4, s[32:35], s54 offen offset:1024 lds
    s_add_u32 s54, s54, 7168
    v_mfma_f32_16x16x32_bf16 v[168:171], a[220:223], v[124:127], v[168:171]
    v_cvt_pk_bf16_f32 v226, v244, v245
    s_waitcnt lgkmcnt(0)
    v_mfma_f32_16x16x32_bf16 v[172:175], a[224:227], v[112:115], v[232:235]
    v_exp_f32 v246, v198
    v_mfma_f32_16x16x32_bf16 v[172:175], a[228:231], v[116:119], v[172:175]
    v_or3_b32 v11, v224, v225, v226
    v_mfma_f32_16x16x32_bf16 v[172:175], a[232:235], v[120:123], v[172:175]
    v_exp_f32 v247, v199
    v_mfma_f32_16x16x32_bf16 v[172:175], a[236:239], v[124:127], v[172:175]
    v_cvt_pk_bf16_f32 v227, v246, v247
    v_mfma_f32_16x16x32_bf16 v[48:51], a[112:115], v[216:219], v[48:51]
    v_exp_f32 v244, v200
    v_mfma_f32_16x16x32_bf16 v[48:51], a[116:119], v[220:223], v[48:51]
    v_mfma_f32_16x16x32_bf16 v[52:55], a[120:123], v[216:219], v[52:55]
    v_exp_f32 v245, v201
    buffer_load_dwordx4 v4, s[32:35], s54 offen offset:2048 lds
    s_add_u32 s54, s54, 7168
    v_mfma_f32_16x16x32_bf16 v[52:55], a[124:127], v[220:223], v[52:55]
    v_cvt_pk_bf16_f32 v228, v244, v245
    v_mfma_f32_16x16x32_bf16 v[56:59], a[128:131], v[216:219], v[56:59]
    v_exp_f32 v246, v202
    v_mfma_f32_16x16x32_bf16 v[56:59], a[132:135], v[220:223], v[56:59]
    v_or3_b32 v11, v11, v227, v228
    v_mfma_f32_16x16x32_bf16 v[60:63], a[136:139], v[216:219], v[60:63]
    v_exp_f32 v247, v203
    v_mfma_f32_16x16x32_bf16 v[60:63], a[140:143], v[220:223], v[60:63]
    v_cvt_pk_bf16_f32 v229, v246, v247
    v_mfma_f32_16x16x32_bf16 v[64:67], a[144:147], v[216:219], v[64:67]
    v_exp_f32 v244, v204
    v_mfma_f32_16x16x32_bf16 v[64:67], a[148:151], v[220:223], v[64:67]
    buffer_load_dwordx4 v4, s[32:35], s54 offen offset:3072 lds
    s_add_u32 s14, s14, 32768
    s_and_b32 s14, s14, 0x7ffff
    v_mfma_f32_16x16x32_bf16 v[68:71], a[152:155], v[216:219], v[68:71]
    v_exp_f32 v245, v205
    v_mfma_f32_16x16x32_bf16 v[68:71], a[156:159], v[220:223], v[68:71]
    v_cvt_pk_bf16_f32 v230, v244, v245
    v_mfma_f32_16x16x32_bf16 v[72:75], a[160:163], v[216:219], v[72:75]
    v_exp_f32 v246, v206
    v_mfma_f32_16x16x32_bf16 v[72:75], a[164:167], v[220:223], v[72:75]
    v_or3_b32 v11, v11, v229, v230
    v_mfma_f32_16x16x32_bf16 v[76:79], a[168:171], v[216:219], v[76:79]
    v_exp_f32 v247, v207
    v_mfma_f32_16x16x32_bf16 v[76:79], a[172:175], v[220:223], v[76:79]
    v_cvt_pk_bf16_f32 v231, v246, v247
    v_mfma_f32_16x16x32_bf16 a[244:247], a[252:255], v[216:219], a[244:247]
    v_bitop3_b32 v11, v11, v231, s47 bitop3:0xa8
    v_cmp_ne_u32 vcc, 0, v11
    v_mfma_f32_16x16x32_bf16 a[244:247], a[252:255], v[220:223], a[244:247]
    v_mfma_f32_16x16x32_bf16 v[176:179], a[176:179], v[128:131], v[236:239]
    v_exp_f32 v244, v160
    v_mfma_f32_16x16x32_bf16 v[176:179], a[180:183], v[132:135], v[176:179]
    s_cbranch_vccnz L_st13_2
L_bk13_2:
    v_mfma_f32_16x16x32_bf16 v[176:179], a[184:187], v[136:139], v[176:179]
    v_exp_f32 v245, v161
    s_barrier
    v_mfma_f32_16x16x32_bf16 v[176:179], a[188:191], v[140:143], v[176:179]
    ds_read_b64_tr_b16 a[80:81], v8 offset:0
    v_cvt_pk_bf16_f32 v208, v244, v245
    s_add_u32 m0, s90, 4096
    s_mov_b32 s54, s14
    buffer_load_dwordx4 v4, s[32:35], s54 offen offset:0 lds
    s_add_u32 s54, s54, 7168
    v_mfma_f32_16x16x32_bf16 v[180:183], a[192:195], v[128:131], v[236:239]
    v_exp_f32 v246, v162
    v_mfma_f32_16x16x32_bf16 v[180:183], a[196:199], v[132:135], v[180:183]
    ds_read_b64_tr_b16 a[82:83], v8 offset:4224
    ds_read_b64_tr_b16 a[84:85], v8 offset:8448
    v_mfma_f32_16x16x32_bf16 v[180:183], a[200:203], v[136:139], v[180:183]
    v_exp_f32 v247, v163
    v_mfma_f32_16x16x32_bf16 v[180:183], a[204:207], v[140:143], v[180:183]
    ds_read_b64_tr_b16 a[86:87], v8 offset:12672
    v_cvt_pk_bf16_f32 v209, v246, v247
    v_mfma_f32_16x16x32_bf16 v[184:187], a[208:211], v[128:131], v[236:239]
    v_exp_f32 v244, v164
    v_mfma_f32_16x16x32_bf16 v[184:187], a[212:215], v[132:135], v[184:187]
    ds_read_b64_tr_b16 a[88:89], v8 offset:32
    ds_read_b64_tr_b16 a[90:91], v8 offset:4256
    v_mfma_f32_16x16x32_bf16 v[184:187], a[216:219], v[136:139], v[184:187]
    v_exp_f32 v245, v165
    buffer_load_dwordx4 v4, s[32:35], s54 offen offset:1024 lds
    s_add_u32 s54, s54, 7168
    v_mfma_f32_16x16x32_bf16 v[184:187], a[220:223], v[140:143], v[184:187]
    ds_read_b64_tr_b16 a[92:93], v8 offset:8480
    v_cvt_pk_bf16_f32 v210, v244, v245
    v_mfma_f32_16x16x32_bf16 v[188:191], a[224:227], v[128:131], v[236:239]
    v_exp_f32 v246, v166
    v_mfma_f32_16x16x32_bf16 v[188:191], a[228:231], v[132:135], v[188:191]
    ds_read_b64_tr_b16 a[94:95], v8 offset:12704
    v_or3_b32 v11, v208, v209, v210
    v_mfma_f32_16x16x32_bf16 v[188:191], a[232:235], v[136:139], v[188:191]
    v_exp_f32 v247, v167
    v_mfma_f32_16x16x32_bf16 v[188:191], a[236:239], v[140:143], v[188:191]
    ds_read_b64_tr_b16 a[96:97], v8 offset:256
    v_cvt_pk_bf16_f32 v211, v246, v247
    v_mfma_f32_16x16x32_bf16 v[80:83], a[112:115], v[224:227], v[80:83]
    v_exp_f32 v244, v168
    v_mfma_f32_16x16x32_bf16 v[80:83], a[116:119], v[228:231], v[80:83]
    ds_read_b64_tr_b16 a[98:99], v8 offset:4480
    ds_read_b64_tr_b16 a[100:101], v8 offset:8704
    v_mfma_f32_16x16x32_bf16 v[84:87], a[120:123], v[224:227], v[84:87]
    v_exp_f32 v245, v169
    buffer_load_dwordx4 v4, s[32:35], s54 offen offset:2048 lds
    s_add_u32 s54, s54, 7168
    v_mfma_f32_16x16x32_bf16 v[84:87], a[124:127], v[228:231], v[84:87]
    ds_read_b64_tr_b16 a[102:103], v8 offset:12928
    v_cvt_pk_bf16_f32 v212, v244, v245
    v_mfma_f32_16x16x32_bf16 v[88:91], a[128:131], v[224:227], v[88:91]
    v_exp_f32 v246, v170
    v_mfma_f32_16x16x32_bf16 v[88:91], a[132:135], v[228:231], v[88:91]
    ds_read_b64_tr_b16 a[104:105], v8 offset:288
    v_or3_b32 v11, v11, v211, v212
    v_mfma_f32_16x16x32_bf16 v[92:95], a[136:139], v[224:227], v[92:95]
    v_exp_f32 v247, v171
    v_mfma_f32_16x16x32_bf16 v[92:95], a[140:143], v[228:231], v[92:95]
    ds_read_b64_tr_b16 a[106:107], v8 offset:4512
    v_cvt_pk_bf16_f32 v213, v246, v247
    v_mfma_f32_16x16x32_bf16 v[96:99], a[144:147], v[224:227], v[96:99]
    v_exp_f32 v244, v172
    v_mfma_f32_16x16x32_bf16 v[96:99], a[148:151], v[228:231], v[96:99]
    ds_read_b64_tr_b16 a[108:109], v8 offset:8736
    ds_read_b64_tr_b16 a[110:111], v8 offset:12960
    buffer_load_dwordx4 v4, s[32:35], s54 offen offset:3072 lds
    s_add_u32 s14, s14, 32768
    s_and_b32 s14, s14, 0x7ffff
    v_mfma_f32_16x16x32_bf16 v[100:103], a[152:155], v[224:227], v[100:103]
    v_exp_f32 v245, v173
    v_mfma_f32_16x16x32_bf16 v[100:103], a[156:159], v[228:231], v[100:103]
    ds_read_b64_tr_b16 a[144:145], v8 offset:512
    v_cvt_pk_bf16_f32 v214, v244, v245
    v_mfma_f32_16x16x32_bf16 v[104:107], a[160:163], v[224:227], v[104:107]
    v_exp_f32 v246, v174
    v_mfma_f32_16x16x32_bf16 v[104:107], a[164:167], v[228:231], v[104:107]
    ds_read_b64_tr_b16 a[146:147], v8 offset:4736
    v_or3_b32 v11, v11, v213, v214
    v_mfma_f32_16x16x32_bf16 v[108:111], a[168:171], v[224:227], v[108:111]
    v_exp_f32 v247, v175
    v_mfma_f32_16x16x32_bf16 v[108:111], a[172:175], v[228:231], v[108:111]
    ds_read_b64_tr_b16 a[148:149], v8 offset:8960
    v_cvt_pk_bf16_f32 v215, v246, v247
    v_mfma_f32_16x16x32_bf16 a[248:251], a[252:255], v[224:227], a[248:251]
    v_bitop3_b32 v11, v11, v215, s47 bitop3:0xa8
    v_cmp_ne_u32 vcc, 0, v11
    v_mfma_f32_16x16x32_bf16 a[248:251], a[252:255], v[228:231], a[248:251]
    ds_read_b64_tr_b16 a[150:151], v8 offset:13184
    ds_read_b64_tr_b16 a[152:153], v8 offset:544
    v_mfma_f32_16x16x32_bf16 v[192:195], a[176:179], v[144:147], v[240:243]
    v_exp_f32 v244, v176
    v_mfma_f32_16x16x32_bf16 v[192:195], a[180:183], v[148:151], v[192:195]
    ds_read_b64_tr_b16 a[154:155], v8 offset:4768
    s_cbranch_vccnz L_st14_0
L_bk14_0:
    v_mfma_f32_16x16x32_bf16 v[192:195], a[184:187], v[152:155], v[192:195]
    v_exp_f32 v245, v177
    v_mfma_f32_16x16x32_bf16 v[192:195], a[188:191], v[156:159], v[192:195]
    ds_read_b64_tr_b16 a[156:157], v8 offset:8992
    v_cvt_pk_bf16_f32 v216, v244, v245
    s_add_u32 m0, s90, 8192
    s_mov_b32 s54, s14
    buffer_load_dwordx4 v4, s[32:35], s54 offen offset:0 lds
    s_add_u32 s54, s54, 7168
    v_mfma_f32_16x16x32_bf16 v[196:199], a[192:195], v[144:147], v[240:243]
    v_exp_f32 v246, v178
    v_mfma_f32_16x16x32_bf16 v[196:199], a[196:199], v[148:151], v[196:199]
    ds_read_b64_tr_b16 a[158:159], v8 offset:13216
    ds_read_b64_tr_b16 a[160:161], v8 offset:768
    v_mfma_f32_16x16x32_bf16 v[196:199], a[200:203], v[152:155], v[196:199]
    v_exp_f32 v247, v179
    v_mfma_f32_16x16x32_bf16 v[196:199], a[204:207], v[156:159], v[196:199]
    ds_read_b64_tr_b16 a[162:163], v8 offset:4992
    v_cvt_pk_bf16_f32 v217, v246, v247
    v_mfma_f32_16x16x32_bf16 v[200:203], a[208:211], v[144:147], v[240:243]
    v_exp_f32 v244, v180
    v_mfma_f32_16x16x32_bf16 v[200:203], a[212:215], v[148:151], v[200:203]
    ds_read_b64_tr_b16 a[164:165], v8 offset:9216
    ds_read_b64_tr_b16 a[166:167], v8 offset:13440
    v_mfma_f32_16x16x32_bf16 v[200:203], a[216:219], v[152:155], v[200:203]
    v_exp_f32 v245, v181
    buffer_load_dwordx4 v4, s[32:35], s54 offen offset:1024 lds
    s_add_u32 s54, s54, 7168
    v_mfma_f32_16x16x32_bf16 v[200:203], a[220:223], v[156:159], v[200:203]
    ds_read_b64_tr_b16 a[168:169], v8 offset:800
    v_cvt_pk_bf16_f32 v218, v244, v245
    v_mfma_f32_16x16x32_bf16 v[204:207], a[224:227], v[144:147], v[240:243]
    v_exp_f32 v246, v182
    v_mfma_f32_16x16x32_bf16 v[204:207], a[228:231], v[148:151], v[204:207]
    ds_read_b64_tr_b16 a[170:171], v8 offset:5024
    v_or3_b32 v11, v216, v217, v218
    v_mfma_f32_16x16x32_bf16 v[204:207], a[232:235], v[152:155], v[204:207]
    v_exp_f32 v247, v183
    v_mfma_f32_16x16x32_bf16 v[204:207], a[236:239], v[156:159], v[204:207]
    ds_read_b64_tr_b16 a[172:173], v8 offset:9248
    v_cvt_pk_bf16_f32 v219, v246, v247
    s_waitcnt lgkmcnt(15)
    v_mfma_f32_16x16x32_bf16 v[16:19], a[80:83], v[208:211], v[16:19]
    v_exp_f32 v244, v184
    v_mfma_f32_16x16x32_bf16 v[16:19], a[84:87], v[212:215], v[16:19]
    ds_read_b64_tr_b16 a[174:175], v8 offset:13472
    ds_read_b128 a[176:179], v5 offset:0
    v_mfma_f32_16x16x32_bf16 v[20:23], a[88:91], v[208:211], v[20:23]
    v_exp_f32 v245, v185
    buffer_load_dwordx4 v4, s[32:35], s54 offen offset:2048 lds
    s_add_u32 s54, s54, 7168
    v_mfma_f32_16x16x32_bf16 v[20:23], a[92:95], v[212:215], v[20:23]
    ds_read_b128 a[180:183], v5 offset:256
    v_cvt_pk_bf16_f32 v220, v244, v245
    v_mfma_f32_16x16x32_bf16 v[24:27], a[96:99], v[208:211], v[24:27]
    v_exp_f32 v246, v186
    v_mfma_f32_16x16x32_bf16 v[24:27], a[100:103], v[212:215], v[24:27]
    ds_read_b128 a[184:187], v5 offset:512
    v_or3_b32 v11, v11, v219, v220
    v_mfma_f32_16x16x32_bf16 v[28:31], a[104:107], v[208:211], v[28:31]
    v_exp_f32 v247, v187
    v_mfma_f32_16x16x32_bf16 v[28:31], a[108:111], v[212:215], v[28:31]
    ds_read_b128 a[188:191], v5 offset:768
    v_cvt_pk_bf16_f32 v221, v246, v247
    s_waitcnt lgkmcnt(12)
    v_mfma_f32_16x16x32_bf16 v[32:35], a[144:147], v[208:211], v[32:35]
    v_exp_f32 v244, v188
    v_mfma_f32_16x16x32_bf16 v[32:35], a[148:151], v[212:215], v[32:35]
    ds_read_b128 a[192:195], v5 offset:4224
    ds_read_b128 a[196:199], v5 offset:4480
    buffer_load_dwordx4 v4, s[32:35], s54 offen offset:3072 lds
    s_add_u32 s14, s14, 32768
    s_and_b32 s14, s14, 0x7ffff
    v_mfma_f32_16x16x32_bf16 v[36:39], a[152:155], v[208:211], v[36:39]
    v_exp_f32 v245, v189
    v_mfma_f32_16x16x32_bf16 v[36:39], a[156:159], v[212:215], v[36:39]
    ds_read_b128 a[200:203], v5 offset:4736
    v_cvt_pk_bf16_f32 v222, v244, v245
    s_waitcnt lgkmcnt(7)
    v_mfma_f32_16x16x32_bf16 v[40:43], a[160:163], v[208:211], v[40:43]
    v_exp_f32 v246, v190
    v_mfma_f32_16x16x32_bf16 v[40:43], a[164:167], v[212:215], v[40:43]
    ds_read_b128 a[204:207], v5 offset:4992
    v_or3_b32 v11, v11, v221, v222
    v_mfma_f32_16x16x32_bf16 v[44:47], a[168:171], v[208:211], v[44:47]
    v_exp_f32 v247, v191
    v_mfma_f32_16x16x32_bf16 v[44:47], a[172:175], v[212:215], v[44:47]
    ds_read_b128 a[208:211], v5 offset:8448
    v_cvt_pk_bf16_f32 v223, v246, v247
    v_mfma_f32_16x16x32_bf16 a[240:243], a[252:255], v[208:211], a[240:243]
    v_bitop3_b32 v11, v11, v223, s47 bitop3:0xa8
    v_cmp_ne_u32 vcc, 0, v11
    v_mfma_f32_16x16x32_bf16 a[240:243], a[252:255], v[212:215], a[240:243]
    ds_read_b128 a[212:215], v5 offset:8704
    ds_read_b128 a[216:219], v5 offset:8960
    s_waitcnt lgkmcnt(7)
    v_mfma_f32_16x16x32_bf16 v[160:163], a[176:179], v[112:115], v[232:235]
    ds_read_b128 a[220:223], v5 offset:9216
    v_exp_f32 v244, v192
    v_mfma_f32_16x16x32_bf16 v[160:163], a[180:183], v[116:119], v[160:163]
    ds_read_b128 a[224:227], v5 offset:12672
    s_cbranch_vccnz L_st14_1
L_bk14_1:
    v_mfma_f32_16x16x32_bf16 v[160:163], a[184:187], v[120:123], v[160:163]
    v_exp_f32 v245, v193
    v_mfma_f32_16x16x32_bf16 v[160:163], a[188:191], v[124:127], v[160:163]
    ds_read_b128 a[228:231], v5 offset:12928
    v_cvt_pk_bf16_f32 v224, v244, v245
    s_waitcnt lgkmcnt(6)
    s_add_u32 m0, s53, 33792
    s_mov_b32 s54, s14
    buffer_load_dwordx4 v4, s[32:35], s54 offen offset:0 lds
    s_add_u32 s54, s54, 7168
    v_mfma_f32_16x16x32_bf16 v[164:167], a[192:195], v[112:115], v[232:235]
    ds_read_b128 a[232:235], v5 offset:13184
    ds_read_b128 a[236:239], v5 offset:13440
    v_exp_f32 v246, v194
    v_mfma_f32_16x16x32_bf16 v[164:167], a[196:199], v[116:119], v[164:167]
    v_mfma_f32_16x16x32_bf16 v[164:167], a[200:203], v[120:123], v[164:167]
    v_exp_f32 v247, v195
    v_mfma_f32_16x16x32_bf16 v[164:167], a[204:207], v[124:127], v[164:167]
    v_cvt_pk_bf16_f32 v225, v246, v247
    s_waitcnt lgkmcnt(4)
    v_mfma_f32_16x16x32_bf16 v[168:171], a[208:211], v[112:115], v[232:235]
    v_exp_f32 v244, v196
    v_mfma_f32_16x16x32_bf16 v[168:171], a[212:215], v[116:119], v[168:171]
    v_mfma_f32_16x16x32_bf16 v[168:171], a[216:219], v[120:123], v[168:171]
    v_exp_f32 v245, v197
    buffer_load_dwordx4 v4, s[32:35], s54 offen offset:1024 lds
    s_add_u32 s54, s54, 7168
    v_mfma_f32_16x16x32_bf16 v[168:171], a[220:223], v[124:127], v[168:171]
    v_cvt_pk_bf16_f32 v226, v244, v245
    s_waitcnt lgkmcnt(0)
    v_mfma_f32_16x16x32_bf16 v[172:175], a[224:227], v[112:115], v[232:235]
    v_exp_f32 v246, v198
    v_mfma_f32_16x16x32_bf16 v[172:175], a[228:231], v[116:119], v[172:175]
    v_or3_b32 v11, v224, v225, v226
    v_mfma_f32_16x16x32_bf16 v[172:175], a[232:235], v[120:123], v[172:175]
    v_exp_f32 v247, v199
    v_mfma_f32_16x16x32_bf16 v[172:175], a[236:239], v[124:127], v[172:175]
    v_cvt_pk_bf16_f32 v227, v246, v247
    v_mfma_f32_16x16x32_bf16 v[48:51], a[80:83], v[216:219], v[48:51]
    v_exp_f32 v244, v200
    v_mfma_f32_16x16x32_bf16 v[48:51], a[84:87], v[220:223], v[48:51]
    v_mfma_f32_16x16x32_bf16 v[52:55], a[88:91], v[216:219], v[52:55]
    v_exp_f32 v245, v201
    buffer_load_dwordx4 v4, s[32:35], s54 offen offset:2048 lds
    s_add_u32 s54, s54, 7168
    v_mfma_f32_16x16x32_bf16 v[52:55], a[92:95], v[220:223], v[52:55]
    v_cvt_pk_bf16_f32 v228, v244, v245
    v_mfma_f32_16x16x32_bf16 v[56:59], a[96:99], v[216:219], v[56:59]
    v_exp_f32 v246, v202
    v_mfma_f32_16x16x32_bf16 v[56:59], a[100:103], v[220:223], v[56:59]
    v_or3_b32 v11, v11, v227, v228
    v_mfma_f32_16x16x32_bf16 v[60:63], a[104:107], v[216:219], v[60:63]
    v_exp_f32 v247, v203
    v_mfma_f32_16x16x32_bf16 v[60:63], a[108:111], v[220:223], v[60:63]
    v_cvt_pk_bf16_f32 v229, v246, v247
    v_mfma_f32_16x16x32_bf16 v[64:67], a[144:147], v[216:219], v[64:67]
    v_exp_f32 v244, v204
    v_mfma_f32_16x16x32_bf16 v[64:67], a[148:151], v[220:223], v[64:67]
    buffer_load_dwordx4 v4, s[32:35], s54 offen offset:3072 lds
    s_add_u32 s14, s14, 32768
    s_and_b32 s14, s14, 0x7ffff
    v_mfma_f32_16x16x32_bf16 v[68:71], a[152:155], v[216:219], v[68:71]
    v_exp_f32 v245, v205
    v_mfma_f32_16x16x32_bf16 v[68:71], a[156:159], v[220:223], v[68:71]
    v_cvt_pk_bf16_f32 v230, v244, v245
    v_mfma_f32_16x16x32_bf16 v[72:75], a[160:163], v[216:219], v[72:75]
    v_exp_f32 v246, v206
    v_mfma_f32_16x16x32_bf16 v[72:75], a[164:167], v[220:223], v[72:75]
    v_or3_b32 v11, v11, v229, v230
    v_mfma_f32_16x16x32_bf16 v[76:79], a[168:171], v[216:219], v[76:79]
    v_exp_f32 v247, v207
    v_mfma_f32_16x16x32_bf16 v[76:79], a[172:175], v[220:223], v[76:79]
    v_cvt_pk_bf16_f32 v231, v246, v247
    v_mfma_f32_16x16x32_bf16 a[244:247], a[252:255], v[216:219], a[244:247]
    v_bitop3_b32 v11, v11, v231, s47 bitop3:0xa8
    v_cmp_ne_u32 vcc, 0, v11
    v_mfma_f32_16x16x32_bf16 a[244:247], a[252:255], v[220:223], a[244:247]
    v_mfma_f32_16x16x32_bf16 v[176:179], a[176:179], v[128:131], v[236:239]
    v_exp_f32 v244, v160
    v_mfma_f32_16x16x32_bf16 v[176:179], a[180:183], v[132:135], v[176:179]
    s_cbranch_vccnz L_st14_2
L_bk14_2:
    v_mfma_f32_16x16x32_bf16 v[176:179], a[184:187], v[136:139], v[176:179]
    v_exp_f32 v245, v161
    s_waitcnt vmcnt(16)
    s_barrier
    v_mfma_f32_16x16x32_bf16 v[176:179], a[188:191], v[140:143], v[176:179]
    ds_read_b64_tr_b16 a[112:113], v7 offset:0
    v_cvt_pk_bf16_f32 v208, v244, v245
    s_add_u32 m0, s53, 50688
    s_mov_b32 s54, s14
    buffer_load_dwordx4 v4, s[32:35], s54 offen offset:0 lds
    s_add_u32 s54, s54, 7168
    v_mfma_f32_16x16x32_bf16 v[180:183], a[192:195], v[128:131], v[236:239]
    v_exp_f32 v246, v162
    v_mfma_f32_16x16x32_bf16 v[180:183], a[196:199], v[132:135], v[180:183]
    ds_read_b64_tr_b16 a[114:115], v7 offset:4224
    ds_read_b64_tr_b16 a[116:117], v7 offset:8448
    buffer_load_dwordx4 v4, s[32:35], s54 offen offset:1024 lds
    s_add_u32 s54, s54, 7168
    v_mfma_f32_16x16x32_bf16 v[180:183], a[200:203], v[136:139], v[180:183]
    v_exp_f32 v247, v163
    v_mfma_f32_16x16x32_bf16 v[180:183], a[204:207], v[140:143], v[180:183]
    ds_read_b64_tr_b16 a[118:119], v7 offset:12672
    v_cvt_pk_bf16_f32 v209, v246, v247
    buffer_load_dwordx4 v4, s[32:35], s54 offen offset:2048 lds
    s_add_u32 s54, s54, 7168
    v_mfma_f32_16x16x32_bf16 v[184:187], a[208:211], v[128:131], v[236:239]
    v_exp_f32 v244, v164
    v_mfma_f32_16x16x32_bf16 v[184:187], a[212:215], v[132:135], v[184:187]
    ds_read_b64_tr_b16 a[120:121], v7 offset:32
    ds_read_b64_tr_b16 a[122:123], v7 offset:4256
    buffer_load_dwordx4 v4, s[32:35], s54 offen offset:3072 lds
    s_add_u32 s14, s14, 32768
    s_and_b32 s14, s14, 0x7ffff
    v_mfma_f32_16x16x32_bf16 v[184:187], a[216:219], v[136:139], v[184:187]
    v_exp_f32 v245, v165
    v_mfma_f32_16x16x32_bf16 v[184:187], a[220:223], v[140:143], v[184:187]
    ds_read_b64_tr_b16 a[124:125], v7 offset:8480
    v_cvt_pk_bf16_f32 v210, v244, v245
    v_mfma_f32_16x16x32_bf16 v[188:191], a[224:227], v[128:131], v[236:239]
    v_exp_f32 v246, v166
    s_add_u32 s55, s90, 0
    v_add_u32 v9, s55, v3
    v_add_u32 v10, s55, v14
    s_waitcnt vmcnt(16)
    v_mfma_f32_16x16x32_bf16 v[188:191], a[228:231], v[132:135], v[188:191]
    ds_read_b64_tr_b16 a[126:127], v7 offset:12704
    v_or3_b32 v11, v208, v209, v210
    v_mfma_f32_16x16x32_bf16 v[188:191], a[232:235], v[136:139], v[188:191]
    v_exp_f32 v247, v167
    ds_read_b64_tr_b16 a[0:1], v9 offset:0
    v_mfma_f32_16x16x32_bf16 v[188:191], a[236:239], v[140:143], v[188:191]
    ds_read_b64_tr_b16 a[128:129], v7 offset:256
    v_cvt_pk_bf16_f32 v211, v246, v247
    v_mfma_f32_16x16x32_bf16 v[80:83], a[80:83], v[224:227], v[80:83]
    v_exp_f32 v244, v168
    ds_read_b64_tr_b16 a[2:3], v9 offset:2048
    v_mfma_f32_16x16x32_bf16 v[80:83], a[84:87], v[228:231], v[80:83]
    ds_read_b64_tr_b16 a[130:131], v7 offset:4480
    ds_read_b64_tr_b16 a[132:133], v7 offset:8704
    v_mfma_f32_16x16x32_bf16 v[84:87], a[88:91], v[224:227], v[84:87]
    v_exp_f32 v245, v169
    v_mfma_f32_16x16x32_bf16 v[84:87], a[92:95], v[228:231], v[84:87]
    ds_read_b64_tr_b16 a[134:135], v7 offset:12928
    v_cvt_pk_bf16_f32 v212, v244, v245
    ds_read_b64_tr_b16 a[4:5], v10 offset:0
    v_mfma_f32_16x16x32_bf16 v[88:91], a[96:99], v[224:227], v[88:91]
    v_exp_f32 v246, v170
    v_mfma_f32_16x16x32_bf16 v[88:91], a[100:103], v[228:231], v[88:91]
    ds_read_b64_tr_b16 a[136:137], v7 offset:288
    v_or3_b32 v11, v11, v211, v212
    ds_read_b64_tr_b16 a[6:7], v10 offset:2048
    v_mfma_f32_16x16x32_bf16 v[92:95], a[104:107], v[224:227], v[92:95]
    v_exp_f32 v247, v171
    v_mfma_f32_16x16x32_bf16 v[92:95], a[108:111], v[228:231], v[92:95]
    ds_read_b64_tr_b16 a[138:139], v7 offset:4512
    v_cvt_pk_bf16_f32 v213, v246, v247
    ds_read_b64_tr_b16 a[8:9], v9 offset:512
    v_mfma_f32_16x16x32_bf16 v[96:99], a[144:147], v[224:227], v[96:99]
    v_exp_f32 v244, v172
    v_mfma_f32_16x16x32_bf16 v[96:99], a[148:151], v[228:231], v[96:99]
    ds_read_b64_tr_b16 a[140:141], v7 offset:8736
    ds_read_b64_tr_b16 a[142:143], v7 offset:12960
    v_mfma_f32_16x16x32_bf16 v[100:103], a[152:155], v[224:227], v[100:103]
    v_exp_f32 v245, v173
    ds_read_b64_tr_b16 a[10:11], v9 offset:2560
    v_mfma_f32_16x16x32_bf16 v[100:103], a[156:159], v[228:231], v[100:103]
    ds_read_b64_tr_b16 a[144:145], v7 offset:512
    v_cvt_pk_bf16_f32 v214, v244, v245
    v_mfma_f32_16x16x32_bf16 v[104:107], a[160:163], v[224:227], v[104:107]
    v_exp_f32 v246, v174
    ds_read_b64_tr_b16 a[12:13], v10 offset:512
    v_mfma_f32_16x16x32_bf16 v[104:107], a[164:167], v[228:231], v[104:107]
    ds_read_b64_tr_b16 a[146:147], v7 offset:4736
    v_or3_b32 v11, v11, v213, v214
    v_mfma_f32_16x16x32_bf16 v[108:111], a[168:171], v[224:227], v[108:111]
    v_exp_f32 v247, v175
    ds_read_b64_tr_b16 a[14:15], v10 offset:2560
    v_mfma_f32_16x16x32_bf16 v[108:111], a[172:175], v[228:231], v[108:111]
    ds_read_b64_tr_b16 a[148:149], v7 offset:8960
    v_cvt_pk_bf16_f32 v215, v246, v247
    v_mfma_f32_16x16x32_bf16 a[248:251], a[252:255], v[224:227], a[248:251]
    v_bitop3_b32 v11, v11, v215, s47 bitop3:0xa8
    v_cmp_ne_u32 vcc, 0, v11
    v_mfma_f32_16x16x32_bf16 a[248:251], a[252:255], v[228:231], a[248:251]
    ds_read_b64_tr_b16 a[150:151], v7 offset:13184
    ds_read_b64_tr_b16 a[152:153], v7 offset:544
    v_mfma_f32_16x16x32_bf16 v[192:195], a[176:179], v[144:147], v[240:243]
    v_exp_f32 v244, v176
    v_mfma_f32_16x16x32_bf16 v[192:195], a[180:183], v[148:151], v[192:195]
    ds_read_b64_tr_b16 a[154:155], v7 offset:4768
    s_cbranch_vccnz L_st15_0
L_bk15_0:
    v_mfma_f32_16x16x32_bf16 v[192:195], a[184:187], v[152:155], v[192:195]
    v_exp_f32 v245, v177
    v_mfma_f32_16x16x32_bf16 v[192:195], a[188:191], v[156:159], v[192:195]
    ds_read_b64_tr_b16 a[156:157], v7 offset:8992
    v_cvt_pk_bf16_f32 v216, v244, v245
    s_add_u32 m0, s53, 67584
    s_mov_b32 s54, s14
    buffer_load_dwordx4 v4, s[32:35], s54 offen offset:0 lds
    s_add_u32 s54, s54, 7168
    v_mfma_f32_16x16x32_bf16 v[196:199], a[192:195], v[144:147], v[240:243]
    v_exp_f32 v246, v178
    buffer_load_dwordx4 v4, s[32:35], s54 offen offset:1024 lds
    s_add_u32 s54, s54, 7168
    v_mfma_f32_16x16x32_bf16 v[196:199], a[196:199], v[148:151], v[196:199]
    ds_read_b64_tr_b16 a[158:159], v7 offset:13216
    ds_read_b64_tr_b16 a[160:161], v7 offset:768
    v_mfma_f32_16x16x32_bf16 v[196:199], a[200:203], v[152:155], v[196:199]
    v_exp_f32 v247, v179
    buffer_load_dwordx4 v4, s[32:35], s54 offen offset:2048 lds
    s_add_u32 s54, s54, 7168
    v_mfma_f32_16x16x32_bf16 v[196:199], a[204:207], v[156:159], v[196:199]
    ds_read_b64_tr_b16 a[162:163], v7 offset:4992
    v_cvt_pk_bf16_f32 v217, v246, v247
    v_mfma_f32_16x16x32_bf16 v[200:203], a[208:211], v[144:147], v[240:243]
    v_exp_f32 v244, v180
    buffer_load_dwordx4 v4, s[32:35], s54 offen offset:3072 lds
    s_add_u32 s14, s14, 32768
    s_and_b32 s14, s14, 0x7ffff
    v_mfma_f32_16x16x32_bf16 v[200:203], a[212:215], v[148:151], v[200:203]
    ds_read_b64_tr_b16 a[164:165], v7 offset:9216
    ds_read_b64_tr_b16 a[166:167], v7 offset:13440
    v_mfma_f32_16x16x32_bf16 v[200:203], a[216:219], v[152:155], v[200:203]
    v_exp_f32 v245, v181
    s_waitcnt lgkmcnt(10)
    s_add_u32 m0, s90, 0
    s_mov_b32 s54, s14
    buffer_load_dwordx4 v4, s[32:35], s54 offen offset:0 lds
    s_add_u32 s54, s54, 7168
    v_mfma_f32_16x16x32_bf16 v[200:203], a[220:223], v[156:159], v[200:203]
    ds_read_b64_tr_b16 a[168:169], v7 offset:800
    v_cvt_pk_bf16_f32 v218, v244, v245
    buffer_load_dwordx4 v4, s[32:35], s54 offen offset:1024 lds
    s_add_u32 s54, s54, 7168
    v_mfma_f32_16x16x32_bf16 v[204:207], a[224:227], v[144:147], v[240:243]
    v_exp_f32 v246, v182
    v_mfma_f32_16x16x32_bf16 v[204:207], a[228:231], v[148:151], v[204:207]
    ds_read_b64_tr_b16 a[170:171], v7 offset:5024
    v_or3_b32 v11, v216, v217, v218
    buffer_load_dwordx4 v4, s[32:35], s54 offen offset:2048 lds
    s_add_u32 s54, s54, 7168
    v_mfma_f32_16x16x32_bf16 v[204:207], a[232:235], v[152:155], v[204:207]
    v_exp_f32 v247, v183
    v_mfma_f32_16x16x32_bf16 v[204:207], a[236:239], v[156:159], v[204:207]
    ds_read_b64_tr_b16 a[172:173], v7 offset:9248
    v_cvt_pk_bf16_f32 v219, v246, v247
    buffer_load_dwordx4 v4, s[32:35], s54 offen offset:3072 lds
    s_add_u32 s14, s14, 32768
    s_and_b32 s14, s14, 0x7ffff
    v_mfma_f32_16x16x32_bf16 v[16:19], a[112:115], v[208:211], v[16:19]
    v_exp_f32 v244, v184
    v_mfma_f32_16x16x32_bf16 v[16:19], a[116:119], v[212:215], v[16:19]
    ds_read_b64_tr_b16 a[174:175], v7 offset:13472
    s_add_u32 s55, s90, 4096
    v_add_u32 v9, s55, v3
    v_add_u32 v10, s55, v14
    s_waitcnt vmcnt(20)
    v_mfma_f32_16x16x32_bf16 v[20:23], a[120:123], v[208:211], v[20:23]
    v_exp_f32 v245, v185
    ds_read_b64_tr_b16 a[16:17], v9 offset:0
    v_mfma_f32_16x16x32_bf16 v[20:23], a[124:127], v[212:215], v[20:23]
    v_cvt_pk_bf16_f32 v220, v244, v245
    v_mfma_f32_16x16x32_bf16 v[24:27], a[128:131], v[208:211], v[24:27]
    v_exp_f32 v246, v186
    ds_read_b64_tr_b16 a[18:19], v9 offset:2048
    v_mfma_f32_16x16x32_bf16 v[24:27], a[132:135], v[212:215], v[24:27]
    v_or3_b32 v11, v11, v219, v220
    v_mfma_f32_16x16x32_bf16 v[28:31], a[136:139], v[208:211], v[28:31]
    v_exp_f32 v247, v187
    ds_read_b64_tr_b16 a[20:21], v10 offset:0
    v_mfma_f32_16x16x32_bf16 v[28:31], a[140:143], v[212:215], v[28:31]
    v_cvt_pk_bf16_f32 v221, v246, v247
    s_waitcnt lgkmcnt(11)
    v_mfma_f32_16x16x32_bf16 v[32:35], a[144:147], v[208:211], v[32:35]
    v_exp_f32 v244, v188
    ds_read_b64_tr_b16 a[22:23], v10 offset:2048
    v_mfma_f32_16x16x32_bf16 v[32:35], a[148:151], v[212:215], v[32:35]
    ds_read_b64_tr_b16 a[24:25], v9 offset:512
    v_mfma_f32_16x16x32_bf16 v[36:39], a[152:155], v[208:211], v[36:39]
    v_exp_f32 v245, v189
    v_mfma_f32_16x16x32_bf16 v[36:39], a[156:159], v[212:215], v[36:39]
    v_cvt_pk_bf16_f32 v222, v244, v245
    s_waitcnt lgkmcnt(5)
    ds_read_b64_tr_b16 a[26:27], v9 offset:2560
    v_mfma_f32_16x16x32_bf16 v[40:43], a[160:163], v[208:211], v[40:43]
    v_exp_f32 v246, v190
    v_mfma_f32_16x16x32_bf16 v[40:43], a[164:167], v[212:215], v[40:43]
    v_or3_b32 v11, v11, v221, v222
    ds_read_b64_tr_b16 a[28:29], v10 offset:512
    v_mfma_f32_16x16x32_bf16 v[44:47], a[168:171], v[208:211], v[44:47]
    v_exp_f32 v247, v191
    v_mfma_f32_16x16x32_bf16 v[44:47], a[172:175], v[212:215], v[44:47]
    v_cvt_pk_bf16_f32 v223, v246, v247
    ds_read_b64_tr_b16 a[30:31], v10 offset:2560
    v_mfma_f32_16x16x32_bf16 a[240:243], a[252:255], v[208:211], a[240:243]
    v_bitop3_b32 v11, v11, v223, s47 bitop3:0xa8
    v_cmp_ne_u32 vcc, 0, v11
    v_mfma_f32_16x16x32_bf16 a[240:243], a[252:255], v[212:215], a[240:243]
    s_cbranch_vccnz L_st15_1
L_bk15_1:
    v_mfma_f32_16x16x32_bf16 a[244:247], a[252:255], v[216:219], a[244:247]
    v_exp_f32 v244, v192
    v_exp_f32 v245, v193
    v_mfma_f32_16x16x32_bf16 a[244:247], a[252:255], v[220:223], a[244:247]
    v_exp_f32 v246, v194
    v_cvt_pk_bf16_f32 v224, v244, v245
    v_mfma_f32_16x16x32_bf16 v[48:51], a[112:115], v[216:219], v[48:51]
    v_exp_f32 v247, v195
    v_exp_f32 v244, v196
    v_mfma_f32_16x16x32_bf16 v[48:51], a[116:119], v[220:223], v[48:51]
    v_cvt_pk_bf16_f32 v225, v246, v247
    v_accvgpr_read_b32 v250, a240
    v_rcp_f32 v250, v250
    s_nop 0
    v_mfma_f32_16x16x32_bf16 v[52:55], a[120:123], v[216:219], v[52:55]
    v_exp_f32 v245, v197
    v_exp_f32 v246, v198
    v_pk_mul_f32 v[16:17], v[16:17], v[250:251] op_sel_hi:[1,0]
    v_pk_mul_f32 v[18:19], v[18:19], v[250:251] op_sel_hi:[1,0]
    v_pk_mul_f32 v[20:21], v[20:21], v[250:251] op_sel_hi:[1,0]
    v_mfma_f32_16x16x32_bf16 v[52:55], a[124:127], v[220:223], v[52:55]
    v_cvt_pk_bf16_f32 v226, v244, v245
    v_exp_f32 v247, v199
    v_pk_mul_f32 v[22:23], v[22:23], v[250:251] op_sel_hi:[1,0]
    v_cvt_pk_bf16_f32 v16, v16, v17
    v_mfma_f32_16x16x32_bf16 v[56:59], a[128:131], v[216:219], v[56:59]
    v_or3_b32 v11, v224, v225, v226
    v_cvt_pk_bf16_f32 v17, v18, v19
    v_cvt_pk_bf16_f32 v18, v20, v21
    v_cvt_pk_bf16_f32 v19, v22, v23
    v_mfma_f32_16x16x32_bf16 v[56:59], a[132:135], v[220:223], v[56:59]
    v_exp_f32 v244, v200
    v_cvt_pk_bf16_f32 v227, v246, v247
    buffer_store_dwordx4 v[16:19], v0, s[36:39], s57 offen offset:0 sc1
    v_pk_mul_f32 v[24:25], v[24:25], v[250:251] op_sel_hi:[1,0]
    v_pk_mul_f32 v[26:27], v[26:27], v[250:251] op_sel_hi:[1,0]
    v_mfma_f32_16x16x32_bf16 v[60:63], a[136:139], v[216:219], v[60:63]
    v_exp_f32 v245, v201
    v_exp_f32 v246, v202
    v_pk_mul_f32 v[28:29], v[28:29], v[250:251] op_sel_hi:[1,0]
    v_pk_mul_f32 v[30:31], v[30:31], v[250:251] op_sel_hi:[1,0]
    v_mfma_f32_16x16x32_bf16 v[60:63], a[140:143], v[220:223], v[60:63]
    v_cvt_pk_bf16_f32 v228, v244, v245
    v_exp_f32 v247, v203
    v_cvt_pk_bf16_f32 v24, v24, v25
    v_cvt_pk_bf16_f32 v25, v26, v27
    v_cvt_pk_bf16_f32 v26, v28, v29
    v_mfma_f32_16x16x32_bf16 v[64:67], a[144:147], v[216:219], v[64:67]
    v_or3_b32 v11, v11, v227, v228
    v_cvt_pk_bf16_f32 v27, v30, v31
    buffer_store_dwordx4 v[24:27], v0, s[36:39], s57 offen offset:1024 sc1
    v_pk_mul_f32 v[32:33], v[32:33], v[250:251] op_sel_hi:[1,0]
    v_mfma_f32_16x16x32_bf16 v[64:67], a[148:151], v[220:223], v[64:67]
    v_exp_f32 v244, v204
    v_cvt_pk_bf16_f32 v229, v246, v247
    v_pk_mul_f32 v[34:35], v[34:35], v[250:251] op_sel_hi:[1,0]
    v_pk_mul_f32 v[36:37], v[36:37], v[250:251] op_sel_hi:[1,0]
    v_mfma_f32_16x16x32_bf16 v[68:71], a[152:155], v[216:219], v[68:71]
    v_exp_f32 v245, v205
    v_exp_f32 v246, v206
    v_pk_mul_f32 v[38:39], v[38:39], v[250:251] op_sel_hi:[1,0]
    v_cvt_pk_bf16_f32 v32, v32, v33
    v_cvt_pk_bf16_f32 v33, v34, v35
    v_mfma_f32_16x16x32_bf16 v[68:71], a[156:159], v[220:223], v[68:71]
    v_cvt_pk_bf16_f32 v230, v244, v245
    v_cvt_pk_bf16_f32 v34, v36, v37
    v_cvt_pk_bf16_f32 v35, v38, v39
    buffer_store_dwordx4 v[32:35], v0, s[36:39], s57 offen offset:2048 sc1
    v_mfma_f32_16x16x32_bf16 v[72:75], a[160:163], v[216:219], v[72:75]
    v_exp_f32 v247, v207
    v_or3_b32 v11, v11, v229, v230
    v_pk_mul_f32 v[40:41], v[40:41], v[250:251] op_sel_hi:[1,0]
    v_pk_mul_f32 v[42:43], v[42:43], v[250:251] op_sel_hi:[1,0]
    v_mfma_f32_16x16x32_bf16 v[72:75], a[164:167], v[220:223], v[72:75]
    v_cvt_pk_bf16_f32 v231, v246, v247
    v_bitop3_b32 v11, v11, v231, s47 bitop3:0xa8
    v_pk_mul_f32 v[44:45], v[44:45], v[250:251] op_sel_hi:[1,0]
    v_pk_mul_f32 v[46:47], v[46:47], v[250:251] op_sel_hi:[1,0]
    v_cvt_pk_bf16_f32 v40, v40, v41
    v_mfma_f32_16x16x32_bf16 v[76:79], a[168:171], v[216:219], v[76:79]
    v_cmp_ne_u32 vcc, 0, v11
    v_cvt_pk_bf16_f32 v41, v42, v43
    v_cvt_pk_bf16_f32 v42, v44, v45
    v_cvt_pk_bf16_f32 v43, v46, v47
    v_mfma_f32_16x16x32_bf16 v[76:79], a[172:175], v[220:223], v[76:79]
    buffer_store_dwordx4 v[40:43], v0, s[36:39], s57 offen offset:3072 sc1
    s_add_u32 s57, s57, 131456
    s_cbranch_vccnz L_st15_2
L_bk15_2:
    v_mfma_f32_16x16x32_bf16 a[248:251], a[252:255], v[224:227], a[248:251]
    v_mfma_f32_16x16x32_bf16 a[248:251], a[252:255], v[228:231], a[248:251]
    v_mfma_f32_16x16x32_bf16 v[80:83], a[112:115], v[224:227], v[80:83]
    v_mfma_f32_16x16x32_bf16 v[80:83], a[116:119], v[228:231], v[80:83]
    v_accvgpr_read_b32 v252, a244
    v_rcp_f32 v252, v252
    s_nop 0
    v_mfma_f32_16x16x32_bf16 v[84:87], a[120:123], v[224:227], v[84:87]
    v_pk_mul_f32 v[48:49], v[48:49], v[252:253] op_sel_hi:[1,0]
    v_pk_mul_f32 v[50:51], v[50:51], v[252:253] op_sel_hi:[1,0]
    v_pk_mul_f32 v[52:53], v[52:53], v[252:253] op_sel_hi:[1,0]
    v_mfma_f32_16x16x32_bf16 v[84:87], a[124:127], v[228:231], v[84:87]
    v_pk_mul_f32 v[54:55], v[54:55], v[252:253] op_sel_hi:[1,0]
    v_cvt_pk_bf16_f32 v48, v48, v49
    v_mfma_f32_16x16x32_bf16 v[88:91], a[128:131], v[224:227], v[88:91]
    v_cvt_pk_bf16_f32 v49, v50, v51
    v_cvt_pk_bf16_f32 v50, v52, v53
    v_cvt_pk_bf16_f32 v51, v54, v55
    v_mfma_f32_16x16x32_bf16 v[88:91], a[132:135], v[228:231], v[88:91]
    buffer_store_dwordx4 v[48:51], v0, s[36:39], s57 offen offset:0 sc1
    v_pk_mul_f32 v[56:57], v[56:57], v[252:253] op_sel_hi:[1,0]
    v_pk_mul_f32 v[58:59], v[58:59], v[252:253] op_sel_hi:[1,0]
    v_mfma_f32_16x16x32_bf16 v[92:95], a[136:139], v[224:227], v[92:95]
    v_pk_mul_f32 v[60:61], v[60:61], v[252:253] op_sel_hi:[1,0]
    v_pk_mul_f32 v[62:63], v[62:63], v[252:253] op_sel_hi:[1,0]
    v_mfma_f32_16x16x32_bf16 v[92:95], a[140:143], v[228:231], v[92:95]
    v_cvt_pk_bf16_f32 v56, v56, v57
    v_cvt_pk_bf16_f32 v57, v58, v59
    v_cvt_pk_bf16_f32 v58, v60, v61
    v_mfma_f32_16x16x32_bf16 v[96:99], a[144:147], v[224:227], v[96:99]
    v_cvt_pk_bf16_f32 v59, v62, v63
    buffer_store_dwordx4 v[56:59], v0, s[36:39], s57 offen offset:1024 sc1
    v_pk_mul_f32 v[64:65], v[64:65], v[252:253] op_sel_hi:[1,0]
    v_mfma_f32_16x16x32_bf16 v[96:99], a[148:151], v[228:231], v[96:99]
    v_pk_mul_f32 v[66:67], v[66:67], v[252:253] op_sel_hi:[1,0]
    v_pk_mul_f32 v[68:69], v[68:69], v[252:253] op_sel_hi:[1,0]
    v_mfma_f32_16x16x32_bf16 v[100:103], a[152:155], v[224:227], v[100:103]
    v_pk_mul_f32 v[70:71], v[70:71], v[252:253] op_sel_hi:[1,0]
    v_cvt_pk_bf16_f32 v64, v64, v65
    v_cvt_pk_bf16_f32 v65, v66, v67
    v_mfma_f32_16x16x32_bf16 v[100:103], a[156:159], v[228:231], v[100:103]
    v_cvt_pk_bf16_f32 v66, v68, v69
    v_cvt_pk_bf16_f32 v67, v70, v71
    buffer_store_dwordx4 v[64:67], v0, s[36:39], s57 offen offset:2048 sc1
    v_mfma_f32_16x16x32_bf16 v[104:107], a[160:163], v[224:227], v[104:107]
    v_pk_mul_f32 v[72:73], v[72:73], v[252:253] op_sel_hi:[1,0]
    v_pk_mul_f32 v[74:75], v[74:75], v[252:253] op_sel_hi:[1,0]
    v_mfma_f32_16x16x32_bf16 v[104:107], a[164:167], v[228:231], v[104:107]
    v_pk_mul_f32 v[76:77], v[76:77], v[252:253] op_sel_hi:[1,0]
    v_pk_mul_f32 v[78:79], v[78:79], v[252:253] op_sel_hi:[1,0]
    v_cvt_pk_bf16_f32 v72, v72, v73
    v_mfma_f32_16x16x32_bf16 v[108:111], a[168:171], v[224:227], v[108:111]
    v_cvt_pk_bf16_f32 v73, v74, v75
    v_cvt_pk_bf16_f32 v74, v76, v77
    v_cvt_pk_bf16_f32 v75, v78, v79
    v_mfma_f32_16x16x32_bf16 v[108:111], a[172:175], v[228:231], v[108:111]
    buffer_store_dwordx4 v[72:75], v0, s[36:39], s57 offen offset:3072 sc1
    s_add_u32 s57, s57, 131456
    s_nop 3
    v_accvgpr_read_b32 v254, a248
    v_rcp_f32 v254, v254
    s_nop 0
    v_pk_mul_f32 v[80:81], v[80:81], v[254:255] op_sel_hi:[1,0]
    v_pk_mul_f32 v[82:83], v[82:83], v[254:255] op_sel_hi:[1,0]
    v_pk_mul_f32 v[84:85], v[84:85], v[254:255] op_sel_hi:[1,0]
    v_pk_mul_f32 v[86:87], v[86:87], v[254:255] op_sel_hi:[1,0]
    v_cvt_pk_bf16_f32 v80, v80, v81
    v_cvt_pk_bf16_f32 v81, v82, v83
    v_cvt_pk_bf16_f32 v82, v84, v85
    v_cvt_pk_bf16_f32 v83, v86, v87
    buffer_store_dwordx4 v[80:83], v0, s[36:39], s57 offen offset:0 sc1
    v_pk_mul_f32 v[88:89], v[88:89], v[254:255] op_sel_hi:[1,0]
    v_pk_mul_f32 v[90:91], v[90:91], v[254:255] op_sel_hi:[1,0]
    v_pk_mul_f32 v[92:93], v[92:93], v[254:255] op_sel_hi:[1,0]
    v_pk_mul_f32 v[94:95], v[94:95], v[254:255] op_sel_hi:[1,0]
    v_cvt_pk_bf16_f32 v88, v88, v89
    v_cvt_pk_bf16_f32 v89, v90, v91
    v_cvt_pk_bf16_f32 v90, v92, v93
    v_cvt_pk_bf16_f32 v91, v94, v95
    buffer_store_dwordx4 v[88:91], v0, s[36:39], s57 offen offset:1024 sc1
    v_pk_mul_f32 v[96:97], v[96:97], v[254:255] op_sel_hi:[1,0]
    v_pk_mul_f32 v[98:99], v[98:99], v[254:255] op_sel_hi:[1,0]
    v_pk_mul_f32 v[100:101], v[100:101], v[254:255] op_sel_hi:[1,0]
    v_pk_mul_f32 v[102:103], v[102:103], v[254:255] op_sel_hi:[1,0]
    v_cvt_pk_bf16_f32 v96, v96, v97
    v_cvt_pk_bf16_f32 v97, v98, v99
    v_cvt_pk_bf16_f32 v98, v100, v101
    v_cvt_pk_bf16_f32 v99, v102, v103
    buffer_store_dwordx4 v[96:99], v0, s[36:39], s57 offen offset:2048 sc1
    v_pk_mul_f32 v[104:105], v[104:105], v[254:255] op_sel_hi:[1,0]
    v_pk_mul_f32 v[106:107], v[106:107], v[254:255] op_sel_hi:[1,0]
    v_pk_mul_f32 v[108:109], v[108:109], v[254:255] op_sel_hi:[1,0]
    v_pk_mul_f32 v[110:111], v[110:111], v[254:255] op_sel_hi:[1,0]
    v_cvt_pk_bf16_f32 v104, v104, v105
    v_cvt_pk_bf16_f32 v105, v106, v107
    v_cvt_pk_bf16_f32 v106, v108, v109
    v_cvt_pk_bf16_f32 v107, v110, v111
    buffer_store_dwordx4 v[104:107], v0, s[36:39], s57 offen offset:3072 sc1
    s_add_u32 s57, s57, 131456
    s_add_u32 m0, s53, 84480
    s_mov_b32 s54, s14
    buffer_load_dwordx4 v4, s[32:35], s54 offen offset:0 lds
    s_add_u32 s54, s54, 7168
    buffer_load_dwordx4 v4, s[32:35], s54 offen offset:1024 lds
    s_add_u32 s54, s54, 7168
    buffer_load_dwordx4 v4, s[32:35], s54 offen offset:2048 lds
    s_add_u32 s54, s54, 7168
    buffer_load_dwordx4 v4, s[32:35], s54 offen offset:3072 lds
    s_add_u32 s14, s14, 32768
    s_and_b32 s14, s14, 0x7ffff
    s_add_u32 m0, s53, 0
    s_mov_b32 s54, s14
    buffer_load_dwordx4 v4, s[32:35], s54 offen offset:0 lds
    s_add_u32 s54, s54, 7168
    buffer_load_dwordx4 v4, s[32:35], s54 offen offset:1024 lds
    s_add_u32 s54, s54, 7168
    buffer_load_dwordx4 v4, s[32:35], s54 offen offset:2048 lds
    s_add_u32 s54, s54, 7168
    buffer_load_dwordx4 v4, s[32:35], s54 offen offset:3072 lds
    s_add_u32 s14, s14, 32768
    s_and_b32 s14, s14, 0x7ffff
    s_add_u32 s55, s90, 8192
    v_add_u32 v9, s55, v3
    v_add_u32 v10, s55, v14
    s_waitcnt vmcnt(36)
    ds_read_b64_tr_b16 a[32:33], v9 offset:0
    ds_read_b64_tr_b16 a[34:35], v9 offset:2048
    ds_read_b64_tr_b16 a[36:37], v10 offset:0
    ds_read_b64_tr_b16 a[38:39], v10 offset:2048
    ds_read_b64_tr_b16 a[40:41], v9 offset:512
    ds_read_b64_tr_b16 a[42:43], v9 offset:2560
    ds_read_b64_tr_b16 a[44:45], v10 offset:512
    ds_read_b64_tr_b16 a[46:47], v10 offset:2560
    s_waitcnt lgkmcnt(8)
    s_add_u32 m0, s90, 4096
    s_mov_b32 s54, s14
    buffer_load_dwordx4 v4, s[32:35], s54 offen offset:0 lds
    s_add_u32 s54, s54, 7168
    buffer_load_dwordx4 v4, s[32:35], s54 offen offset:1024 lds
    s_add_u32 s54, s54, 7168
    buffer_load_dwordx4 v4, s[32:35], s54 offen offset:2048 lds
    s_add_u32 s54, s54, 7168
    buffer_load_dwordx4 v4, s[32:35], s54 offen offset:3072 lds
    s_add_u32 s14, s14, 32768
    s_and_b32 s14, s14, 0x7ffff
    v_and_b32 v11, 1, v1
    v_lshrrev_b32 v12, 1, v1
    v_lshl_add_u32 v11, v12, 2, v11
    v_mul_u32_u24 v11, 9216, v11
    s_and_b32 s15, s43, 6
    s_lshr_b32 s55, s44, 4
    s_add_u32 s15, s15, s55
    s_and_b32 s55, s43, 1
    s_lshl_b32 s55, s55, 4
    s_add_u32 s15, s15, s55
    s_mul_i32 s15, s15, 1152
    s_and_b32 s55, s44, 15
    s_lshl_b32 s55, s55, 3
    s_add_u32 s15, s15, s55
    s_and_b32 s55, s44, 0
    s_lshl_b32 s55, s55, 5
    s_add_u32 s15, s15, s55
    s_add_u32 s15, s15, 16777216
    v_mov_b32 v12, s92
    v_mov_b32 v13, s93
    s_waitcnt vmcnt(12)
    s_barrier
    s_cmp_lg_u32 s40, 0
    s_cbranch_scc1 L_c3
    s_mov_b64 exec, 0xffff
    buffer_store_dwordx2 v[12:13], v11, s[36:39], s15 offen sc1
    s_mov_b64 exec, -1
L_c3:
    s_xor_b32 s56, s42, 1
    s_mul_i32 s56, s56, 394368
    s_mul_i32 s57, s42, 394368
    v_add_u32 v160, s56, v0
    v_add_u32 v163, s57, v0
    v_add_u32 v161, 131456, v160
    v_add_u32 v162, 262912, v160
    v_add_u32 v164, 131456, v163
    v_add_u32 v165, 262912, v163
    v_add_u32 v167, s90, v0
    s_lshl_b32 s57, s40, 10
    s_add_u32 s57, s57, 101376
    v_add_u32 v168, s57, v0
    s_mul_i32 s57, s40, 3072
    v_add_u32 v166, s57, v0
    v_and_b32 v169, 15, v1
    v_lshlrev_b32 v169, 10, v169
    v_lshrrev_b32 v6, 4, v1
    v_lshl_add_u32 v169, v6, 3, v169
    v_and_b32 v7, 15, v1
    s_cmp_eq_u32 s40, 0
    s_cselect_b32 s56, s45, 67108864
    v_lshl_add_u32 v7, v7, 3, s56
    s_waitcnt lgkmcnt(0)
    s_add_u32 m0, s90, 8192
    s_mov_b32 s54, s14
    buffer_load_dwordx4 v4, s[32:35], s54 offen offset:0 lds
    s_add_u32 s54, s54, 7168
    buffer_load_dwordx4 v4, s[32:35], s54 offen offset:1024 lds
    s_add_u32 s54, s54, 7168
    buffer_load_dwordx4 v4, s[32:35], s54 offen offset:2048 lds
    s_add_u32 s54, s54, 7168
    buffer_load_dwordx4 v4, s[32:35], s54 offen offset:3072 lds
    s_add_u32 s14, s14, 32768
    s_and_b32 s14, s14, 0x7ffff
    s_add_u32 s55, s53, 33792
    v_add_u32 v9, s55, v3
    v_add_u32 v10, s55, v14
    ds_read_b64_tr_b16 a[48:49], v9 offset:0
    ds_read_b64_tr_b16 a[50:51], v9 offset:2048
    ds_read_b64_tr_b16 a[52:53], v10 offset:0
    ds_read_b64_tr_b16 a[54:55], v10 offset:2048
    ds_read_b64_tr_b16 a[56:57], v9 offset:512
    ds_read_b64_tr_b16 a[58:59], v9 offset:2560
    ds_read_b64_tr_b16 a[60:61], v10 offset:512
    ds_read_b64_tr_b16 a[62:63], v10 offset:2560
    s_add_u32 m0, s53, 16896
    s_mov_b32 s54, s14
    buffer_load_dwordx4 v4, s[32:35], s54 offen offset:0 lds
    s_add_u32 s54, s54, 7168
    buffer_load_dwordx4 v4, s[32:35], s54 offen offset:1024 lds
    s_add_u32 s54, s54, 7168
    buffer_load_dwordx4 v4, s[32:35], s54 offen offset:2048 lds
    s_add_u32 s54, s54, 7168
    buffer_load_dwordx4 v4, s[32:35], s54 offen offset:3072 lds
    s_add_u32 s14, s14, 32768
    s_and_b32 s14, s14, 0x7ffff
    s_add_u32 s55, s53, 50688
    v_add_u32 v9, s55, v3
    v_add_u32 v10, s55, v14
    ds_read_b64_tr_b16 a[64:65], v9 offset:0
    ds_read_b64_tr_b16 a[66:67], v9 offset:2048
    ds_read_b64_tr_b16 a[68:69], v10 offset:0
    ds_read_b64_tr_b16 a[70:71], v10 offset:2048
    ds_read_b64_tr_b16 a[72:73], v9 offset:512
    ds_read_b64_tr_b16 a[74:75], v9 offset:2560
    ds_read_b64_tr_b16 a[76:77], v10 offset:512
    ds_read_b64_tr_b16 a[78:79], v10 offset:2560
    s_waitcnt lgkmcnt(8)
    s_add_u32 m0, s53, 33792
    s_mov_b32 s54, s14
    buffer_load_dwordx4 v4, s[32:35], s54 offen offset:0 lds
    s_add_u32 s54, s54, 7168
    buffer_load_dwordx4 v4, s[32:35], s54 offen offset:1024 lds
    s_add_u32 s54, s54, 7168
    buffer_load_dwordx4 v4, s[32:35], s54 offen offset:2048 lds
    s_add_u32 s54, s54, 7168
    buffer_load_dwordx4 v4, s[32:35], s54 offen offset:3072 lds
    s_add_u32 s14, s14, 32768
    s_and_b32 s14, s14, 0x7ffff
    s_add_u32 s55, s53, 67584
    v_add_u32 v9, s55, v3
    v_add_u32 v10, s55, v14
    ds_read_b64_tr_b16 a[80:81], v9 offset:0
    ds_read_b64_tr_b16 a[82:83], v9 offset:2048
    ds_read_b64_tr_b16 a[84:85], v10 offset:0
    ds_read_b64_tr_b16 a[86:87], v10 offset:2048
    ds_read_b64_tr_b16 a[88:89], v9 offset:512
    ds_read_b64_tr_b16 a[90:91], v9 offset:2560
    ds_read_b64_tr_b16 a[92:93], v10 offset:512
    ds_read_b64_tr_b16 a[94:95], v10 offset:2560
    s_waitcnt lgkmcnt(8)
    s_add_u32 m0, s53, 50688
    s_mov_b32 s54, s14
    buffer_load_dwordx4 v4, s[32:35], s54 offen offset:0 lds
    s_add_u32 s54, s54, 7168
    buffer_load_dwordx4 v4, s[32:35], s54 offen offset:1024 lds
    s_add_u32 s54, s54, 7168
    buffer_load_dwordx4 v4, s[32:35], s54 offen offset:2048 lds
    s_add_u32 s54, s54, 7168
    buffer_load_dwordx4 v4, s[32:35], s54 offen offset:3072 lds
    s_add_u32 s14, s14, 32768
    s_and_b32 s14, s14, 0x7ffff
    buffer_load_dwordx2 v[172:173], v7, s[36:39], 0 offen sc1
    s_add_u32 s55, s90, 0
    v_add_u32 v9, s55, v3
    v_add_u32 v10, s55, v14
    ds_read_b64_tr_b16 a[96:97], v9 offset:0
    ds_read_b64_tr_b16 a[98:99], v9 offset:2048
    ds_read_b64_tr_b16 a[100:101], v10 offset:0
    ds_read_b64_tr_b16 a[102:103], v10 offset:2048
    ds_read_b64_tr_b16 a[104:105], v9 offset:512
    ds_read_b64_tr_b16 a[106:107], v9 offset:2560
    ds_read_b64_tr_b16 a[108:109], v10 offset:512
    ds_read_b64_tr_b16 a[110:111], v10 offset:2560
    s_waitcnt lgkmcnt(8)
    s_add_u32 m0, s53, 67584
    s_mov_b32 s54, s14
    buffer_load_dwordx4 v4, s[32:35], s54 offen offset:0 lds
    s_add_u32 s54, s54, 7168
    buffer_load_dwordx4 v4, s[32:35], s54 offen offset:1024 lds
    s_add_u32 s54, s54, 7168
    buffer_load_dwordx4 v4, s[32:35], s54 offen offset:2048 lds
    s_add_u32 s54, s54, 7168
    buffer_load_dwordx4 v4, s[32:35], s54 offen offset:3072 lds
    s_add_u32 s14, s14, 32768
    s_and_b32 s14, s14, 0x7ffff
    s_add_u32 s55, s53, 84480
    v_add_u32 v9, s55, v3
    v_add_u32 v10, s55, v14
    s_waitcnt vmcnt(29)
    ds_read_b64_tr_b16 a[176:177], v9 offset:0
    ds_read_b64_tr_b16 a[178:179], v9 offset:2048
    ds_read_b64_tr_b16 a[180:181], v10 offset:0
    ds_read_b64_tr_b16 a[182:183], v10 offset:2048
    ds_read_b64_tr_b16 a[184:185], v9 offset:512
    ds_read_b64_tr_b16 a[186:187], v9 offset:2560
    ds_read_b64_tr_b16 a[188:189], v10 offset:512
    ds_read_b64_tr_b16 a[190:191], v10 offset:2560
    s_waitcnt lgkmcnt(8)
    s_add_u32 m0, s90, 0
    s_mov_b32 s54, s14
    buffer_load_dwordx4 v4, s[32:35], s54 offen offset:0 lds
    s_add_u32 s54, s54, 7168
    buffer_load_dwordx4 v4, s[32:35], s54 offen offset:1024 lds
    s_add_u32 s54, s54, 7168
    buffer_load_dwordx4 v4, s[32:35], s54 offen offset:2048 lds
    s_add_u32 s54, s54, 7168
    buffer_load_dwordx4 v4, s[32:35], s54 offen offset:3072 lds
    s_add_u32 s14, s14, 32768
    s_and_b32 s14, s14, 0x7ffff
    s_cmp_lg_u32 s40, 0
    s_cbranch_scc1 L_poll2_ok
    s_waitcnt vmcnt(8)
    v_cmp_ne_u64 vcc, s[92:93], v[172:173]
    s_cbranch_vccz L_poll2_ok
    s_mov_b32 s13, 0x100000
L_poll2:
    buffer_load_dwordx2 v[172:173], v7, s[36:39], 0 offen sc1
    s_waitcnt vmcnt(0)
    v_cmp_ne_u64 vcc, s[92:93], v[172:173]
    s_cbranch_vccz L_poll2_ok
    s_sleep 2
    s_sub_u32 s13, s13, 1
    s_cbranch_scc0 L_poll2
L_poll2_ok:
    s_barrier
    s_add_u32 s46, s99, 1024
    s_and_b32 s46, s46, 0x3fff
    buffer_load_dwordx4 v[64:67], v160, s[16:19], s99 offen sc1
    buffer_load_dwordx4 v[76:79], v160, s[16:19], s46 offen sc1
    buffer_load_dwordx4 v[68:71], v161, s[16:19], s99 offen sc1
    buffer_load_dwordx4 v[80:83], v161, s[16:19], s46 offen sc1
    buffer_load_dwordx4 v[72:75], v162, s[16:19], s99 offen sc1
    buffer_load_dwordx4 v[84:87], v162, s[16:19], s46 offen sc1
    s_add_u32 s99, s46, 1024
    s_and_b32 s99, s99, 0x3fff
    s_add_u32 s46, s99, 1024
    s_and_b32 s46, s46, 0x3fff
    buffer_load_dwordx4 v[88:91], v160, s[16:19], s99 offen sc1
    buffer_load_dwordx4 v[100:103], v160, s[16:19], s46 offen sc1
    buffer_load_dwordx4 v[92:95], v161, s[16:19], s99 offen sc1
    buffer_load_dwordx4 v[104:107], v161, s[16:19], s46 offen sc1
    buffer_load_dwordx4 v[96:99], v162, s[16:19], s99 offen sc1
    buffer_load_dwordx4 v[108:111], v162, s[16:19], s46 offen sc1
    s_add_u32 s99, s46, 1024
    s_and_b32 s99, s99, 0x3fff
    s_add_u32 s46, s99, 1024
    s_and_b32 s46, s46, 0x3fff
    s_mul_i32 s48, s2, 12672
    s_add_u32 s48, s48, 17301504
    s_xor_b32 s12, s2, 1
    s_mul_i32 s41, s12, 12672
    s_add_u32 s41, s41, 17301504
    s_mul_i32 s12, s12, 1152
    s_add_u32 s12, s12, 16777216
    s_cmp_eq_u32 s40, 0
    s_cselect_b32 s56, s12, 67108864
    v_mov_b32 v170, s56
    s_waitcnt vmcnt(10)
    v_mfma_f32_16x16x32_bf16 v[16:19], a[0:3], v[64:67], 0
    s_add_u32 s55, s53, 0
    v_add_u32 v9, s55, v3
    v_add_u32 v10, s55, v14
    v_mfma_f32_16x16x32_bf16 v[16:19], a[16:19], v[76:79], v[16:19]
    ds_read_b64_tr_b16 a[192:193], v9 offset:0
    v_mfma_f32_16x16x32_bf16 v[20:23], a[4:7], v[64:67], 0
    ds_read_b64_tr_b16 a[194:195], v9 offset:2048
    v_mfma_f32_16x16x32_bf16 v[20:23], a[20:23], v[76:79], v[20:23]
    ds_read_b64_tr_b16 a[196:197], v10 offset:0
    v_mfma_f32_16x16x32_bf16 v[24:27], a[8:11], v[64:67], 0
    ds_read_b64_tr_b16 a[198:199], v10 offset:2048
    v_mfma_f32_16x16x32_bf16 v[24:27], a[24:27], v[76:79], v[24:27]
    ds_read_b64_tr_b16 a[200:201], v9 offset:512
    v_mfma_f32_16x16x32_bf16 v[28:31], a[12:15], v[64:67], 0
    v_mfma_f32_16x16x32_bf16 v[28:31], a[28:31], v[76:79], v[28:31]
    buffer_load_dwordx4 v[64:67], v160, s[16:19], s99 offen sc1
    buffer_load_dwordx4 v[76:79], v160, s[16:19], s46 offen sc1
    s_waitcnt vmcnt(10)
    v_mfma_f32_16x16x32_bf16 v[32:35], a[0:3], v[68:71], 0
    ds_read_b64_tr_b16 a[202:203], v9 offset:2560
    v_mfma_f32_16x16x32_bf16 v[32:35], a[16:19], v[80:83], v[32:35]
    ds_read_b64_tr_b16 a[204:205], v10 offset:512
    v_mfma_f32_16x16x32_bf16 v[36:39], a[4:7], v[68:71], 0
    ds_read_b64_tr_b16 a[206:207], v10 offset:2560
    v_mfma_f32_16x16x32_bf16 v[36:39], a[20:23], v[80:83], v[36:39]
    s_add_u32 s55, s90, 4096
    v_add_u32 v9, s55, v3
    v_add_u32 v10, s55, v14
    v_mfma_f32_16x16x32_bf16 v[40:43], a[8:11], v[68:71], 0
    ds_read_b64_tr_b16 a[208:209], v9 offset:0
    v_mfma_f32_16x16x32_bf16 v[40:43], a[24:27], v[80:83], v[40:43]
    ds_read_b64_tr_b16 a[210:211], v9 offset:2048
    v_mfma_f32_16x16x32_bf16 v[44:47], a[12:15], v[68:71], 0
    v_mfma_f32_16x16x32_bf16 v[44:47], a[28:31], v[80:83], v[44:47]
    buffer_load_dwordx4 v[68:71], v161, s[16:19], s99 offen sc1
    buffer_load_dwordx4 v[80:83], v161, s[16:19], s46 offen sc1
    s_waitcnt vmcnt(10)
    v_mfma_f32_16x16x32_bf16 v[48:51], a[0:3], v[72:75], 0
    ds_read_b64_tr_b16 a[212:213], v10 offset:0
    v_mfma_f32_16x16x32_bf16 v[48:51], a[16:19], v[84:87], v[48:51]
    ds_read_b64_tr_b16 a[214:215], v10 offset:2048
    v_mfma_f32_16x16x32_bf16 v[52:55], a[4:7], v[72:75], 0
    ds_read_b64_tr_b16 a[216:217], v9 offset:512
    v_mfma_f32_16x16x32_bf16 v[52:55], a[20:23], v[84:87], v[52:55]
    ds_read_b64_tr_b16 a[218:219], v9 offset:2560
    v_mfma_f32_16x16x32_bf16 v[56:59], a[8:11], v[72:75], 0
    ds_read_b64_tr_b16 a[220:221], v10 offset:512
    v_mfma_f32_16x16x32_bf16 v[56:59], a[24:27], v[84:87], v[56:59]
    ds_read_b64_tr_b16 a[222:223], v10 offset:2560
    v_mfma_f32_16x16x32_bf16 v[60:63], a[12:15], v[72:75], 0
    v_mfma_f32_16x16x32_bf16 v[60:63], a[28:31], v[84:87], v[60:63]
    buffer_load_dwordx4 v[72:75], v162, s[16:19], s99 offen sc1
    buffer_load_dwordx4 v[84:87], v162, s[16:19], s46 offen sc1
    s_add_u32 s99, s46, 1024
    s_and_b32 s99, s99, 0x3fff
    s_add_u32 s46, s99, 1024
    s_and_b32 s46, s46, 0x3fff
    s_waitcnt vmcnt(10)
    v_mfma_f32_16x16x32_bf16 v[16:19], a[32:35], v[88:91], v[16:19]
    s_add_u32 s55, s90, 8192
    v_add_u32 v9, s55, v3
    v_add_u32 v10, s55, v14
    v_mfma_f32_16x16x32_bf16 v[16:19], a[48:51], v[100:103], v[16:19]
    ds_read_b64_tr_b16 a[224:225], v9 offset:0
    v_mfma_f32_16x16x32_bf16 v[20:23], a[36:39], v[88:91], v[20:23]
    ds_read_b64_tr_b16 a[226:227], v9 offset:2048
    v_mfma_f32_16x16x32_bf16 v[20:23], a[52:55], v[100:103], v[20:23]
    ds_read_b64_tr_b16 a[228:229], v10 offset:0
    v_mfma_f32_16x16x32_bf16 v[24:27], a[40:43], v[88:91], v[24:27]
    ds_read_b64_tr_b16 a[230:231], v10 offset:2048
    v_mfma_f32_16x16x32_bf16 v[24:27], a[56:59], v[100:103], v[24:27]
    ds_read_b64_tr_b16 a[232:233], v9 offset:512
    v_mfma_f32_16x16x32_bf16 v[28:31], a[44:47], v[88:91], v[28:31]
    v_mfma_f32_16x16x32_bf16 v[28:31], a[60:63], v[100:103], v[28:31]
    buffer_load_dwordx4 v[88:91], v160, s[16:19], s99 offen sc1
    buffer_load_dwordx4 v[100:103], v160, s[16:19], s46 offen sc1
    s_waitcnt vmcnt(10)
    v_mfma_f32_16x16x32_bf16 v[32:35], a[32:35], v[92:95], v[32:35]
    ds_read_b64_tr_b16 a[234:235], v9 offset:2560
    v_mfma_f32_16x16x32_bf16 v[32:35], a[48:51], v[104:107], v[32:35]
    ds_read_b64_tr_b16 a[236:237], v10 offset:512
    v_mfma_f32_16x16x32_bf16 v[36:39], a[36:39], v[92:95], v[36:39]
    ds_read_b64_tr_b16 a[238:239], v10 offset:2560
    v_mfma_f32_16x16x32_bf16 v[36:39], a[52:55], v[104:107], v[36:39]
    s_add_u32 s55, s53, 16896
    v_add_u32 v9, s55, v3
    v_add_u32 v10, s55, v14
    v_mfma_f32_16x16x32_bf16 v[40:43], a[40:43], v[92:95], v[40:43]
    ds_read_b64_tr_b16 a[112:113], v9 offset:0
    v_mfma_f32_16x16x32_bf16 v[40:43], a[56:59], v[104:107], v[40:43]
    ds_read_b64_tr_b16 a[114:115], v9 offset:2048
    v_mfma_f32_16x16x32_bf16 v[44:47], a[44:47], v[92:95], v[44:47]
    v_mfma_f32_16x16x32_bf16 v[44:47], a[60:63], v[104:107], v[44:47]
    buffer_load_dwordx4 v[92:95], v161, s[16:19], s99 offen sc1
    buffer_load_dwordx4 v[104:107], v161, s[16:19], s46 offen sc1
    s_waitcnt vmcnt(10)
    v_mfma_f32_16x16x32_bf16 v[48:51], a[32:35], v[96:99], v[48:51]
    ds_read_b64_tr_b16 a[116:117], v10 offset:0
    v_mfma_f32_16x16x32_bf16 v[48:51], a[48:51], v[108:111], v[48:51]
    ds_read_b64_tr_b16 a[118:119], v10 offset:2048
    v_mfma_f32_16x16x32_bf16 v[52:55], a[36:39], v[96:99], v[52:55]
    ds_read_b64_tr_b16 a[120:121], v9 offset:512
    v_mfma_f32_16x16x32_bf16 v[52:55], a[52:55], v[108:111], v[52:55]
    ds_read_b64_tr_b16 a[122:123], v9 offset:2560
    v_mfma_f32_16x16x32_bf16 v[56:59], a[40:43], v[96:99], v[56:59]
    ds_read_b64_tr_b16 a[124:125], v10 offset:512
    v_mfma_f32_16x16x32_bf16 v[56:59], a[56:59], v[108:111], v[56:59]
    ds_read_b64_tr_b16 a[126:127], v10 offset:2560
    v_mfma_f32_16x16x32_bf16 v[60:63], a[44:47], v[96:99], v[60:63]
    v_mfma_f32_16x16x32_bf16 v[60:63], a[60:63], v[108:111], v[60:63]
    buffer_load_dwordx4 v[96:99], v162, s[16:19], s99 offen sc1
    buffer_load_dwordx4 v[108:111], v162, s[16:19], s46 offen sc1
    s_add_u32 s99, s46, 1024
    s_and_b32 s99, s99, 0x3fff
    s_add_u32 s46, s99, 1024
    s_and_b32 s46, s46, 0x3fff
    s_waitcnt vmcnt(10)
    v_mfma_f32_16x16x32_bf16 v[16:19], a[64:67], v[64:67], v[16:19]
    s_add_u32 s55, s53, 33792
    v_add_u32 v9, s55, v3
    v_add_u32 v10, s55, v14
    v_mfma_f32_16x16x32_bf16 v[16:19], a[80:83], v[76:79], v[16:19]
    ds_read_b64_tr_b16 a[128:129], v9 offset:0
    v_mfma_f32_16x16x32_bf16 v[20:23], a[68:71], v[64:67], v[20:23]
    ds_read_b64_tr_b16 a[130:131], v9 offset:2048
    v_mfma_f32_16x16x32_bf16 v[20:23], a[84:87], v[76:79], v[20:23]
    ds_read_b64_tr_b16 a[132:133], v10 offset:0
    v_mfma_f32_16x16x32_bf16 v[24:27], a[72:75], v[64:67], v[24:27]
    ds_read_b64_tr_b16 a[134:135], v10 offset:2048
    v_mfma_f32_16x16x32_bf16 v[24:27], a[88:91], v[76:79], v[24:27]
    ds_read_b64_tr_b16 a[136:137], v9 offset:512
    v_mfma_f32_16x16x32_bf16 v[28:31], a[76:79], v[64:67], v[28:31]
    v_mfma_f32_16x16x32_bf16 v[28:31], a[92:95], v[76:79], v[28:31]
    buffer_load_dwordx4 v[64:67], v160, s[16:19], s99 offen sc1
    buffer_load_dwordx4 v[76:79], v160, s[16:19], s46 offen sc1
    s_waitcnt vmcnt(10)
    v_mfma_f32_16x16x32_bf16 v[32:35], a[64:67], v[68:71], v[32:35]
    ds_read_b64_tr_b16 a[138:139], v9 offset:2560
    v_mfma_f32_16x16x32_bf16 v[32:35], a[80:83], v[80:83], v[32:35]
    ds_read_b64_tr_b16 a[140:141], v10 offset:512
    v_mfma_f32_16x16x32_bf16 v[36:39], a[68:71], v[68:71], v[36:39]
    ds_read_b64_tr_b16 a[142:143], v10 offset:2560
    v_mfma_f32_16x16x32_bf16 v[36:39], a[84:87], v[80:83], v[36:39]
    s_add_u32 s55, s53, 50688
    v_add_u32 v9, s55, v3
    v_add_u32 v10, s55, v14
    v_mfma_f32_16x16x32_bf16 v[40:43], a[72:75], v[68:71], v[40:43]
    ds_read_b64_tr_b16 a[144:145], v9 offset:0
    v_mfma_f32_16x16x32_bf16 v[40:43], a[88:91], v[80:83], v[40:43]
    ds_read_b64_tr_b16 a[146:147], v9 offset:2048
    v_mfma_f32_16x16x32_bf16 v[44:47], a[76:79], v[68:71], v[44:47]
    v_mfma_f32_16x16x32_bf16 v[44:47], a[92:95], v[80:83], v[44:47]
    buffer_load_dwordx4 v[68:71], v161, s[16:19], s99 offen sc1
    buffer_load_dwordx4 v[80:83], v161, s[16:19], s46 offen sc1
    s_waitcnt vmcnt(10)
    v_mfma_f32_16x16x32_bf16 v[48:51], a[64:67], v[72:75], v[48:51]
    ds_read_b64_tr_b16 a[148:149], v10 offset:0
    v_mfma_f32_16x16x32_bf16 v[48:51], a[80:83], v[84:87], v[48:51]
    ds_read_b64_tr_b16 a[150:151], v10 offset:2048
    v_mfma_f32_16x16x32_bf16 v[52:55], a[68:71], v[72:75], v[52:55]
    ds_read_b64_tr_b16 a[152:153], v9 offset:512
    v_mfma_f32_16x16x32_bf16 v[52:55], a[84:87], v[84:87], v[52:55]
    ds_read_b64_tr_b16 a[154:155], v9 offset:2560
    v_mfma_f32_16x16x32_bf16 v[56:59], a[72:75], v[72:75], v[56:59]
    ds_read_b64_tr_b16 a[156:157], v10 offset:512
    v_mfma_f32_16x16x32_bf16 v[56:59], a[88:91], v[84:87], v[56:59]
    ds_read_b64_tr_b16 a[158:159], v10 offset:2560
    v_mfma_f32_16x16x32_bf16 v[60:63], a[76:79], v[72:75], v[60:63]
    v_mfma_f32_16x16x32_bf16 v[60:63], a[92:95], v[84:87], v[60:63]
    buffer_load_dwordx4 v[72:75], v162, s[16:19], s99 offen sc1
    buffer_load_dwordx4 v[84:87], v162, s[16:19], s46 offen sc1
    s_add_u32 s99, s46, 1024
    s_and_b32 s99, s99, 0x3fff
    s_add_u32 s46, s99, 1024
    s_and_b32 s46, s46, 0x3fff
    s_waitcnt vmcnt(10) lgkmcnt(15)
    v_mfma_f32_16x16x32_bf16 v[16:19], a[96:99], v[88:91], v[16:19]
    s_add_u32 s55, s53, 67584
    v_add_u32 v9, s55, v3
    v_add_u32 v10, s55, v14
    v_mfma_f32_16x16x32_bf16 v[16:19], a[176:179], v[100:103], v[16:19]
    ds_read_b64_tr_b16 a[160:161], v9 offset:0
    v_mfma_f32_16x16x32_bf16 v[20:23], a[100:103], v[88:91], v[20:23]
    ds_read_b64_tr_b16 a[162:163], v9 offset:2048
    v_mfma_f32_16x16x32_bf16 v[20:23], a[180:183], v[100:103], v[20:23]
    ds_read_b64_tr_b16 a[164:165], v10 offset:0
    v_mfma_f32_16x16x32_bf16 v[24:27], a[104:107], v[88:91], v[24:27]
    ds_read_b64_tr_b16 a[166:167], v10 offset:2048
    v_mfma_f32_16x16x32_bf16 v[24:27], a[184:187], v[100:103], v[24:27]
    ds_read_b64_tr_b16 a[168:169], v9 offset:512
    v_mfma_f32_16x16x32_bf16 v[28:31], a[108:111], v[88:91], v[28:31]
    v_mfma_f32_16x16x32_bf16 v[28:31], a[188:191], v[100:103], v[28:31]
    buffer_load_dwordx4 v[88:91], v160, s[16:19], s99 offen sc1
    buffer_load_dwordx4 v[100:103], v160, s[16:19], s46 offen sc1
    s_waitcnt vmcnt(10)
    v_mfma_f32_16x16x32_bf16 v[32:35], a[96:99], v[92:95], v[32:35]
    ds_read_b64_tr_b16 a[170:171], v9 offset:2560
    v_mfma_f32_16x16x32_bf16 v[32:35], a[176:179], v[104:107], v[32:35]
    ds_read_b64_tr_b16 a[172:173], v10 offset:512
    v_mfma_f32_16x16x32_bf16 v[36:39], a[100:103], v[92:95], v[36:39]
    ds_read_b64_tr_b16 a[174:175], v10 offset:2560
    v_mfma_f32_16x16x32_bf16 v[36:39], a[180:183], v[104:107], v[36:39]
    s_add_u32 s55, s90, 0
    v_add_u32 v9, s55, v3
    v_add_u32 v10, s55, v14
    v_mfma_f32_16x16x32_bf16 v[40:43], a[104:107], v[92:95], v[40:43]
    ds_read_b64_tr_b16 a[240:241], v9 offset:0
    v_mfma_f32_16x16x32_bf16 v[40:43], a[184:187], v[104:107], v[40:43]
    ds_read_b64_tr_b16 a[242:243], v9 offset:2048
    v_mfma_f32_16x16x32_bf16 v[44:47], a[108:111], v[92:95], v[44:47]
    v_mfma_f32_16x16x32_bf16 v[44:47], a[188:191], v[104:107], v[44:47]
    buffer_load_dwordx4 v[92:95], v161, s[16:19], s99 offen sc1
    buffer_load_dwordx4 v[104:107], v161, s[16:19], s46 offen sc1
    s_waitcnt vmcnt(10)
    v_mfma_f32_16x16x32_bf16 v[48:51], a[96:99], v[96:99], v[48:51]
    ds_read_b64_tr_b16 a[244:245], v10 offset:0
    v_mfma_f32_16x16x32_bf16 v[48:51], a[176:179], v[108:111], v[48:51]
    ds_read_b64_tr_b16 a[246:247], v10 offset:2048
    v_mfma_f32_16x16x32_bf16 v[52:55], a[100:103], v[96:99], v[52:55]
    ds_read_b64_tr_b16 a[248:249], v9 offset:512
    v_mfma_f32_16x16x32_bf16 v[52:55], a[180:183], v[108:111], v[52:55]
    ds_read_b64_tr_b16 a[250:251], v9 offset:2560
    v_mfma_f32_16x16x32_bf16 v[56:59], a[104:107], v[96:99], v[56:59]
    ds_read_b64_tr_b16 a[252:253], v10 offset:512
    v_mfma_f32_16x16x32_bf16 v[56:59], a[184:187], v[108:111], v[56:59]
    ds_read_b64_tr_b16 a[254:255], v10 offset:2560
    v_mfma_f32_16x16x32_bf16 v[60:63], a[108:111], v[96:99], v[60:63]
    v_mfma_f32_16x16x32_bf16 v[60:63], a[188:191], v[108:111], v[60:63]
    buffer_load_dwordx4 v[96:99], v162, s[16:19], s99 offen sc1
    buffer_load_dwordx4 v[108:111], v162, s[16:19], s46 offen sc1
    s_add_u32 s99, s46, 1024
    s_and_b32 s99, s99, 0x3fff
    s_add_u32 s46, s99, 1024
    s_and_b32 s46, s46, 0x3fff
    s_waitcnt vmcnt(10)
    v_mfma_f32_16x16x32_bf16 v[16:19], a[192:195], v[64:67], v[16:19]
    v_mfma_f32_16x16x32_bf16 v[16:19], a[208:211], v[76:79], v[16:19]
    v_mfma_f32_16x16x32_bf16 v[20:23], a[196:199], v[64:67], v[20:23]
    v_mfma_f32_16x16x32_bf16 v[20:23], a[212:215], v[76:79], v[20:23]
    v_mfma_f32_16x16x32_bf16 v[24:27], a[200:203], v[64:67], v[24:27]
    v_mfma_f32_16x16x32_bf16 v[24:27], a[216:219], v[76:79], v[24:27]
    v_mfma_f32_16x16x32_bf16 v[28:31], a[204:207], v[64:67], v[28:31]
    v_mfma_f32_16x16x32_bf16 v[28:31], a[220:223], v[76:79], v[28:31]
    buffer_load_dwordx4 v[64:67], v160, s[16:19], s99 offen sc1
    buffer_load_dwordx4 v[76:79], v160, s[16:19], s46 offen sc1
    s_waitcnt vmcnt(10)
    v_mfma_f32_16x16x32_bf16 v[32:35], a[192:195], v[68:71], v[32:35]
    v_mfma_f32_16x16x32_bf16 v[32:35], a[208:211], v[80:83], v[32:35]
    v_mfma_f32_16x16x32_bf16 v[36:39], a[196:199], v[68:71], v[36:39]
    v_mfma_f32_16x16x32_bf16 v[36:39], a[212:215], v[80:83], v[36:39]
    v_mfma_f32_16x16x32_bf16 v[40:43], a[200:203], v[68:71], v[40:43]
    v_mfma_f32_16x16x32_bf16 v[40:43], a[216:219], v[80:83], v[40:43]
    v_mfma_f32_16x16x32_bf16 v[44:47], a[204:207], v[68:71], v[44:47]
    v_mfma_f32_16x16x32_bf16 v[44:47], a[220:223], v[80:83], v[44:47]
    buffer_load_dwordx4 v[68:71], v161, s[16:19], s99 offen sc1
    buffer_load_dwordx4 v[80:83], v161, s[16:19], s46 offen sc1
    s_waitcnt vmcnt(10)
    v_mfma_f32_16x16x32_bf16 v[48:51], a[192:195], v[72:75], v[48:51]
    v_mfma_f32_16x16x32_bf16 v[48:51], a[208:211], v[84:87], v[48:51]
    v_mfma_f32_16x16x32_bf16 v[52:55], a[196:199], v[72:75], v[52:55]
    v_mfma_f32_16x16x32_bf16 v[52:55], a[212:215], v[84:87], v[52:55]
    v_mfma_f32_16x16x32_bf16 v[56:59], a[200:203], v[72:75], v[56:59]
    v_mfma_f32_16x16x32_bf16 v[56:59], a[216:219], v[84:87], v[56:59]
    v_mfma_f32_16x16x32_bf16 v[60:63], a[204:207], v[72:75], v[60:63]
    v_mfma_f32_16x16x32_bf16 v[60:63], a[220:223], v[84:87], v[60:63]
    buffer_load_dwordx4 v[72:75], v162, s[16:19], s99 offen sc1
    buffer_load_dwordx4 v[84:87], v162, s[16:19], s46 offen sc1
    s_add_u32 s99, s46, 1024
    s_and_b32 s99, s99, 0x3fff
    s_add_u32 s46, s99, 1024
    s_and_b32 s46, s46, 0x3fff
    s_waitcnt vmcnt(10)
    v_mfma_f32_16x16x32_bf16 v[16:19], a[224:227], v[88:91], v[16:19]
    v_mfma_f32_16x16x32_bf16 v[16:19], a[112:115], v[100:103], v[16:19]
    v_mfma_f32_16x16x32_bf16 v[20:23], a[228:231], v[88:91], v[20:23]
    v_mfma_f32_16x16x32_bf16 v[20:23], a[116:119], v[100:103], v[20:23]
    v_mfma_f32_16x16x32_bf16 v[24:27], a[232:235], v[88:91], v[24:27]
    v_mfma_f32_16x16x32_bf16 v[24:27], a[120:123], v[100:103], v[24:27]
    v_mfma_f32_16x16x32_bf16 v[28:31], a[236:239], v[88:91], v[28:31]
    v_mfma_f32_16x16x32_bf16 v[28:31], a[124:127], v[100:103], v[28:31]
    buffer_load_dwordx4 v[88:91], v160, s[16:19], s99 offen sc1
    buffer_load_dwordx4 v[100:103], v160, s[16:19], s46 offen sc1
    s_waitcnt vmcnt(10)
    v_mfma_f32_16x16x32_bf16 v[32:35], a[224:227], v[92:95], v[32:35]
    v_mfma_f32_16x16x32_bf16 v[32:35], a[112:115], v[104:107], v[32:35]
    v_mfma_f32_16x16x32_bf16 v[36:39], a[228:231], v[92:95], v[36:39]
    v_mfma_f32_16x16x32_bf16 v[36:39], a[116:119], v[104:107], v[36:39]
    v_mfma_f32_16x16x32_bf16 v[40:43], a[232:235], v[92:95], v[40:43]
    v_mfma_f32_16x16x32_bf16 v[40:43], a[120:123], v[104:107], v[40:43]
    v_mfma_f32_16x16x32_bf16 v[44:47], a[236:239], v[92:95], v[44:47]
    v_mfma_f32_16x16x32_bf16 v[44:47], a[124:127], v[104:107], v[44:47]
    buffer_load_dwordx4 v[92:95], v161, s[16:19], s99 offen sc1
    buffer_load_dwordx4 v[104:107], v161, s[16:19], s46 offen sc1
    s_waitcnt vmcnt(10)
    v_mfma_f32_16x16x32_bf16 v[48:51], a[224:227], v[96:99], v[48:51]
    v_mfma_f32_16x16x32_bf16 v[48:51], a[112:115], v[108:111], v[48:51]
    v_mfma_f32_16x16x32_bf16 v[52:55], a[228:231], v[96:99], v[52:55]
    v_mfma_f32_16x16x32_bf16 v[52:55], a[116:119], v[108:111], v[52:55]
    v_mfma_f32_16x16x32_bf16 v[56:59], a[232:235], v[96:99], v[56:59]
    v_mfma_f32_16x16x32_bf16 v[56:59], a[120:123], v[108:111], v[56:59]
    v_mfma_f32_16x16x32_bf16 v[60:63], a[236:239], v[96:99], v[60:63]
    v_mfma_f32_16x16x32_bf16 v[60:63], a[124:127], v[108:111], v[60:63]
    buffer_load_dwordx4 v[96:99], v162, s[16:19], s99 offen sc1
    buffer_load_dwordx4 v[108:111], v162, s[16:19], s46 offen sc1
    s_add_u32 s99, s46, 1024
    s_and_b32 s99, s99, 0x3fff
    s_add_u32 s46, s99, 1024
    s_and_b32 s46, s46, 0x3fff
    s_waitcnt vmcnt(10) lgkmcnt(15)
    v_mfma_f32_16x16x32_bf16 v[16:19], a[128:131], v[64:67], v[16:19]
    v_mfma_f32_16x16x32_bf16 v[16:19], a[144:147], v[76:79], v[16:19]
    v_mfma_f32_16x16x32_bf16 v[20:23], a[132:135], v[64:67], v[20:23]
    v_mfma_f32_16x16x32_bf16 v[20:23], a[148:151], v[76:79], v[20:23]
    v_mfma_f32_16x16x32_bf16 v[24:27], a[136:139], v[64:67], v[24:27]
    v_mfma_f32_16x16x32_bf16 v[24:27], a[152:155], v[76:79], v[24:27]
    v_mfma_f32_16x16x32_bf16 v[28:31], a[140:143], v[64:67], v[28:31]
    v_mfma_f32_16x16x32_bf16 v[28:31], a[156:159], v[76:79], v[28:31]
    buffer_load_dwordx4 v[64:67], v163, s[16:19], s99 offen sc1
    buffer_load_dwordx4 v[76:79], v163, s[16:19], s46 offen sc1
    s_waitcnt vmcnt(10)
    v_mfma_f32_16x16x32_bf16 v[32:35], a[128:131], v[68:71], v[32:35]
    v_mfma_f32_16x16x32_bf16 v[32:35], a[144:147], v[80:83], v[32:35]
    v_mfma_f32_16x16x32_bf16 v[36:39], a[132:135], v[68:71], v[36:39]
    v_mfma_f32_16x16x32_bf16 v[36:39], a[148:151], v[80:83], v[36:39]
    v_mfma_f32_16x16x32_bf16 v[40:43], a[136:139], v[68:71], v[40:43]
    v_mfma_f32_16x16x32_bf16 v[40:43], a[152:155], v[80:83], v[40:43]
    v_mfma_f32_16x16x32_bf16 v[44:47], a[140:143], v[68:71], v[44:47]
    v_mfma_f32_16x16x32_bf16 v[44:47], a[156:159], v[80:83], v[44:47]
    buffer_load_dwordx4 v[68:71], v164, s[16:19], s99 offen sc1
    buffer_load_dwordx4 v[80:83], v164, s[16:19], s46 offen sc1
    s_waitcnt vmcnt(10)
    v_mfma_f32_16x16x32_bf16 v[48:51], a[128:131], v[72:75], v[48:51]
    v_mfma_f32_16x16x32_bf16 v[48:51], a[144:147], v[84:87], v[48:51]
    v_mfma_f32_16x16x32_bf16 v[52:55], a[132:135], v[72:75], v[52:55]
    v_mfma_f32_16x16x32_bf16 v[52:55], a[148:151], v[84:87], v[52:55]
    v_mfma_f32_16x16x32_bf16 v[56:59], a[136:139], v[72:75], v[56:59]
    v_mfma_f32_16x16x32_bf16 v[56:59], a[152:155], v[84:87], v[56:59]
    v_mfma_f32_16x16x32_bf16 v[60:63], a[140:143], v[72:75], v[60:63]
    v_mfma_f32_16x16x32_bf16 v[60:63], a[156:159], v[84:87], v[60:63]
    buffer_load_dwordx4 v[72:75], v165, s[16:19], s99 offen sc1
    buffer_load_dwordx4 v[84:87], v165, s[16:19], s46 offen sc1
    s_add_u32 s99, s46, 1024
    s_and_b32 s99, s99, 0x3fff
    s_add_u32 s46, s99, 1024
    s_and_b32 s46, s46, 0x3fff
    s_waitcnt vmcnt(10) lgkmcnt(0)
    v_mfma_f32_16x16x32_bf16 v[16:19], a[160:163], v[88:91], v[16:19]
    v_mfma_f32_16x16x32_bf16 v[16:19], a[240:243], v[100:103], v[16:19]
    v_mfma_f32_16x16x32_bf16 v[20:23], a[164:167], v[88:91], v[20:23]
    v_mfma_f32_16x16x32_bf16 v[20:23], a[244:247], v[100:103], v[20:23]
    v_mfma_f32_16x16x32_bf16 v[24:27], a[168:171], v[88:91], v[24:27]
    v_mfma_f32_16x16x32_bf16 v[24:27], a[248:251], v[100:103], v[24:27]
    v_mfma_f32_16x16x32_bf16 v[28:31], a[172:175], v[88:91], v[28:31]
    v_mfma_f32_16x16x32_bf16 v[28:31], a[252:255], v[100:103], v[28:31]
    buffer_load_dwordx4 v[88:91], v163, s[16:19], s99 offen sc1
    buffer_load_dwordx4 v[100:103], v163, s[16:19], s46 offen sc1
    s_waitcnt vmcnt(10)
    v_mfma_f32_16x16x32_bf16 v[32:35], a[160:163], v[92:95], v[32:35]
    v_mfma_f32_16x16x32_bf16 v[32:35], a[240:243], v[104:107], v[32:35]
    v_mfma_f32_16x16x32_bf16 v[36:39], a[164:167], v[92:95], v[36:39]
    ds_write_b128 v167, v[16:19] offset:0
    v_mfma_f32_16x16x32_bf16 v[36:39], a[244:247], v[104:107], v[36:39]
    ds_write_b128 v167, v[20:23] offset:1024
    v_mfma_f32_16x16x32_bf16 v[40:43], a[168:171], v[92:95], v[40:43]
    ds_write_b128 v167, v[24:27] offset:2048
    v_mfma_f32_16x16x32_bf16 v[40:43], a[248:251], v[104:107], v[40:43]
    ds_write_b128 v167, v[28:31] offset:3072
    v_mfma_f32_16x16x32_bf16 v[44:47], a[172:175], v[92:95], v[44:47]
    v_mfma_f32_16x16x32_bf16 v[44:47], a[252:255], v[104:107], v[44:47]
    buffer_load_dwordx4 v[92:95], v164, s[16:19], s99 offen sc1
    buffer_load_dwordx4 v[104:107], v164, s[16:19], s46 offen sc1
    s_waitcnt vmcnt(10)
    v_mfma_f32_16x16x32_bf16 v[48:51], a[160:163], v[96:99], v[48:51]
    v_mfma_f32_16x16x32_bf16 v[48:51], a[240:243], v[108:111], v[48:51]
    v_mfma_f32_16x16x32_bf16 v[52:55], a[164:167], v[96:99], v[52:55]
    ds_write_b128 v167, v[32:35] offset:4096
    v_mfma_f32_16x16x32_bf16 v[52:55], a[244:247], v[108:111], v[52:55]
    ds_write_b128 v167, v[36:39] offset:5120
    v_mfma_f32_16x16x32_bf16 v[56:59], a[168:171], v[96:99], v[56:59]
    ds_write_b128 v167, v[40:43] offset:6144
    v_mfma_f32_16x16x32_bf16 v[56:59], a[248:251], v[108:111], v[56:59]
    ds_write_b128 v167, v[44:47] offset:7168
    v_mfma_f32_16x16x32_bf16 v[60:63], a[172:175], v[96:99], v[60:63]
    v_mfma_f32_16x16x32_bf16 v[60:63], a[252:255], v[108:111], v[60:63]
    buffer_load_dwordx4 v[96:99], v165, s[16:19], s99 offen sc1
    buffer_load_dwordx4 v[108:111], v165, s[16:19], s46 offen sc1
    s_add_u32 s99, s46, 1024
    s_and_b32 s99, s99, 0x3fff
    s_add_u32 s46, s99, 1024
    s_and_b32 s46, s46, 0x3fff
    s_waitcnt vmcnt(10)
    v_mfma_f32_16x16x32_bf16 v[112:115], a[0:3], v[64:67], 0
    v_mfma_f32_16x16x32_bf16 v[112:115], a[16:19], v[76:79], v[112:115]
    v_mfma_f32_16x16x32_bf16 v[116:119], a[4:7], v[64:67], 0
    v_mfma_f32_16x16x32_bf16 v[116:119], a[20:23], v[76:79], v[116:119]
    ds_write_b128 v167, v[48:51] offset:8192
    v_mfma_f32_16x16x32_bf16 v[120:123], a[8:11], v[64:67], 0
    ds_write_b128 v167, v[52:55] offset:9216
    v_mfma_f32_16x16x32_bf16 v[120:123], a[24:27], v[76:79], v[120:123]
    ds_write_b128 v167, v[56:59] offset:10240
    v_mfma_f32_16x16x32_bf16 v[124:127], a[12:15], v[64:67], 0
    v_mfma_f32_16x16x32_bf16 v[124:127], a[28:31], v[76:79], v[124:127]
    buffer_load_dwordx4 v[64:67], v163, s[16:19], s99 offen sc1
    buffer_load_dwordx4 v[76:79], v163, s[16:19], s46 offen sc1
    s_waitcnt vmcnt(10)
    v_mfma_f32_16x16x32_bf16 v[128:131], a[0:3], v[68:71], 0
    ds_write_b128 v167, v[60:63] offset:11264
    v_mfma_f32_16x16x32_bf16 v[128:131], a[16:19], v[80:83], v[128:131]
    v_mfma_f32_16x16x32_bf16 v[132:135], a[4:7], v[68:71], 0
    v_mfma_f32_16x16x32_bf16 v[132:135], a[20:23], v[80:83], v[132:135]
    v_mfma_f32_16x16x32_bf16 v[136:139], a[8:11], v[68:71], 0
    v_mfma_f32_16x16x32_bf16 v[136:139], a[24:27], v[80:83], v[136:139]
    s_waitcnt lgkmcnt(0)
    s_barrier
    v_mfma_f32_16x16x32_bf16 v[140:143], a[12:15], v[68:71], 0
    v_mfma_f32_16x16x32_bf16 v[140:143], a[28:31], v[80:83], v[140:143]
    buffer_load_dwordx4 v[68:71], v164, s[16:19], s99 offen sc1
    buffer_load_dwordx4 v[80:83], v164, s[16:19], s46 offen sc1
    s_waitcnt vmcnt(10)
    v_mfma_f32_16x16x32_bf16 v[144:147], a[0:3], v[72:75], 0
    ds_read_b128 v[176:179], v168 offset:0
    ds_read_b128 v[180:183], v168 offset:15360
    v_mfma_f32_16x16x32_bf16 v[144:147], a[16:19], v[84:87], v[144:147]
    ds_read_b128 v[184:187], v168 offset:30720
    ds_read_b128 v[188:191], v168 offset:46080
    v_mfma_f32_16x16x32_bf16 v[148:151], a[4:7], v[72:75], 0
    ds_read_b128 v[192:195], v168 offset:4096
    ds_read_b128 v[196:199], v168 offset:19456
    v_mfma_f32_16x16x32_bf16 v[148:151], a[20:23], v[84:87], v[148:151]
    ds_read_b128 v[200:203], v168 offset:34816
    ds_read_b128 v[204:207], v168 offset:50176
    v_mfma_f32_16x16x32_bf16 v[152:155], a[8:11], v[72:75], 0
    ds_read_b128 v[208:211], v168 offset:8192
    ds_read_b128 v[212:215], v168 offset:23552
    v_mfma_f32_16x16x32_bf16 v[152:155], a[24:27], v[84:87], v[152:155]
    ds_read_b128 v[216:219], v168 offset:38912
    ds_read_b128 v[220:223], v168 offset:54272
    v_mfma_f32_16x16x32_bf16 v[156:159], a[12:15], v[72:75], 0
    v_mfma_f32_16x16x32_bf16 v[156:159], a[28:31], v[84:87], v[156:159]
    buffer_load_dwordx4 v[72:75], v165, s[16:19], s99 offen sc1
    buffer_load_dwordx4 v[84:87], v165, s[16:19], s46 offen sc1
    s_add_u32 s99, s46, 1024
    s_and_b32 s99, s99, 0x3fff
    s_add_u32 s46, s99, 1024
    s_and_b32 s46, s46, 0x3fff
    s_waitcnt vmcnt(10)
    v_mfma_f32_16x16x32_bf16 v[112:115], a[32:35], v[88:91], v[112:115]
    s_waitcnt lgkmcnt(8)
    v_add_f32 v176, v176, v180
    v_add_f32 v184, v184, v188
    v_mfma_f32_16x16x32_bf16 v[112:115], a[48:51], v[100:103], v[112:115]
    v_add_f32 v177, v177, v181
    v_add_f32 v185, v185, v189
    v_add_f32 v178, v178, v182
    v_mfma_f32_16x16x32_bf16 v[116:119], a[36:39], v[88:91], v[116:119]
    v_add_f32 v186, v186, v190
    v_add_f32 v179, v179, v183
    v_add_f32 v187, v187, v191
    v_mfma_f32_16x16x32_bf16 v[116:119], a[52:55], v[100:103], v[116:119]
    v_add_f32 v176, v176, v184
    v_add_f32 v177, v177, v185
    v_add_f32 v178, v178, v186
    v_mfma_f32_16x16x32_bf16 v[120:123], a[40:43], v[88:91], v[120:123]
    v_add_f32 v179, v179, v187
    buffer_store_dwordx4 v[176:179], v166, s[36:39], s48 offen offset:0 sc1
    s_waitcnt lgkmcnt(4)
    v_mfma_f32_16x16x32_bf16 v[120:123], a[56:59], v[100:103], v[120:123]
    v_add_f32 v192, v192, v196
    v_add_f32 v200, v200, v204
    v_add_f32 v193, v193, v197
    v_mfma_f32_16x16x32_bf16 v[124:127], a[44:47], v[88:91], v[124:127]
    v_mfma_f32_16x16x32_bf16 v[124:127], a[60:63], v[100:103], v[124:127]
    buffer_load_dwordx4 v[88:91], v163, s[16:19], s99 offen sc1
    buffer_load_dwordx4 v[100:103], v163, s[16:19], s46 offen sc1
    s_waitcnt vmcnt(11)
    v_mfma_f32_16x16x32_bf16 v[128:131], a[32:35], v[92:95], v[128:131]
    v_add_f32 v201, v201, v205
    v_add_f32 v194, v194, v198
    v_add_f32 v202, v202, v206
    v_mfma_f32_16x16x32_bf16 v[128:131], a[48:51], v[104:107], v[128:131]
    v_add_f32 v195, v195, v199
    v_add_f32 v203, v203, v207
    v_add_f32 v192, v192, v200
    v_mfma_f32_16x16x32_bf16 v[132:135], a[36:39], v[92:95], v[132:135]
    v_add_f32 v193, v193, v201
    v_add_f32 v194, v194, v202
    v_add_f32 v195, v195, v203
    v_mfma_f32_16x16x32_bf16 v[132:135], a[52:55], v[104:107], v[132:135]
    buffer_store_dwordx4 v[192:195], v166, s[36:39], s48 offen offset:1024 sc1
    s_waitcnt lgkmcnt(0)
    v_add_f32 v208, v208, v212
    v_mfma_f32_16x16x32_bf16 v[136:139], a[40:43], v[92:95], v[136:139]
    v_add_f32 v216, v216, v220
    v_add_f32 v209, v209, v213
    v_add_f32 v217, v217, v221
    v_mfma_f32_16x16x32_bf16 v[136:139], a[56:59], v[104:107], v[136:139]
    v_add_f32 v210, v210, v214
    v_add_f32 v218, v218, v222
    v_add_f32 v211, v211, v215
    v_mfma_f32_16x16x32_bf16 v[140:143], a[44:47], v[92:95], v[140:143]
    v_mfma_f32_16x16x32_bf16 v[140:143], a[60:63], v[104:107], v[140:143]
    buffer_load_dwordx4 v[92:95], v164, s[16:19], s99 offen sc1
    buffer_load_dwordx4 v[104:107], v164, s[16:19], s46 offen sc1
    s_waitcnt vmcnt(12)
    v_mfma_f32_16x16x32_bf16 v[144:147], a[32:35], v[96:99], v[144:147]
    v_add_f32 v219, v219, v223
    v_add_f32 v208, v208, v216
    v_add_f32 v209, v209, v217
    v_mfma_f32_16x16x32_bf16 v[144:147], a[48:51], v[108:111], v[144:147]
    v_add_f32 v210, v210, v218
    v_add_f32 v211, v211, v219
    buffer_store_dwordx4 v[208:211], v166, s[36:39], s48 offen offset:2048 sc1
    v_mfma_f32_16x16x32_bf16 v[148:151], a[36:39], v[96:99], v[148:151]
    v_mfma_f32_16x16x32_bf16 v[148:151], a[52:55], v[108:111], v[148:151]
    v_mfma_f32_16x16x32_bf16 v[152:155], a[40:43], v[96:99], v[152:155]
    v_mfma_f32_16x16x32_bf16 v[152:155], a[56:59], v[108:111], v[152:155]
    v_mfma_f32_16x16x32_bf16 v[156:159], a[44:47], v[96:99], v[156:159]
    v_mfma_f32_16x16x32_bf16 v[156:159], a[60:63], v[108:111], v[156:159]
    buffer_load_dwordx4 v[96:99], v165, s[16:19], s99 offen sc1
    buffer_load_dwordx4 v[108:111], v165, s[16:19], s46 offen sc1
    s_add_u32 s99, s46, 1024
    s_and_b32 s99, s99, 0x3fff
    s_add_u32 s46, s99, 1024
    s_and_b32 s46, s46, 0x3fff
    s_waitcnt vmcnt(13)
    v_mfma_f32_16x16x32_bf16 v[112:115], a[64:67], v[64:67], v[112:115]
    v_mfma_f32_16x16x32_bf16 v[112:115], a[80:83], v[76:79], v[112:115]
    v_mfma_f32_16x16x32_bf16 v[116:119], a[68:71], v[64:67], v[116:119]
    v_mfma_f32_16x16x32_bf16 v[116:119], a[84:87], v[76:79], v[116:119]
    v_mfma_f32_16x16x32_bf16 v[120:123], a[72:75], v[64:67], v[120:123]
    v_mfma_f32_16x16x32_bf16 v[120:123], a[88:91], v[76:79], v[120:123]
    v_mfma_f32_16x16x32_bf16 v[124:127], a[76:79], v[64:67], v[124:127]
    v_mfma_f32_16x16x32_bf16 v[124:127], a[92:95], v[76:79], v[124:127]
    buffer_load_dwordx4 v[64:67], v163, s[16:19], s99 offen sc1
    buffer_load_dwordx4 v[76:79], v163, s[16:19], s46 offen sc1
    s_waitcnt vmcnt(13)
    v_mfma_f32_16x16x32_bf16 v[128:131], a[64:67], v[68:71], v[128:131]
    v_mfma_f32_16x16x32_bf16 v[128:131], a[80:83], v[80:83], v[128:131]
    v_mfma_f32_16x16x32_bf16 v[132:135], a[68:71], v[68:71], v[132:135]
    v_mfma_f32_16x16x32_bf16 v[132:135], a[84:87], v[80:83], v[132:135]
    v_mfma_f32_16x16x32_bf16 v[136:139], a[72:75], v[68:71], v[136:139]
    v_mfma_f32_16x16x32_bf16 v[136:139], a[88:91], v[80:83], v[136:139]
    v_mfma_f32_16x16x32_bf16 v[140:143], a[76:79], v[68:71], v[140:143]
    v_mfma_f32_16x16x32_bf16 v[140:143], a[92:95], v[80:83], v[140:143]
    buffer_load_dwordx4 v[68:71], v164, s[16:19], s99 offen sc1
    buffer_load_dwordx4 v[80:83], v164, s[16:19], s46 offen sc1
    s_waitcnt vmcnt(13)
    v_mfma_f32_16x16x32_bf16 v[144:147], a[64:67], v[72:75], v[144:147]
    v_mfma_f32_16x16x32_bf16 v[144:147], a[80:83], v[84:87], v[144:147]
    v_mfma_f32_16x16x32_bf16 v[148:151], a[68:71], v[72:75], v[148:151]
    v_mfma_f32_16x16x32_bf16 v[148:151], a[84:87], v[84:87], v[148:151]
    v_mfma_f32_16x16x32_bf16 v[152:155], a[72:75], v[72:75], v[152:155]
    v_mfma_f32_16x16x32_bf16 v[152:155], a[88:91], v[84:87], v[152:155]
    v_mfma_f32_16x16x32_bf16 v[156:159], a[76:79], v[72:75], v[156:159]
    v_mfma_f32_16x16x32_bf16 v[156:159], a[92:95], v[84:87], v[156:159]
    buffer_load_dwordx4 v[72:75], v165, s[16:19], s99 offen sc1
    buffer_load_dwordx4 v[84:87], v165, s[16:19], s46 offen sc1
    s_add_u32 s99, s46, 1024
    s_and_b32 s99, s99, 0x3fff
    s_add_u32 s46, s99, 1024
    s_and_b32 s46, s46, 0x3fff
    s_waitcnt vmcnt(12)
    v_mfma_f32_16x16x32_bf16 v[112:115], a[96:99], v[88:91], v[112:115]
    v_mfma_f32_16x16x32_bf16 v[112:115], a[176:179], v[100:103], v[112:115]
    v_mfma_f32_16x16x32_bf16 v[116:119], a[100:103], v[88:91], v[116:119]
    v_mfma_f32_16x16x32_bf16 v[116:119], a[180:183], v[100:103], v[116:119]
    v_mfma_f32_16x16x32_bf16 v[120:123], a[104:107], v[88:91], v[120:123]
    v_mfma_f32_16x16x32_bf16 v[120:123], a[184:187], v[100:103], v[120:123]
    v_mfma_f32_16x16x32_bf16 v[124:127], a[108:111], v[88:91], v[124:127]
    v_mfma_f32_16x16x32_bf16 v[124:127], a[188:191], v[100:103], v[124:127]
    buffer_load_dwordx4 v[88:91], v163, s[16:19], s99 offen sc1
    buffer_load_dwordx4 v[100:103], v163, s[16:19], s46 offen sc1
    s_waitcnt vmcnt(11)
    v_mfma_f32_16x16x32_bf16 v[128:131], a[96:99], v[92:95], v[128:131]
    v_mfma_f32_16x16x32_bf16 v[128:131], a[176:179], v[104:107], v[128:131]
    v_mfma_f32_16x16x32_bf16 v[132:135], a[100:103], v[92:95], v[132:135]
    v_mfma_f32_16x16x32_bf16 v[132:135], a[180:183], v[104:107], v[132:135]
    v_mfma_f32_16x16x32_bf16 v[136:139], a[104:107], v[92:95], v[136:139]
    v_mfma_f32_16x16x32_bf16 v[136:139], a[184:187], v[104:107], v[136:139]
    v_mfma_f32_16x16x32_bf16 v[140:143], a[108:111], v[92:95], v[140:143]
    v_mfma_f32_16x16x32_bf16 v[140:143], a[188:191], v[104:107], v[140:143]
    buffer_load_dwordx4 v[92:95], v164, s[16:19], s99 offen sc1
    buffer_load_dwordx4 v[104:107], v164, s[16:19], s46 offen sc1
    s_waitcnt vmcnt(10)
    v_mfma_f32_16x16x32_bf16 v[144:147], a[96:99], v[96:99], v[144:147]
    v_mfma_f32_16x16x32_bf16 v[144:147], a[176:179], v[108:111], v[144:147]
    v_mfma_f32_16x16x32_bf16 v[148:151], a[100:103], v[96:99], v[148:151]
    v_mfma_f32_16x16x32_bf16 v[148:151], a[180:183], v[108:111], v[148:151]
    v_mfma_f32_16x16x32_bf16 v[152:155], a[104:107], v[96:99], v[152:155]
    v_mfma_f32_16x16x32_bf16 v[152:155], a[184:187], v[108:111], v[152:155]
    v_mfma_f32_16x16x32_bf16 v[156:159], a[108:111], v[96:99], v[156:159]
    v_mfma_f32_16x16x32_bf16 v[156:159], a[188:191], v[108:111], v[156:159]
    buffer_load_dwordx4 v[96:99], v165, s[16:19], s99 offen sc1
    buffer_load_dwordx4 v[108:111], v165, s[16:19], s46 offen sc1
    s_add_u32 s99, s46, 1024
    s_and_b32 s99, s99, 0x3fff
    s_add_u32 s46, s99, 1024
    s_and_b32 s46, s46, 0x3fff
    s_barrier
    s_cmp_lg_u32 s40, 0
    s_cbranch_scc1 L_c4
    s_mov_b64 exec, 1
    buffer_store_dwordx2 v[12:13], v0, s[36:39], s45 offen offset:512 sc1
    s_mov_b64 exec, -1
L_c4:
    s_waitcnt vmcnt(10)
    v_mfma_f32_16x16x32_bf16 v[112:115], a[192:195], v[64:67], v[112:115]
    v_mfma_f32_16x16x32_bf16 v[112:115], a[208:211], v[76:79], v[112:115]
    v_mfma_f32_16x16x32_bf16 v[116:119], a[196:199], v[64:67], v[116:119]
    v_mfma_f32_16x16x32_bf16 v[116:119], a[212:215], v[76:79], v[116:119]
    v_mfma_f32_16x16x32_bf16 v[120:123], a[200:203], v[64:67], v[120:123]
    v_mfma_f32_16x16x32_bf16 v[120:123], a[216:219], v[76:79], v[120:123]
    v_mfma_f32_16x16x32_bf16 v[124:127], a[204:207], v[64:67], v[124:127]
    v_mfma_f32_16x16x32_bf16 v[124:127], a[220:223], v[76:79], v[124:127]
    buffer_load_dwordx4 v[64:67], v163, s[16:19], s99 offen sc1
    buffer_load_dwordx4 v[76:79], v163, s[16:19], s46 offen sc1
    s_waitcnt vmcnt(10)
    v_mfma_f32_16x16x32_bf16 v[128:131], a[192:195], v[68:71], v[128:131]
    v_mfma_f32_16x16x32_bf16 v[128:131], a[208:211], v[80:83], v[128:131]
    v_mfma_f32_16x16x32_bf16 v[132:135], a[196:199], v[68:71], v[132:135]
    v_mfma_f32_16x16x32_bf16 v[132:135], a[212:215], v[80:83], v[132:135]
    v_mfma_f32_16x16x32_bf16 v[136:139], a[200:203], v[68:71], v[136:139]
    v_mfma_f32_16x16x32_bf16 v[136:139], a[216:219], v[80:83], v[136:139]
    v_mfma_f32_16x16x32_bf16 v[140:143], a[204:207], v[68:71], v[140:143]
    v_mfma_f32_16x16x32_bf16 v[140:143], a[220:223], v[80:83], v[140:143]
    buffer_load_dwordx4 v[68:71], v164, s[16:19], s99 offen sc1
    buffer_load_dwordx4 v[80:83], v164, s[16:19], s46 offen sc1
    s_waitcnt vmcnt(10)
    v_mfma_f32_16x16x32_bf16 v[144:147], a[192:195], v[72:75], v[144:147]
    v_mfma_f32_16x16x32_bf16 v[144:147], a[208:211], v[84:87], v[144:147]
    v_mfma_f32_16x16x32_bf16 v[148:151], a[196:199], v[72:75], v[148:151]
    v_mfma_f32_16x16x32_bf16 v[148:151], a[212:215], v[84:87], v[148:151]
    v_mfma_f32_16x16x32_bf16 v[152:155], a[200:203], v[72:75], v[152:155]
    v_mfma_f32_16x16x32_bf16 v[152:155], a[216:219], v[84:87], v[152:155]
    v_mfma_f32_16x16x32_bf16 v[156:159], a[204:207], v[72:75], v[156:159]
    v_mfma_f32_16x16x32_bf16 v[156:159], a[220:223], v[84:87], v[156:159]
    buffer_load_dwordx4 v[72:75], v165, s[16:19], s99 offen sc1
    buffer_load_dwordx4 v[84:87], v165, s[16:19], s46 offen sc1
    s_add_u32 s99, s46, 1024
    s_and_b32 s99, s99, 0x3fff
    s_add_u32 s46, s99, 1024
    s_and_b32 s46, s46, 0x3fff
    s_waitcnt vmcnt(10)
    v_mfma_f32_16x16x32_bf16 v[112:115], a[224:227], v[88:91], v[112:115]
    v_mfma_f32_16x16x32_bf16 v[112:115], a[112:115], v[100:103], v[112:115]
    v_mfma_f32_16x16x32_bf16 v[116:119], a[228:231], v[88:91], v[116:119]
    v_mfma_f32_16x16x32_bf16 v[116:119], a[116:119], v[100:103], v[116:119]
    v_mfma_f32_16x16x32_bf16 v[120:123], a[232:235], v[88:91], v[120:123]
    v_mfma_f32_16x16x32_bf16 v[120:123], a[120:123], v[100:103], v[120:123]
    v_mfma_f32_16x16x32_bf16 v[124:127], a[236:239], v[88:91], v[124:127]
    v_mfma_f32_16x16x32_bf16 v[124:127], a[124:127], v[100:103], v[124:127]
    buffer_load_dwordx4 v[88:91], v163, s[16:19], s99 offen sc1
    buffer_load_dwordx4 v[100:103], v163, s[16:19], s46 offen sc1
    s_waitcnt vmcnt(10)
    v_mfma_f32_16x16x32_bf16 v[128:131], a[224:227], v[92:95], v[128:131]
    v_mfma_f32_16x16x32_bf16 v[128:131], a[112:115], v[104:107], v[128:131]
    v_mfma_f32_16x16x32_bf16 v[132:135], a[228:231], v[92:95], v[132:135]
    v_mfma_f32_16x16x32_bf16 v[132:135], a[116:119], v[104:107], v[132:135]
    v_mfma_f32_16x16x32_bf16 v[136:139], a[232:235], v[92:95], v[136:139]
    v_mfma_f32_16x16x32_bf16 v[136:139], a[120:123], v[104:107], v[136:139]
    v_mfma_f32_16x16x32_bf16 v[140:143], a[236:239], v[92:95], v[140:143]
    v_mfma_f32_16x16x32_bf16 v[140:143], a[124:127], v[104:107], v[140:143]
    buffer_load_dwordx4 v[92:95], v164, s[16:19], s99 offen sc1
    buffer_load_dwordx4 v[104:107], v164, s[16:19], s46 offen sc1
    s_waitcnt vmcnt(10)
    v_mfma_f32_16x16x32_bf16 v[144:147], a[224:227], v[96:99], v[144:147]
    v_mfma_f32_16x16x32_bf16 v[144:147], a[112:115], v[108:111], v[144:147]
    v_mfma_f32_16x16x32_bf16 v[148:151], a[228:231], v[96:99], v[148:151]
    v_mfma_f32_16x16x32_bf16 v[148:151], a[116:119], v[108:111], v[148:151]
    v_mfma_f32_16x16x32_bf16 v[152:155], a[232:235], v[96:99], v[152:155]
    v_mfma_f32_16x16x32_bf16 v[152:155], a[120:123], v[108:111], v[152:155]
    v_mfma_f32_16x16x32_bf16 v[156:159], a[236:239], v[96:99], v[156:159]
    v_mfma_f32_16x16x32_bf16 v[156:159], a[124:127], v[108:111], v[156:159]
    buffer_load_dwordx4 v[96:99], v165, s[16:19], s99 offen sc1
    buffer_load_dwordx4 v[108:111], v165, s[16:19], s46 offen sc1
    s_add_u32 s99, s46, 1024
    s_and_b32 s99, s99, 0x3fff
    s_add_u32 s46, s99, 1024
    s_and_b32 s46, s46, 0x3fff
    buffer_load_dwordx2 v[172:173], v170, s[36:39], 0 offen offset:512 sc1
    s_waitcnt vmcnt(11)
    v_mfma_f32_16x16x32_bf16 v[112:115], a[128:131], v[64:67], v[112:115]
    v_mfma_f32_16x16x32_bf16 v[112:115], a[144:147], v[76:79], v[112:115]
    v_mfma_f32_16x16x32_bf16 v[116:119], a[132:135], v[64:67], v[116:119]
    v_mfma_f32_16x16x32_bf16 v[116:119], a[148:151], v[76:79], v[116:119]
    v_mfma_f32_16x16x32_bf16 v[120:123], a[136:139], v[64:67], v[120:123]
    v_mfma_f32_16x16x32_bf16 v[120:123], a[152:155], v[76:79], v[120:123]
    v_mfma_f32_16x16x32_bf16 v[124:127], a[140:143], v[64:67], v[124:127]
    v_mfma_f32_16x16x32_bf16 v[124:127], a[156:159], v[76:79], v[124:127]
    s_waitcnt vmcnt(9)
    v_mfma_f32_16x16x32_bf16 v[128:131], a[128:131], v[68:71], v[128:131]
    v_mfma_f32_16x16x32_bf16 v[128:131], a[144:147], v[80:83], v[128:131]
    v_mfma_f32_16x16x32_bf16 v[132:135], a[132:135], v[68:71], v[132:135]
    v_mfma_f32_16x16x32_bf16 v[132:135], a[148:151], v[80:83], v[132:135]
    v_mfma_f32_16x16x32_bf16 v[136:139], a[136:139], v[68:71], v[136:139]
    v_mfma_f32_16x16x32_bf16 v[136:139], a[152:155], v[80:83], v[136:139]
    v_mfma_f32_16x16x32_bf16 v[140:143], a[140:143], v[68:71], v[140:143]
    v_mfma_f32_16x16x32_bf16 v[140:143], a[156:159], v[80:83], v[140:143]
    s_waitcnt vmcnt(7)
    v_mfma_f32_16x16x32_bf16 v[144:147], a[128:131], v[72:75], v[144:147]
    v_mfma_f32_16x16x32_bf16 v[144:147], a[144:147], v[84:87], v[144:147]
    v_mfma_f32_16x16x32_bf16 v[148:151], a[132:135], v[72:75], v[148:151]
    v_mfma_f32_16x16x32_bf16 v[148:151], a[148:151], v[84:87], v[148:151]
    v_mfma_f32_16x16x32_bf16 v[152:155], a[136:139], v[72:75], v[152:155]
    v_mfma_f32_16x16x32_bf16 v[152:155], a[152:155], v[84:87], v[152:155]
    v_mfma_f32_16x16x32_bf16 v[156:159], a[140:143], v[72:75], v[156:159]
    v_mfma_f32_16x16x32_bf16 v[156:159], a[156:159], v[84:87], v[156:159]
    s_add_u32 s99, s46, 1024
    s_and_b32 s99, s99, 0x3fff
    s_add_u32 s46, s99, 1024
    s_and_b32 s46, s46, 0x3fff
    s_waitcnt vmcnt(5)
    v_mfma_f32_16x16x32_bf16 v[112:115], a[160:163], v[88:91], v[112:115]
    v_mfma_f32_16x16x32_bf16 v[112:115], a[240:243], v[100:103], v[112:115]
    v_mfma_f32_16x16x32_bf16 v[116:119], a[164:167], v[88:91], v[116:119]
    v_mfma_f32_16x16x32_bf16 v[116:119], a[244:247], v[100:103], v[116:119]
    v_mfma_f32_16x16x32_bf16 v[120:123], a[168:171], v[88:91], v[120:123]
    v_mfma_f32_16x16x32_bf16 v[120:123], a[248:251], v[100:103], v[120:123]
    v_mfma_f32_16x16x32_bf16 v[124:127], a[172:175], v[88:91], v[124:127]
    v_mfma_f32_16x16x32_bf16 v[124:127], a[252:255], v[100:103], v[124:127]
    s_waitcnt vmcnt(3)
    v_mfma_f32_16x16x32_bf16 v[128:131], a[160:163], v[92:95], v[128:131]
    v_mfma_f32_16x16x32_bf16 v[128:131], a[240:243], v[104:107], v[128:131]
    v_mfma_f32_16x16x32_bf16 v[132:135], a[164:167], v[92:95], v[132:135]
    ds_write_b128 v167, v[112:115] offset:0
    v_mfma_f32_16x16x32_bf16 v[132:135], a[244:247], v[104:107], v[132:135]
    ds_write_b128 v167, v[116:119] offset:1024
    v_mfma_f32_16x16x32_bf16 v[136:139], a[168:171], v[92:95], v[136:139]
    ds_write_b128 v167, v[120:123] offset:2048
    v_mfma_f32_16x16x32_bf16 v[136:139], a[248:251], v[104:107], v[136:139]
    ds_write_b128 v167, v[124:127] offset:3072
    v_mfma_f32_16x16x32_bf16 v[140:143], a[172:175], v[92:95], v[140:143]
    v_mfma_f32_16x16x32_bf16 v[140:143], a[252:255], v[104:107], v[140:143]
    s_waitcnt vmcnt(1)
    v_mfma_f32_16x16x32_bf16 v[144:147], a[160:163], v[96:99], v[144:147]
    v_mfma_f32_16x16x32_bf16 v[144:147], a[240:243], v[108:111], v[144:147]
    v_mfma_f32_16x16x32_bf16 v[148:151], a[164:167], v[96:99], v[148:151]
    ds_write_b128 v167, v[128:131] offset:4096
    v_mfma_f32_16x16x32_bf16 v[148:151], a[244:247], v[108:111], v[148:151]
    ds_write_b128 v167, v[132:135] offset:5120
    v_mfma_f32_16x16x32_bf16 v[152:155], a[168:171], v[96:99], v[152:155]
    ds_write_b128 v167, v[136:139] offset:6144
    v_mfma_f32_16x16x32_bf16 v[152:155], a[248:251], v[108:111], v[152:155]
    ds_write_b128 v167, v[140:143] offset:7168
    v_mfma_f32_16x16x32_bf16 v[156:159], a[172:175], v[96:99], v[156:159]
    v_mfma_f32_16x16x32_bf16 v[156:159], a[252:255], v[108:111], v[156:159]
    s_add_u32 s99, s46, 1024
    s_and_b32 s99, s99, 0x3fff
    s_add_u32 s46, s99, 1024
    s_and_b32 s46, s46, 0x3fff
    s_nop 3
    ds_write_b128 v167, v[144:147] offset:8192
    ds_write_b128 v167, v[148:151] offset:9216
    ds_write_b128 v167, v[152:155] offset:10240
    ds_write_b128 v167, v[156:159] offset:11264
    s_waitcnt lgkmcnt(0)
    s_cmp_lg_u32 s40, 0
    s_cbranch_scc1 L_poll3_ok
    s_waitcnt vmcnt(0)
    v_cmp_ne_u64 vcc, s[92:93], v[172:173]
    s_cbranch_vccz L_poll3_ok
    s_mov_b32 s13, 0x100000
L_poll3:
    buffer_load_dwordx2 v[172:173], v170, s[36:39], 0 offen offset:512 sc1
    s_waitcnt vmcnt(0)
    v_cmp_ne_u64 vcc, s[92:93], v[172:173]
    s_cbranch_vccz L_poll3_ok
    s_sleep 1
    s_sub_u32 s13, s13, 1
    s_cbranch_scc0 L_poll3
L_poll3_ok:
    s_barrier
    buffer_load_dwordx4 v[224:227], v166, s[36:39], s41 offen offset:0 sc1
    buffer_load_dwordx4 v[228:231], v166, s[36:39], s41 offen offset:1024 sc1
    buffer_load_dwordx4 v[232:235], v166, s[36:39], s41 offen offset:2048 sc1
    ds_read_b128 v[176:179], v168 offset:0
    ds_read_b128 v[180:183], v168 offset:15360
    ds_read_b128 v[184:187], v168 offset:30720
    ds_read_b128 v[188:191], v168 offset:46080
    ds_read_b128 v[192:195], v168 offset:4096
    ds_read_b128 v[196:199], v168 offset:19456
    ds_read_b128 v[200:203], v168 offset:34816
    ds_read_b128 v[204:207], v168 offset:50176
    ds_read_b128 v[208:211], v168 offset:8192
    ds_read_b128 v[212:215], v168 offset:23552
    ds_read_b128 v[216:219], v168 offset:38912
    ds_read_b128 v[220:223], v168 offset:54272
    s_lshl_b32 s99, s97, 1
    s_add_u32 s99, s99, s42
    s_mul_i32 s99, s99, 49152
    s_lshl_b32 s55, s98, 7
    s_add_u32 s99, s99, s55
    s_lshl_b32 s55, s40, 5
    s_add_u32 s99, s99, s55
    s_waitcnt lgkmcnt(8)
    v_pk_add_f32 v[176:177], v[176:177], v[180:181]
    v_pk_add_f32 v[184:185], v[184:185], v[188:189]
    v_pk_add_f32 v[178:179], v[178:179], v[182:183]
    v_pk_add_f32 v[186:187], v[186:187], v[190:191]
    v_pk_add_f32 v[176:177], v[176:177], v[184:185]
    v_pk_add_f32 v[178:179], v[178:179], v[186:187]
    s_waitcnt lgkmcnt(4)
    v_pk_add_f32 v[192:193], v[192:193], v[196:197]
    v_pk_add_f32 v[200:201], v[200:201], v[204:205]
    v_pk_add_f32 v[194:195], v[194:195], v[198:199]
    v_pk_add_f32 v[202:203], v[202:203], v[206:207]
    v_pk_add_f32 v[192:193], v[192:193], v[200:201]
    v_pk_add_f32 v[194:195], v[194:195], v[202:203]
    s_waitcnt lgkmcnt(0)
    v_pk_add_f32 v[208:209], v[208:209], v[212:213]
    v_pk_add_f32 v[216:217], v[216:217], v[220:221]
    v_pk_add_f32 v[210:211], v[210:211], v[214:215]
    v_pk_add_f32 v[218:219], v[218:219], v[222:223]
    v_pk_add_f32 v[208:209], v[208:209], v[216:217]
    v_pk_add_f32 v[210:211], v[210:211], v[218:219]
    s_waitcnt vmcnt(2)
    v_pk_add_f32 v[176:177], v[176:177], v[224:225]
    v_pk_add_f32 v[178:179], v[178:179], v[226:227]
    v_cvt_pk_bf16_f32 v176, v176, v177
    v_cvt_pk_bf16_f32 v177, v178, v179
    buffer_store_dwordx2 v[176:177], v169, s[8:11], s99 offen
    s_add_u32 s99, s99, 16384
    s_waitcnt vmcnt(2)
    v_pk_add_f32 v[192:193], v[192:193], v[228:229]
    v_pk_add_f32 v[194:195], v[194:195], v[230:231]
    v_cvt_pk_bf16_f32 v192, v192, v193
    v_cvt_pk_bf16_f32 v193, v194, v195
    buffer_store_dwordx2 v[192:193], v169, s[8:11], s99 offen
    s_add_u32 s99, s99, 16384
    s_waitcnt vmcnt(2)
    v_pk_add_f32 v[208:209], v[208:209], v[232:233]
    v_pk_add_f32 v[210:211], v[210:211], v[234:235]
    v_cvt_pk_bf16_f32 v208, v208, v209
    v_cvt_pk_bf16_f32 v209, v210, v211
    buffer_store_dwordx2 v[208:209], v169, s[8:11], s99 offen
L_end:
    s_endpgm
L_ncslow:
    s_mov_b32 s13, 0x100000
L_ncs2:
    s_sleep 8
    buffer_load_dwordx2 v[252:253], v254, s[4:7], 0 offen offset:128 sc1
    s_waitcnt vmcnt(0)
    v_readfirstlane_b32 s92, v252
    v_readfirstlane_b32 s93, v253
    s_cmp_lg_u32 s92, 0
    s_cbranch_scc1 L_ncok
    s_sub_u32 s13, s13, 1
    s_cbranch_scc0 L_ncs2
    s_branch L_ncok
L_st1_0:
    s_call_b64 s[50:51], L_rare0
    s_branch L_bk1_0
L_st1_1:
    s_call_b64 s[50:51], L_rare1
    s_branch L_bk1_1
L_st1_2:
    s_call_b64 s[50:51], L_rare2
    s_branch L_bk1_2
L_st2_0:
    s_call_b64 s[50:51], L_rare0
    s_branch L_bk2_0
L_st2_1:
    s_call_b64 s[50:51], L_rare1
    s_branch L_bk2_1
L_st2_2:
    s_call_b64 s[50:51], L_rare2
    s_branch L_bk2_2
L_st3_0:
    s_call_b64 s[50:51], L_rare0
    s_branch L_bk3_0
L_st3_1:
    s_call_b64 s[50:51], L_rare1
    s_branch L_bk3_1
L_st3_2:
    s_call_b64 s[50:51], L_rare2
    s_branch L_bk3_2
L_st4_0:
    s_call_b64 s[50:51], L_rare0
    s_branch L_bk4_0
L_st4_1:
    s_call_b64 s[50:51], L_rare1
    s_branch L_bk4_1
L_st4_2:
    s_call_b64 s[50:51], L_rare2
    s_branch L_bk4_2
L_st5_0:
    s_call_b64 s[50:51], L_rare0
    s_branch L_bk5_0
L_st5_1:
    s_call_b64 s[50:51], L_rare1
    s_branch L_bk5_1
L_st5_2:
    s_call_b64 s[50:51], L_rare2
    s_branch L_bk5_2
L_st6_0:
    s_call_b64 s[50:51], L_rare0
    s_branch L_bk6_0
L_st6_1:
    s_call_b64 s[50:51], L_rare1
    s_branch L_bk6_1
L_st6_2:
    s_call_b64 s[50:51], L_rare2
    s_branch L_bk6_2
L_st7_0:
    s_call_b64 s[50:51], L_rare0
    s_branch L_bk7_0
L_st7_1:
    s_call_b64 s[50:51], L_rare1
    s_branch L_bk7_1
L_st7_2:
    s_call_b64 s[50:51], L_rare2
    s_branch L_bk7_2
L_st8_0:
    s_call_b64 s[50:51], L_rare0
    s_branch L_bk8_0
L_st8_1:
    s_call_b64 s[50:51], L_rare1
    s_branch L_bk8_1
L_st8_2:
    s_call_b64 s[50:51], L_rare2
    s_branch L_bk8_2
L_st9_0:
    s_call_b64 s[50:51], L_rare0
    s_branch L_bk9_0
L_st9_1:
    s_call_b64 s[50:51], L_rare1
    s_branch L_bk9_1
L_st9_2:
    s_call_b64 s[50:51], L_rare2
    s_branch L_bk9_2
L_st10_0:
    s_call_b64 s[50:51], L_rare0
    s_branch L_bk10_0
L_st10_1:
    s_call_b64 s[50:51], L_rare1
    s_branch L_bk10_1
L_st10_2:
    s_call_b64 s[50:51], L_rare2
    s_branch L_bk10_2
L_st11_0:
    s_call_b64 s[50:51], L_rare0
    s_branch L_bk11_0
L_st11_1:
    s_call_b64 s[50:51], L_rare1
    s_branch L_bk11_1
L_st11_2:
    s_call_b64 s[50:51], L_rare2
    s_branch L_bk11_2
L_st12_0:
    s_call_b64 s[50:51], L_rare0
    s_branch L_bk12_0
L_st12_1:
    s_call_b64 s[50:51], L_rare1
    s_branch L_bk12_1
L_st12_2:
    s_call_b64 s[50:51], L_rare2
    s_branch L_bk12_2
L_st13_0:
    s_call_b64 s[50:51], L_rare0
    s_branch L_bk13_0
L_st13_1:
    s_call_b64 s[50:51], L_rare1
    s_branch L_bk13_1
L_st13_2:
    s_call_b64 s[50:51], L_rare2
    s_branch L_bk13_2
L_st14_0:
    s_call_b64 s[50:51], L_rare0
    s_branch L_bk14_0
L_st14_1:
    s_call_b64 s[50:51], L_rare1
    s_branch L_bk14_1
L_st14_2:
    s_call_b64 s[50:51], L_rare2
    s_branch L_bk14_2
L_st15_0:
    s_call_b64 s[50:51], L_rare0
    s_branch L_bk15_0
L_st15_1:
    s_call_b64 s[50:51], L_rare1
    s_branch L_bk15_1
L_st15_2:
    s_call_b64 s[50:51], L_rare2
    s_branch L_bk15_2
L_rare0:
    s_nop 7
    v_max3_f32 v248, v160, v161, v162
    v_max3_f32 v249, v163, v164, v165
    v_max3_f32 v248, v248, v166, v167
    v_max3_f32 v249, v249, v168, v169
    v_max3_f32 v248, v248, v170, v171
    v_max3_f32 v249, v249, v172, v173
    v_max3_f32 v248, v248, v174, v175
    v_max_f32 v248, v248, v249
    v_mov_b32 v250, v248
    s_nop 1
    v_permlane32_swap_b32 v250, v248
    s_nop 1
    v_max_f32 v248, v248, v250
    v_mov_b32 v250, v248
    s_nop 1
    v_permlane16_swap_b32 v250, v248
    s_nop 1
    v_max_f32 v248, v248, v250
    v_add_f32 v248, 0x41000000, v248
    v_max_f32 v248, 0, v248
    v_sub_f32 v160, v160, v248
    v_sub_f32 v161, v161, v248
    v_sub_f32 v162, v162, v248
    v_sub_f32 v163, v163, v248
    v_sub_f32 v164, v164, v248
    v_sub_f32 v165, v165, v248
    v_sub_f32 v166, v166, v248
    v_sub_f32 v167, v167, v248
    v_sub_f32 v168, v168, v248
    v_sub_f32 v169, v169, v248
    v_sub_f32 v170, v170, v248
    v_sub_f32 v171, v171, v248
    v_sub_f32 v172, v172, v248
    v_sub_f32 v173, v173, v248
    v_sub_f32 v174, v174, v248
    v_sub_f32 v175, v175, v248
    v_exp_f32 v160, v160
    v_exp_f32 v161, v161
    v_exp_f32 v162, v162
    v_exp_f32 v163, v163
    v_exp_f32 v164, v164
    v_exp_f32 v165, v165
    v_exp_f32 v166, v166
    v_exp_f32 v167, v167
    v_exp_f32 v168, v168
    v_exp_f32 v169, v169
    v_exp_f32 v170, v170
    v_exp_f32 v171, v171
    v_exp_f32 v172, v172
    v_exp_f32 v173, v173
    v_exp_f32 v174, v174
    v_exp_f32 v175, v175
    v_sub_f32 v12, 0, v248
    v_exp_f32 v12, v12
    v_sub_f32 v232, v232, v248
    v_sub_f32 v233, v233, v248
    v_sub_f32 v234, v234, v248
    v_sub_f32 v235, v235, v248
    v_cvt_pk_bf16_f32 v208, v160, v161
    v_cvt_pk_bf16_f32 v209, v162, v163
    v_cvt_pk_bf16_f32 v210, v164, v165
    v_cvt_pk_bf16_f32 v211, v166, v167
    v_cvt_pk_bf16_f32 v212, v168, v169
    v_cvt_pk_bf16_f32 v213, v170, v171
    v_cvt_pk_bf16_f32 v214, v172, v173
    v_cvt_pk_bf16_f32 v215, v174, v175
    v_mul_f32 v16, v16, v12
    v_mul_f32 v17, v17, v12
    v_mul_f32 v18, v18, v12
    v_mul_f32 v19, v19, v12
    v_mul_f32 v20, v20, v12
    v_mul_f32 v21, v21, v12
    v_mul_f32 v22, v22, v12
    v_mul_f32 v23, v23, v12
    v_mul_f32 v24, v24, v12
    v_mul_f32 v25, v25, v12
    v_mul_f32 v26, v26, v12
    v_mul_f32 v27, v27, v12
    v_mul_f32 v28, v28, v12
    v_mul_f32 v29, v29, v12
    v_mul_f32 v30, v30, v12
    v_mul_f32 v31, v31, v12
    v_mul_f32 v32, v32, v12
    v_mul_f32 v33, v33, v12
    v_mul_f32 v34, v34, v12
    v_mul_f32 v35, v35, v12
    v_mul_f32 v36, v36, v12
    v_mul_f32 v37, v37, v12
    v_mul_f32 v38, v38, v12
    v_mul_f32 v39, v39, v12
    v_mul_f32 v40, v40, v12
    v_mul_f32 v41, v41, v12
    v_mul_f32 v42, v42, v12
    v_mul_f32 v43, v43, v12
    v_mul_f32 v44, v44, v12
    v_mul_f32 v45, v45, v12
    v_mul_f32 v46, v46, v12
    v_mul_f32 v47, v47, v12
    v_accvgpr_read_b32 v13, a240
    v_mul_f32 v13, v13, v12
    v_accvgpr_write_b32 a240, v13
    v_accvgpr_read_b32 v13, a241
    v_mul_f32 v13, v13, v12
    v_accvgpr_write_b32 a241, v13
    v_accvgpr_read_b32 v13, a242
    v_mul_f32 v13, v13, v12
    v_accvgpr_write_b32 a242, v13
    v_accvgpr_read_b32 v13, a243
    v_mul_f32 v13, v13, v12
    v_accvgpr_write_b32 a243, v13
    s_nop 1
    s_setpc_b64 s[50:51]
L_rare1:
    s_nop 7
    v_max3_f32 v248, v176, v177, v178
    v_max3_f32 v249, v179, v180, v181
    v_max3_f32 v248, v248, v182, v183
    v_max3_f32 v249, v249, v184, v185
    v_max3_f32 v248, v248, v186, v187
    v_max3_f32 v249, v249, v188, v189
    v_max3_f32 v248, v248, v190, v191
    v_max_f32 v248, v248, v249
    v_mov_b32 v250, v248
    s_nop 1
    v_permlane32_swap_b32 v250, v248
    s_nop 1
    v_max_f32 v248, v248, v250
    v_mov_b32 v250, v248
    s_nop 1
    v_permlane16_swap_b32 v250, v248
    s_nop 1
    v_max_f32 v248, v248, v250
    v_add_f32 v248, 0x41000000, v248
    v_max_f32 v248, 0, v248
    v_sub_f32 v176, v176, v248
    v_sub_f32 v177, v177, v248
    v_sub_f32 v178, v178, v248
    v_sub_f32 v179, v179, v248
    v_sub_f32 v180, v180, v248
    v_sub_f32 v181, v181, v248
    v_sub_f32 v182, v182, v248
    v_sub_f32 v183, v183, v248
    v_sub_f32 v184, v184, v248
    v_sub_f32 v185, v185, v248
    v_sub_f32 v186, v186, v248
    v_sub_f32 v187, v187, v248
    v_sub_f32 v188, v188, v248
    v_sub_f32 v189, v189, v248
    v_sub_f32 v190, v190, v248
    v_sub_f32 v191, v191, v248
    v_exp_f32 v176, v176
    v_exp_f32 v177, v177
    v_exp_f32 v178, v178
    v_exp_f32 v179, v179
    v_exp_f32 v180, v180
    v_exp_f32 v181, v181
    v_exp_f32 v182, v182
    v_exp_f32 v183, v183
    v_exp_f32 v184, v184
    v_exp_f32 v185, v185
    v_exp_f32 v186, v186
    v_exp_f32 v187, v187
    v_exp_f32 v188, v188
    v_exp_f32 v189, v189
    v_exp_f32 v190, v190
    v_exp_f32 v191, v191
    v_sub_f32 v12, 0, v248
    v_exp_f32 v12, v12
    v_sub_f32 v236, v236, v248
    v_sub_f32 v237, v237, v248
    v_sub_f32 v238, v238, v248
    v_sub_f32 v239, v239, v248
    v_cvt_pk_bf16_f32 v216, v176, v177
    v_cvt_pk_bf16_f32 v217, v178, v179
    v_cvt_pk_bf16_f32 v218, v180, v181
    v_cvt_pk_bf16_f32 v219, v182, v183
    v_cvt_pk_bf16_f32 v220, v184, v185
    v_cvt_pk_bf16_f32 v221, v186, v187
    v_cvt_pk_bf16_f32 v222, v188, v189
    v_cvt_pk_bf16_f32 v223, v190, v191
    v_mul_f32 v48, v48, v12
    v_mul_f32 v49, v49, v12
    v_mul_f32 v50, v50, v12
    v_mul_f32 v51, v51, v12
    v_mul_f32 v52, v52, v12
    v_mul_f32 v53, v53, v12
    v_mul_f32 v54, v54, v12
    v_mul_f32 v55, v55, v12
    v_mul_f32 v56, v56, v12
    v_mul_f32 v57, v57, v12
    v_mul_f32 v58, v58, v12
    v_mul_f32 v59, v59, v12
    v_mul_f32 v60, v60, v12
    v_mul_f32 v61, v61, v12
    v_mul_f32 v62, v62, v12
    v_mul_f32 v63, v63, v12
    v_mul_f32 v64, v64, v12
    v_mul_f32 v65, v65, v12
    v_mul_f32 v66, v66, v12
    v_mul_f32 v67, v67, v12
    v_mul_f32 v68, v68, v12
    v_mul_f32 v69, v69, v12
    v_mul_f32 v70, v70, v12
    v_mul_f32 v71, v71, v12
    v_mul_f32 v72, v72, v12
    v_mul_f32 v73, v73, v12
    v_mul_f32 v74, v74, v12
    v_mul_f32 v75, v75, v12
    v_mul_f32 v76, v76, v12
    v_mul_f32 v77, v77, v12
    v_mul_f32 v78, v78, v12
    v_mul_f32 v79, v79, v12
    v_accvgpr_read_b32 v13, a244
    v_mul_f32 v13, v13, v12
    v_accvgpr_write_b32 a244, v13
    v_accvgpr_read_b32 v13, a245
    v_mul_f32 v13, v13, v12
    v_accvgpr_write_b32 a245, v13
    v_accvgpr_read_b32 v13, a246
    v_mul_f32 v13, v13, v12
    v_accvgpr_write_b32 a246, v13
    v_accvgpr_read_b32 v13, a247
    v_mul_f32 v13, v13, v12
    v_accvgpr_write_b32 a247, v13
    s_nop 1
    s_setpc_b64 s[50:51]
L_rare2:
    s_nop 7
    v_max3_f32 v248, v192, v193, v194
    v_max3_f32 v249, v195, v196, v197
    v_max3_f32 v248, v248, v198, v199
    v_max3_f32 v249, v249, v200, v201
    v_max3_f32 v248, v248, v202, v203
    v_max3_f32 v249, v249, v204, v205
    v_max3_f32 v248, v248, v206, v207
    v_max_f32 v248, v248, v249
    v_mov_b32 v250, v248
    s_nop 1
    v_permlane32_swap_b32 v250, v248
    s_nop 1
    v_max_f32 v248, v248, v250
    v_mov_b32 v250, v248
    s_nop 1
    v_permlane16_swap_b32 v250, v248
    s_nop 1
    v_max_f32 v248, v248, v250
    v_add_f32 v248, 0x41000000, v248
    v_max_f32 v248, 0, v248
    v_sub_f32 v192, v192, v248
    v_sub_f32 v193, v193, v248
    v_sub_f32 v194, v194, v248
    v_sub_f32 v195, v195, v248
    v_sub_f32 v196, v196, v248
    v_sub_f32 v197, v197, v248
    v_sub_f32 v198, v198, v248
    v_sub_f32 v199, v199, v248
    v_sub_f32 v200, v200, v248
    v_sub_f32 v201, v201, v248
    v_sub_f32 v202, v202, v248
    v_sub_f32 v203, v203, v248
    v_sub_f32 v204, v204, v248
    v_sub_f32 v205, v205, v248
    v_sub_f32 v206, v206, v248
    v_sub_f32 v207, v207, v248
    v_exp_f32 v192, v192
    v_exp_f32 v193, v193
    v_exp_f32 v194, v194
    v_exp_f32 v195, v195
    v_exp_f32 v196, v196
    v_exp_f32 v197, v197
    v_exp_f32 v198, v198
    v_exp_f32 v199, v199
    v_exp_f32 v200, v200
    v_exp_f32 v201, v201
    v_exp_f32 v202, v202
    v_exp_f32 v203, v203
    v_exp_f32 v204, v204
    v_exp_f32 v205, v205
    v_exp_f32 v206, v206
    v_exp_f32 v207, v207
    v_sub_f32 v12, 0, v248
    v_exp_f32 v12, v12
    v_sub_f32 v240, v240, v248
    v_sub_f32 v241, v241, v248
    v_sub_f32 v242, v242, v248
    v_sub_f32 v243, v243, v248
    v_cvt_pk_bf16_f32 v224, v192, v193
    v_cvt_pk_bf16_f32 v225, v194, v195
    v_cvt_pk_bf16_f32 v226, v196, v197
    v_cvt_pk_bf16_f32 v227, v198, v199
    v_cvt_pk_bf16_f32 v228, v200, v201
    v_cvt_pk_bf16_f32 v229, v202, v203
    v_cvt_pk_bf16_f32 v230, v204, v205
    v_cvt_pk_bf16_f32 v231, v206, v207
    v_mul_f32 v80, v80, v12
    v_mul_f32 v81, v81, v12
    v_mul_f32 v82, v82, v12
    v_mul_f32 v83, v83, v12
    v_mul_f32 v84, v84, v12
    v_mul_f32 v85, v85, v12
    v_mul_f32 v86, v86, v12
    v_mul_f32 v87, v87, v12
    v_mul_f32 v88, v88, v12
    v_mul_f32 v89, v89, v12
    v_mul_f32 v90, v90, v12
    v_mul_f32 v91, v91, v12
    v_mul_f32 v92, v92, v12
    v_mul_f32 v93, v93, v12
    v_mul_f32 v94, v94, v12
    v_mul_f32 v95, v95, v12
    v_mul_f32 v96, v96, v12
    v_mul_f32 v97, v97, v12
    v_mul_f32 v98, v98, v12
    v_mul_f32 v99, v99, v12
    v_mul_f32 v100, v100, v12
    v_mul_f32 v101, v101, v12
    v_mul_f32 v102, v102, v12
    v_mul_f32 v103, v103, v12
    v_mul_f32 v104, v104, v12
    v_mul_f32 v105, v105, v12
    v_mul_f32 v106, v106, v12
    v_mul_f32 v107, v107, v12
    v_mul_f32 v108, v108, v12
    v_mul_f32 v109, v109, v12
    v_mul_f32 v110, v110, v12
    v_mul_f32 v111, v111, v12
    v_accvgpr_read_b32 v13, a248
    v_mul_f32 v13, v13, v12
    v_accvgpr_write_b32 a248, v13
    v_accvgpr_read_b32 v13, a249
    v_mul_f32 v13, v13, v12
    v_accvgpr_write_b32 a249, v13
    v_accvgpr_read_b32 v13, a250
    v_mul_f32 v13, v13, v12
    v_accvgpr_write_b32 a250, v13
    v_accvgpr_read_b32 v13, a251
    v_mul_f32 v13, v13, v12
    v_accvgpr_write_b32 a251, v13
    s_nop 1
    s_setpc_b64 s[50:51]
L_codeend:
.section .rodata,"a"
.p2align 6
.amdhsa_kernel standalone__gqa_block_cached__near_ridge_kernel
  .amdhsa_next_free_vgpr 512
  .amdhsa_next_free_sgpr 102
  .amdhsa_accum_offset 256
  .amdhsa_group_segment_fixed_size 0
  .amdhsa_kernarg_size 64
  .amdhsa_user_sgpr_count 2
  .amdhsa_user_sgpr_kernarg_segment_ptr 1
  .amdhsa_system_sgpr_workgroup_id_x 1
  .amdhsa_float_denorm_mode_32 3
.end_amdhsa_kernel
```
